```python
import torch

def _softmax(x, axis=-1):
    return torch.softmax(x, dim=axis)
def _gelu(x):
    return torch.nn.functional.gelu(x, approximate="tanh")
def _silu(x):
    return torch.nn.functional.silu(x)
def _sigmoid(x):
    return torch.sigmoid(x)
def _layernorm(x, axis=-1, eps=1e-5):
    m = x.mean(dim=axis, keepdim=True)
    v = x.var(dim=axis, keepdim=True, unbiased=False)
    return (x - m) / torch.sqrt(v + eps)
def _scatter_add(tgt, idx, src, axis=0):
    return tgt.clone().index_add_(axis, idx, src)
def _segment_sum(src, seg, n):
    out = torch.zeros((n,) + src.shape[1:], dtype=src.dtype)
    return out.index_add_(0, seg, src)
def _pad(x, pw):
    flat = tuple(v for pair in reversed(pw) for v in pair)
    return torch.nn.functional.pad(x, flat)

kernel_name = 'gated_mix__mha_block__swiglu_ffn__prompt'

def setup_inputs():

    _w = (lambda a: (lambda t: t.to(torch.bfloat16) if t.is_floating_point() else t)(torch.as_tensor(a)))
    def _A_setup():
        B, S, D, H = 1, 2048, 640, 32
        return {
            "x": _w((lambda *s: torch.randn(*s, dtype=torch.bfloat16) * 0.05)(B, S, D)),
            "wqkv": _w((lambda *s: torch.randn(*s, dtype=torch.bfloat16) * 0.8)(D, 3 * D)),
            "wo": _w((lambda *s: torch.randn(*s, dtype=torch.bfloat16) * 0.05)(D, D)),
        }
    _A_in = _A_setup()

    def _B_setup():
        B, S, D, F = 1, 2048, 640, 1536
        return {
            "x": _w((lambda *s: torch.randn(*s, dtype=torch.bfloat16) * 0.05)(B, S, D)),
            "w_gate": _w((lambda *s: torch.randn(*s, dtype=torch.bfloat16) * 0.1)(D, F)),
            "w_up": _w((lambda *s: torch.randn(*s, dtype=torch.bfloat16) * 0.1)(D, F)),
            "w_down": _w((lambda *s: torch.randn(*s, dtype=torch.bfloat16) * 0.1)(F, D)),
        }
    _B_in = _B_setup()

    return {
        "A_x": _A_in["x"],
        "A_wqkv": _A_in["wqkv"],
        "A_wo": _A_in["wo"],
        "B_x": _B_in["x"],
        "B_w_gate": _B_in["w_gate"],
        "B_w_up": _B_in["w_up"],
        "B_w_down": _B_in["w_down"],
        "gate_w": _w((lambda *s: torch.randn(*s, dtype=torch.bfloat16) * 0.05)(640) * 16.0),
    }

def reference(A_x, A_wqkv, A_wo, B_x, B_w_gate, B_w_up, B_w_down, gate_w):
    def _A_ref(x, wqkv, wo):
        B, S, D = x.shape
        H = 32
        Dh = D // H
        qkv = (lambda x, *d: x.permute(*d))((x @ wqkv).reshape(B, S, 3, H, Dh), 2, 0, 3, 1, 4)
        q, k, v = qkv[0], qkv[1], qkv[2]
        scores = torch.einsum("bhqd,bhkd->bhqk", q, k) * (Dh ** -0.5)
        p = _softmax(scores, axis=-1)
        o = torch.einsum("bhqk,bhkd->bhqd", p, v)
        return (lambda x, *d: x.permute(*d))(o, 0, 2, 1, 3).reshape(B, S, D) @ wo

    def _B_ref(x, w_gate, w_up, w_down):
        g = _silu(x @ w_gate)
        u = x @ w_up
        return (g * u) @ w_down

    x = A_x
    g = _sigmoid((x * gate_w).sum(-1, keepdims=True))
    a = _A_ref(x, A_wqkv, A_wo)
    b = _B_ref(x, B_w_gate, B_w_up, B_w_down)
    return g * a + (1 - g) * b
```

```asm
; @launch grid=(512,1,1) block=(256,1,1) lds=81920
.amdgcn_target "amdgcn-amd-amdhsa--gfx950"
.text
.globl gated_mix__mha_block__swiglu_ffn__prompt_kernel
.p2align 8
.type gated_mix__mha_block__swiglu_ffn__prompt_kernel,@function
gated_mix__mha_block__swiglu_ffn__prompt_kernel:
    s_cmp_ge_u32 s2, 512
    s_cbranch_scc1 CODE_END
    s_load_dwordx4 s[4:7], s[0:1], 0
    s_load_dwordx4 s[8:11], s[0:1], 72
    v_lshrrev_b32 v1, 6, v0
    v_and_b32 v2, 63, v0
    s_cmp_ge_u32 s2, 256
    v_readfirstlane_b32 s28, v1
    s_cbranch_scc1 B_role
    s_setprio 1
    s_and_b32 s24, s2, 7
    s_lshr_b32 s25, s2, 3
    s_and_b32 s26, s24, 3
    s_lshl_b32 s26, s26, 2
    s_and_b32 s27, s25, 3
    s_add_u32 s26, s26, s27
    s_lshr_b32 s27, s24, 2
    s_lshl_b32 s27, s27, 3
    s_lshr_b32 s29, s25, 2
    s_add_u32 s27, s27, s29
    s_lshl_b32 s29, s26, 7
    s_lshl_b32 s30, s28, 5
    s_add_u32 s30, s30, s29
    s_cmp_eq_u32 s27, 15
    s_cbranch_scc1 A_gate
    v_lshrrev_b32 v5, 3, v2
    v_and_b32 v6, 7, v2
    v_lshrrev_b32 v7, 1, v5
    v_xor_b32 v6, v6, v7
    v_lshlrev_b32 v6, 4, v6
    v_add_u32 v5, s30, v5
    v_mul_u32_u24 v5, 1280, v5
    v_add_u32 v3, v5, v6
    v_xor_b32 v4, 64, v3
    v_add_u32 v4, 10240, v4
    s_lshl_b32 s31, s28, 12
    s_and_b32 s35, s28, 1
    s_lshr_b32 s36, s28, 1
    v_lshrrev_b32 v5, 2, v2
    s_lshl_b32 s32, s36, 4
    v_add_u32 v5, s32, v5
    v_mul_u32_u24 v5, 3840, v5
    v_and_b32 v6, 3, v2
    v_lshlrev_b32 v6, 4, v6
    s_lshl_b32 s32, s27, 8
    s_lshl_b32 s33, s35, 7
    s_add_u32 s32, s32, s33
    v_add3_u32 v8, v5, v6, s32
    s_lshl_b32 s32, s28, 11
    s_add_u32 s32, s32, 49152
    s_and_b32 s38, s25, 3
    s_mul_i32 s38, s38, 3
    s_lshr_b32 s39, s25, 2
    s_mul_i32 s39, s39, 1
    s_add_u32 s38, s38, s39
    s_mul_i32 s39, s24, 1
    s_add_u32 s38, s38, s39
    s_mul_i32 s39, s38, 6554
    s_lshr_b32 s39, s39, 16
    s_mul_i32 s39, s39, 10
    s_sub_u32 s38, s38, s39
    s_lshl_b32 s37, s38, 1
    s_waitcnt lgkmcnt(0)
    s_mov_b32 s12, s4
    s_mov_b32 s13, s5
    s_mov_b32 s14, 0x280000
    s_mov_b32 s15, 0x00020000
    s_mov_b32 s16, s6
    s_mov_b32 s17, s7
    s_mov_b32 s18, 0x258000
    s_mov_b32 s19, 0x00020000
    s_add_u32 m0, s31, 0
    s_lshl_b32 s33, s38, 7
    buffer_load_dwordx4 v3, s[12:15], s33 offen lds
    s_add_u32 m0, s31, 1024
    s_nop 0
    buffer_load_dwordx4 v4, s[12:15], s33 offen lds
    s_add_u32 m0, s31, 2048
    s_add_u32 s33, s33, 20480
    buffer_load_dwordx4 v3, s[12:15], s33 offen lds
    s_add_u32 m0, s31, 3072
    s_add_u32 s38, s38, 1
    s_cmp_eq_u32 s38, 10
    s_cselect_b32 s38, 0, s38
    buffer_load_dwordx4 v4, s[12:15], s33 offen lds
    s_add_u32 m0, s32, 0
    s_mul_i32 s34, s37, 122880
    buffer_load_dwordx4 v8, s[16:19], s34 offen lds
    s_add_u32 m0, s32, 960
    s_add_u32 s37, s37, 1
    s_cmp_eq_u32 s37, 20
    s_cselect_b32 s37, 0, s37
    buffer_load_dwordx4 v8, s[16:19], s34 offen offset:64 lds
    s_add_u32 m0, s32, 8192
    s_mul_i32 s34, s37, 122880
    buffer_load_dwordx4 v8, s[16:19], s34 offen lds
    s_add_u32 m0, s32, 9152
    s_add_u32 s37, s37, 1
    s_cmp_eq_u32 s37, 20
    s_cselect_b32 s37, 0, s37
    buffer_load_dwordx4 v8, s[16:19], s34 offen offset:64 lds
    s_add_u32 m0, s31, 16384
    s_lshl_b32 s33, s38, 7
    buffer_load_dwordx4 v3, s[12:15], s33 offen lds
    s_add_u32 m0, s31, 17408
    s_nop 0
    buffer_load_dwordx4 v4, s[12:15], s33 offen lds
    s_add_u32 m0, s31, 18432
    s_add_u32 s33, s33, 20480
    buffer_load_dwordx4 v3, s[12:15], s33 offen lds
    s_add_u32 m0, s31, 19456
    s_add_u32 s38, s38, 1
    s_cmp_eq_u32 s38, 10
    s_cselect_b32 s38, 0, s38
    buffer_load_dwordx4 v4, s[12:15], s33 offen lds
    s_add_u32 m0, s32, 16384
    s_mul_i32 s34, s37, 122880
    buffer_load_dwordx4 v8, s[16:19], s34 offen lds
    s_add_u32 m0, s32, 17344
    s_add_u32 s37, s37, 1
    s_cmp_eq_u32 s37, 20
    s_cselect_b32 s37, 0, s37
    buffer_load_dwordx4 v8, s[16:19], s34 offen offset:64 lds
    v_and_b32 v5, 31, v2
    v_lshrrev_b32 v6, 5, v2
    v_lshrrev_b32 v7, 1, v5
    v_and_b32 v7, 7, v7
    v_xor_b32 v7, v7, v6
    v_lshlrev_b32 v7, 4, v7
    s_lshl_b32 s40, s35, 13
    v_lshlrev_b32 v9, 7, v5
    v_add3_u32 v10, v9, v7, s40
    v_xor_b32 v11, 32, v10
    v_xor_b32 v12, 64, v10
    v_xor_b32 v13, 96, v10
    v_bfe_u32 v9, v2, 2, 2
    v_lshlrev_b32 v7, 6, v9
    v_bfe_u32 v9, v2, 4, 1
    v_lshl_add_u32 v7, v9, 5, v7
    v_lshl_add_u32 v7, v6, 9, v7
    s_lshl_b32 s40, s36, 11
    s_add_u32 s40, s40, 49152
    v_add_u32 v14, s40, v7
    s_cmp_ge_u32 s27, 5
    s_cselect_b32 s39, 1, 0
    s_cmp_ge_u32 s27, 10
    s_cselect_b32 s39, 2, s39
    s_mul_i32 s40, s39, 5
    s_sub_u32 s45, s27, s40
    s_lshl_b32 s40, s45, 7
    s_lshl_b32 s41, s36, 6
    s_add_u32 s40, s40, s41
    s_lshr_b32 s41, s26, 1
    s_mul_i32 s41, s41, 20480
    s_and_b32 s42, s26, 1
    s_lshl_b32 s42, s42, 1
    s_add_u32 s42, s42, s35
    s_cmp_eq_u32 s39, 0
    s_cselect_b32 s43, 0x500000, 0x0
    s_mov_b32 s44, 163840
    s_mul_i32 s96, s45, 6554
    s_lshr_b32 s96, s96, 10
    s_lshl_b32 s97, s39, 5
    s_add_u32 s96, s96, s97
    s_add_u32 s96, s96, 136
    s_mov_b32 s97, s45
    v_mov_b32 v144, 0x40000000
    v_mov_b32 v18, 0
    s_add_u32 s3, s2, 256
    s_add_u32 s20, s10, s43
    s_addc_u32 s21, s11, 0
    s_mov_b32 s22, 0x500000
    s_mov_b32 s23, 0x00020000
    s_add_u32 s60, s10, 0x1800000
    s_addc_u32 s61, s11, 0
    s_mov_b32 s62, 0x20000
    s_mov_b32 s63, 0x00020000
    s_cmp_eq_u32 s39, 2
    s_cbranch_scc1 A_vpath
    s_mov_b32 s52, s8
    s_mov_b32 s53, s9
    s_mov_b32 s54, 0x100
    s_mov_b32 s55, 0x00020000
    v_and_b32 v7, 1, v2
    v_lshl_add_u32 v14, v7, 4, v14
    v_bfe_u32 v7, v2, 1, 1
    v_lshl_add_u32 v14, v7, 3, v14
    v_lshlrev_b32 v26, 4, v5
    v_add_u32 v26, s41, v26
    s_lshl_b32 s45, s42, 11
    s_lshl_b32 s46, s42, 9
    s_add_u32 s46, s46, 8192
    s_lshr_b32 s47, s40, 3
    v_add_u32 v27, s47, v6
    s_lshl_b32 s47, s44, 1
    s_mov_b32 s56, s45
    s_mov_b32 s57, s46
    v_add_u32 v28, 0, v27
    v_mul_u32_u24 v29, 13108, v28
    v_lshrrev_b32 v29, 16, v29
    v_mul_u32_u24 v30, 5, v29
    v_sub_u32 v30, v28, v30
    v_mul_lo_u32 v29, v29, s47
    v_add_u32 v29, v29, v26
    v_cmp_lt_u32 vcc, 2, v30
    v_mov_b32 v28, s44
    v_add_u32 v31, 1, v30
    v_cndmask_b32 v28, 0, v28, vcc
    v_cndmask_b32 v31, v30, v31, vcc
    v_and_b32 v31, 1, v31
    v_lshl_add_u32 v28, v31, 9, v28
    v_add3_u32 v28, v28, v29, s56
    v_cmp_eq_u32 s[40:41], 2, v30
    v_add_u32 v29, s57, v29
    s_nop 0
    v_cndmask_b32 v128, v28, v144, s[40:41]
    v_cndmask_b32 v132, v144, v29, s[40:41]
    v_add_u32 v28, 2, v27
    v_mul_u32_u24 v29, 13108, v28
    v_lshrrev_b32 v29, 16, v29
    v_mul_u32_u24 v30, 5, v29
    v_sub_u32 v30, v28, v30
    v_mul_lo_u32 v29, v29, s47
    v_add_u32 v29, v29, v26
    v_cmp_lt_u32 vcc, 2, v30
    v_mov_b32 v28, s44
    v_add_u32 v31, 1, v30
    v_cndmask_b32 v28, 0, v28, vcc
    v_cndmask_b32 v31, v30, v31, vcc
    v_and_b32 v31, 1, v31
    v_lshl_add_u32 v28, v31, 9, v28
    v_add3_u32 v28, v28, v29, s56
    v_cmp_eq_u32 s[42:43], 2, v30
    v_add_u32 v29, s57, v29
    s_nop 0
    v_cndmask_b32 v129, v28, v144, s[42:43]
    v_cndmask_b32 v133, v144, v29, s[42:43]
    v_add_u32 v28, 4, v27
    v_mul_u32_u24 v29, 13108, v28
    v_lshrrev_b32 v29, 16, v29
    v_mul_u32_u24 v30, 5, v29
    v_sub_u32 v30, v28, v30
    v_mul_lo_u32 v29, v29, s47
    v_add_u32 v29, v29, v26
    v_cmp_lt_u32 vcc, 2, v30
    v_mov_b32 v28, s44
    v_add_u32 v31, 1, v30
    v_cndmask_b32 v28, 0, v28, vcc
    v_cndmask_b32 v31, v30, v31, vcc
    v_and_b32 v31, 1, v31
    v_lshl_add_u32 v28, v31, 9, v28
    v_add3_u32 v28, v28, v29, s56
    v_cmp_eq_u32 s[48:49], 2, v30
    v_add_u32 v29, s57, v29
    s_nop 0
    v_cndmask_b32 v130, v28, v144, s[48:49]
    v_cndmask_b32 v134, v144, v29, s[48:49]
    v_add_u32 v28, 6, v27
    v_mul_u32_u24 v29, 13108, v28
    v_lshrrev_b32 v29, 16, v29
    v_mul_u32_u24 v30, 5, v29
    v_sub_u32 v30, v28, v30
    v_mul_lo_u32 v29, v29, s47
    v_add_u32 v29, v29, v26
    v_cmp_lt_u32 vcc, 2, v30
    v_mov_b32 v28, s44
    v_add_u32 v31, 1, v30
    v_cndmask_b32 v28, 0, v28, vcc
    v_cndmask_b32 v31, v30, v31, vcc
    v_and_b32 v31, 1, v31
    v_lshl_add_u32 v28, v31, 9, v28
    v_add3_u32 v28, v28, v29, s56
    v_cmp_eq_u32 s[50:51], 2, v30
    v_add_u32 v29, s57, v29
    s_nop 0
    v_cndmask_b32 v131, v28, v144, s[50:51]
    v_cndmask_b32 v135, v144, v29, s[50:51]
    s_waitcnt vmcnt(8)
    s_barrier
    ds_read_b128 v[32:35], v10 offset:0
    ds_read_b128 v[36:39], v10 offset:4096
    ds_read_b64_tr_b16 v[40:41], v14 offset:0
    ds_read_b64_tr_b16 v[42:43], v14 offset:256
    ds_read_b64_tr_b16 v[44:45], v14 offset:1024
    ds_read_b64_tr_b16 v[46:47], v14 offset:1280
    s_waitcnt lgkmcnt(0)
    ds_read_b128 v[48:51], v11 offset:0
    ds_read_b128 v[52:55], v11 offset:4096
    v_mfma_f32_32x32x16_bf16 v[64:79], v[40:43], v[32:35], 0
    ds_read_b64_tr_b16 v[56:57], v14 offset:4096
    ds_read_b64_tr_b16 v[58:59], v14 offset:4352
    v_mfma_f32_32x32x16_bf16 v[80:95], v[44:47], v[32:35], 0
    ds_read_b64_tr_b16 v[60:61], v14 offset:5120
    ds_read_b64_tr_b16 v[62:63], v14 offset:5376
    v_mfma_f32_32x32x16_bf16 v[96:111], v[40:43], v[36:39], 0
    s_add_u32 m0, s32, 24576
    s_mul_i32 s34, s37, 122880
    buffer_load_dwordx4 v8, s[16:19], s34 offen lds
    s_add_u32 m0, s32, 25536
    s_add_u32 s37, s37, 1
    s_cmp_eq_u32 s37, 20
    s_cselect_b32 s37, 0, s37
    buffer_load_dwordx4 v8, s[16:19], s34 offen offset:64 lds
    v_mfma_f32_32x32x16_bf16 v[112:127], v[44:47], v[36:39], 0
    s_waitcnt vmcnt(8) lgkmcnt(0)
    s_barrier
    ds_read_b128 v[32:35], v12 offset:0
    ds_read_b128 v[36:39], v12 offset:4096
    v_mfma_f32_32x32x16_bf16 v[64:79], v[56:59], v[48:51], v[64:79]
    ds_read_b64_tr_b16 v[40:41], v14 offset:8192
    ds_read_b64_tr_b16 v[42:43], v14 offset:8448
    v_mfma_f32_32x32x16_bf16 v[80:95], v[60:63], v[48:51], v[80:95]
    ds_read_b64_tr_b16 v[44:45], v14 offset:9216
    ds_read_b64_tr_b16 v[46:47], v14 offset:9472
    v_mfma_f32_32x32x16_bf16 v[96:111], v[56:59], v[52:55], v[96:111]
    s_add_u32 m0, s31, 32768
    s_lshl_b32 s33, s38, 7
    buffer_load_dwordx4 v3, s[12:15], s33 offen lds
    s_add_u32 m0, s31, 33792
    s_nop 0
    buffer_load_dwordx4 v4, s[12:15], s33 offen lds
    v_mfma_f32_32x32x16_bf16 v[112:127], v[60:63], v[52:55], v[112:127]
    s_add_u32 m0, s31, 34816
    s_add_u32 s33, s33, 20480
    buffer_load_dwordx4 v3, s[12:15], s33 offen lds
    s_add_u32 m0, s31, 35840
    s_add_u32 s38, s38, 1
    s_cmp_eq_u32 s38, 10
    s_cselect_b32 s38, 0, s38
    buffer_load_dwordx4 v4, s[12:15], s33 offen lds
    s_waitcnt lgkmcnt(0)
    ds_read_b128 v[48:51], v13 offset:0
    ds_read_b128 v[52:55], v13 offset:4096
    v_mfma_f32_32x32x16_bf16 v[64:79], v[40:43], v[32:35], v[64:79]
    ds_read_b64_tr_b16 v[56:57], v14 offset:12288
    ds_read_b64_tr_b16 v[58:59], v14 offset:12544
    v_mfma_f32_32x32x16_bf16 v[80:95], v[44:47], v[32:35], v[80:95]
    ds_read_b64_tr_b16 v[60:61], v14 offset:13312
    ds_read_b64_tr_b16 v[62:63], v14 offset:13568
    v_mfma_f32_32x32x16_bf16 v[96:111], v[40:43], v[36:39], v[96:111]
    s_add_u32 m0, s32, 0
    s_mul_i32 s34, s37, 122880
    buffer_load_dwordx4 v8, s[16:19], s34 offen lds
    s_add_u32 m0, s32, 960
    s_add_u32 s37, s37, 1
    s_cmp_eq_u32 s37, 20
    s_cselect_b32 s37, 0, s37
    buffer_load_dwordx4 v8, s[16:19], s34 offen offset:64 lds
    v_mfma_f32_32x32x16_bf16 v[112:127], v[44:47], v[36:39], v[112:127]
    s_waitcnt vmcnt(8) lgkmcnt(0)
    s_barrier
    ds_read_b128 v[32:35], v10 offset:16384
    ds_read_b128 v[36:39], v10 offset:20480
    v_mfma_f32_32x32x16_bf16 v[64:79], v[56:59], v[48:51], v[64:79]
    ds_read_b64_tr_b16 v[40:41], v14 offset:16384
    ds_read_b64_tr_b16 v[42:43], v14 offset:16640
    v_mfma_f32_32x32x16_bf16 v[80:95], v[60:63], v[48:51], v[80:95]
    ds_read_b64_tr_b16 v[44:45], v14 offset:17408
    ds_read_b64_tr_b16 v[46:47], v14 offset:17664
    v_mfma_f32_32x32x16_bf16 v[96:111], v[56:59], v[52:55], v[96:111]
    s_add_u32 m0, s32, 8192
    s_mul_i32 s34, s37, 122880
    buffer_load_dwordx4 v8, s[16:19], s34 offen lds
    s_add_u32 m0, s32, 9152
    s_add_u32 s37, s37, 1
    s_cmp_eq_u32 s37, 20
    s_cselect_b32 s37, 0, s37
    buffer_load_dwordx4 v8, s[16:19], s34 offen offset:64 lds
    v_mfma_f32_32x32x16_bf16 v[112:127], v[60:63], v[52:55], v[112:127]
    s_add_u32 m0, s31, 0
    s_lshl_b32 s33, s38, 7
    buffer_load_dwordx4 v3, s[12:15], s33 offen lds
    s_add_u32 m0, s31, 1024
    s_nop 0
    buffer_load_dwordx4 v4, s[12:15], s33 offen lds
    s_waitcnt lgkmcnt(0)
    ds_read_b128 v[48:51], v11 offset:16384
    ds_read_b128 v[52:55], v11 offset:20480
    v_mfma_f32_32x32x16_bf16 v[64:79], v[40:43], v[32:35], v[64:79]
    ds_read_b64_tr_b16 v[56:57], v14 offset:20480
    ds_read_b64_tr_b16 v[58:59], v14 offset:20736
    v_mfma_f32_32x32x16_bf16 v[80:95], v[44:47], v[32:35], v[80:95]
    ds_read_b64_tr_b16 v[60:61], v14 offset:21504
    ds_read_b64_tr_b16 v[62:63], v14 offset:21760
    v_mfma_f32_32x32x16_bf16 v[96:111], v[40:43], v[36:39], v[96:111]
    s_add_u32 m0, s31, 2048
    s_add_u32 s33, s33, 20480
    buffer_load_dwordx4 v3, s[12:15], s33 offen lds
    s_add_u32 m0, s31, 3072
    s_add_u32 s38, s38, 1
    s_cmp_eq_u32 s38, 10
    s_cselect_b32 s38, 0, s38
    buffer_load_dwordx4 v4, s[12:15], s33 offen lds
    v_mfma_f32_32x32x16_bf16 v[112:127], v[44:47], v[36:39], v[112:127]
    s_waitcnt vmcnt(12) lgkmcnt(0)
    s_barrier
    ds_read_b128 v[32:35], v12 offset:16384
    ds_read_b128 v[36:39], v12 offset:20480
    v_mfma_f32_32x32x16_bf16 v[64:79], v[56:59], v[48:51], v[64:79]
    ds_read_b64_tr_b16 v[40:41], v14 offset:24576
    ds_read_b64_tr_b16 v[42:43], v14 offset:24832
    v_mfma_f32_32x32x16_bf16 v[80:95], v[60:63], v[48:51], v[80:95]
    ds_read_b64_tr_b16 v[44:45], v14 offset:25600
    ds_read_b64_tr_b16 v[46:47], v14 offset:25856
    v_mfma_f32_32x32x16_bf16 v[96:111], v[56:59], v[52:55], v[96:111]
    s_add_u32 m0, s32, 16384
    s_mul_i32 s34, s37, 122880
    buffer_load_dwordx4 v8, s[16:19], s34 offen lds
    s_add_u32 m0, s32, 17344
    s_add_u32 s37, s37, 1
    s_cmp_eq_u32 s37, 20
    s_cselect_b32 s37, 0, s37
    buffer_load_dwordx4 v8, s[16:19], s34 offen offset:64 lds
    v_mfma_f32_32x32x16_bf16 v[112:127], v[60:63], v[52:55], v[112:127]
    s_waitcnt lgkmcnt(0)
    ds_read_b128 v[48:51], v13 offset:16384
    ds_read_b128 v[52:55], v13 offset:20480
    v_mfma_f32_32x32x16_bf16 v[64:79], v[40:43], v[32:35], v[64:79]
    ds_read_b64_tr_b16 v[56:57], v14 offset:28672
    ds_read_b64_tr_b16 v[58:59], v14 offset:28928
    v_mfma_f32_32x32x16_bf16 v[80:95], v[44:47], v[32:35], v[80:95]
    ds_read_b64_tr_b16 v[60:61], v14 offset:29696
    ds_read_b64_tr_b16 v[62:63], v14 offset:29952
    v_mfma_f32_32x32x16_bf16 v[96:111], v[40:43], v[36:39], v[96:111]
    v_mfma_f32_32x32x16_bf16 v[112:127], v[44:47], v[36:39], v[112:127]
    s_waitcnt vmcnt(8) lgkmcnt(0)
    s_barrier
    ds_read_b128 v[32:35], v10 offset:32768
    ds_read_b128 v[36:39], v10 offset:36864
    v_mfma_f32_32x32x16_bf16 v[64:79], v[56:59], v[48:51], v[64:79]
    ds_read_b64_tr_b16 v[40:41], v14 offset:0
    ds_read_b64_tr_b16 v[42:43], v14 offset:256
    v_mfma_f32_32x32x16_bf16 v[80:95], v[60:63], v[48:51], v[80:95]
    ds_read_b64_tr_b16 v[44:45], v14 offset:1024
    ds_read_b64_tr_b16 v[46:47], v14 offset:1280
    v_mfma_f32_32x32x16_bf16 v[96:111], v[56:59], v[52:55], v[96:111]
    s_add_u32 m0, s32, 24576
    s_mul_i32 s34, s37, 122880
    buffer_load_dwordx4 v8, s[16:19], s34 offen lds
    s_add_u32 m0, s32, 25536
    s_add_u32 s37, s37, 1
    s_cmp_eq_u32 s37, 20
    s_cselect_b32 s37, 0, s37
    buffer_load_dwordx4 v8, s[16:19], s34 offen offset:64 lds
    v_mfma_f32_32x32x16_bf16 v[112:127], v[60:63], v[52:55], v[112:127]
    s_add_u32 m0, s31, 16384
    s_lshl_b32 s33, s38, 7
    buffer_load_dwordx4 v3, s[12:15], s33 offen lds
    s_add_u32 m0, s31, 17408
    s_nop 0
    buffer_load_dwordx4 v4, s[12:15], s33 offen lds
    s_waitcnt lgkmcnt(0)
    ds_read_b128 v[48:51], v11 offset:32768
    ds_read_b128 v[52:55], v11 offset:36864
    v_mfma_f32_32x32x16_bf16 v[64:79], v[40:43], v[32:35], v[64:79]
    ds_read_b64_tr_b16 v[56:57], v14 offset:4096
    ds_read_b64_tr_b16 v[58:59], v14 offset:4352
    v_mfma_f32_32x32x16_bf16 v[80:95], v[44:47], v[32:35], v[80:95]
    ds_read_b64_tr_b16 v[60:61], v14 offset:5120
    ds_read_b64_tr_b16 v[62:63], v14 offset:5376
    v_mfma_f32_32x32x16_bf16 v[96:111], v[40:43], v[36:39], v[96:111]
    s_add_u32 m0, s31, 18432
    s_add_u32 s33, s33, 20480
    buffer_load_dwordx4 v3, s[12:15], s33 offen lds
    s_add_u32 m0, s31, 19456
    s_add_u32 s38, s38, 1
    s_cmp_eq_u32 s38, 10
    s_cselect_b32 s38, 0, s38
    buffer_load_dwordx4 v4, s[12:15], s33 offen lds
    v_mfma_f32_32x32x16_bf16 v[112:127], v[44:47], v[36:39], v[112:127]
    s_waitcnt vmcnt(12) lgkmcnt(0)
    s_barrier
    ds_read_b128 v[32:35], v12 offset:32768
    ds_read_b128 v[36:39], v12 offset:36864
    v_mfma_f32_32x32x16_bf16 v[64:79], v[56:59], v[48:51], v[64:79]
    ds_read_b64_tr_b16 v[40:41], v14 offset:8192
    ds_read_b64_tr_b16 v[42:43], v14 offset:8448
    v_mfma_f32_32x32x16_bf16 v[80:95], v[60:63], v[48:51], v[80:95]
    ds_read_b64_tr_b16 v[44:45], v14 offset:9216
    ds_read_b64_tr_b16 v[46:47], v14 offset:9472
    v_mfma_f32_32x32x16_bf16 v[96:111], v[56:59], v[52:55], v[96:111]
    s_add_u32 m0, s32, 0
    s_mul_i32 s34, s37, 122880
    buffer_load_dwordx4 v8, s[16:19], s34 offen lds
    s_add_u32 m0, s32, 960
    s_add_u32 s37, s37, 1
    s_cmp_eq_u32 s37, 20
    s_cselect_b32 s37, 0, s37
    buffer_load_dwordx4 v8, s[16:19], s34 offen offset:64 lds
    v_mfma_f32_32x32x16_bf16 v[112:127], v[60:63], v[52:55], v[112:127]
    s_waitcnt lgkmcnt(0)
    ds_read_b128 v[48:51], v13 offset:32768
    ds_read_b128 v[52:55], v13 offset:36864
    v_mfma_f32_32x32x16_bf16 v[64:79], v[40:43], v[32:35], v[64:79]
    ds_read_b64_tr_b16 v[56:57], v14 offset:12288
    ds_read_b64_tr_b16 v[58:59], v14 offset:12544
    v_mfma_f32_32x32x16_bf16 v[80:95], v[44:47], v[32:35], v[80:95]
    ds_read_b64_tr_b16 v[60:61], v14 offset:13312
    ds_read_b64_tr_b16 v[62:63], v14 offset:13568
    v_mfma_f32_32x32x16_bf16 v[96:111], v[40:43], v[36:39], v[96:111]
    v_mfma_f32_32x32x16_bf16 v[112:127], v[44:47], v[36:39], v[112:127]
    s_waitcnt vmcnt(8) lgkmcnt(0)
    s_barrier
    ds_read_b128 v[32:35], v10 offset:0
    ds_read_b128 v[36:39], v10 offset:4096
    v_mfma_f32_32x32x16_bf16 v[64:79], v[56:59], v[48:51], v[64:79]
    ds_read_b64_tr_b16 v[40:41], v14 offset:16384
    ds_read_b64_tr_b16 v[42:43], v14 offset:16640
    v_mfma_f32_32x32x16_bf16 v[80:95], v[60:63], v[48:51], v[80:95]
    ds_read_b64_tr_b16 v[44:45], v14 offset:17408
    ds_read_b64_tr_b16 v[46:47], v14 offset:17664
    v_mfma_f32_32x32x16_bf16 v[96:111], v[56:59], v[52:55], v[96:111]
    s_add_u32 m0, s32, 8192
    s_mul_i32 s34, s37, 122880
    buffer_load_dwordx4 v8, s[16:19], s34 offen lds
    s_add_u32 m0, s32, 9152
    s_add_u32 s37, s37, 1
    s_cmp_eq_u32 s37, 20
    s_cselect_b32 s37, 0, s37
    buffer_load_dwordx4 v8, s[16:19], s34 offen offset:64 lds
    v_mfma_f32_32x32x16_bf16 v[112:127], v[60:63], v[52:55], v[112:127]
    s_add_u32 m0, s31, 32768
    s_lshl_b32 s33, s38, 7
    buffer_load_dwordx4 v3, s[12:15], s33 offen lds
    s_add_u32 m0, s31, 33792
    s_nop 0
    buffer_load_dwordx4 v4, s[12:15], s33 offen lds
    s_waitcnt lgkmcnt(0)
    ds_read_b128 v[48:51], v11 offset:0
    ds_read_b128 v[52:55], v11 offset:4096
    v_mfma_f32_32x32x16_bf16 v[64:79], v[40:43], v[32:35], v[64:79]
    ds_read_b64_tr_b16 v[56:57], v14 offset:20480
    ds_read_b64_tr_b16 v[58:59], v14 offset:20736
    v_mfma_f32_32x32x16_bf16 v[80:95], v[44:47], v[32:35], v[80:95]
    ds_read_b64_tr_b16 v[60:61], v14 offset:21504
    ds_read_b64_tr_b16 v[62:63], v14 offset:21760
    v_mfma_f32_32x32x16_bf16 v[96:111], v[40:43], v[36:39], v[96:111]
    s_add_u32 m0, s31, 34816
    s_add_u32 s33, s33, 20480
    buffer_load_dwordx4 v3, s[12:15], s33 offen lds
    s_add_u32 m0, s31, 35840
    s_add_u32 s38, s38, 1
    s_cmp_eq_u32 s38, 10
    s_cselect_b32 s38, 0, s38
    buffer_load_dwordx4 v4, s[12:15], s33 offen lds
    v_mfma_f32_32x32x16_bf16 v[112:127], v[44:47], v[36:39], v[112:127]
    s_waitcnt vmcnt(12) lgkmcnt(0)
    s_barrier
    ds_read_b128 v[32:35], v12 offset:0
    ds_read_b128 v[36:39], v12 offset:4096
    v_mfma_f32_32x32x16_bf16 v[64:79], v[56:59], v[48:51], v[64:79]
    ds_read_b64_tr_b16 v[40:41], v14 offset:24576
    ds_read_b64_tr_b16 v[42:43], v14 offset:24832
    v_mfma_f32_32x32x16_bf16 v[80:95], v[60:63], v[48:51], v[80:95]
    ds_read_b64_tr_b16 v[44:45], v14 offset:25600
    ds_read_b64_tr_b16 v[46:47], v14 offset:25856
    v_mfma_f32_32x32x16_bf16 v[96:111], v[56:59], v[52:55], v[96:111]
    s_add_u32 m0, s32, 16384
    s_mul_i32 s34, s37, 122880
    buffer_load_dwordx4 v8, s[16:19], s34 offen lds
    s_add_u32 m0, s32, 17344
    s_add_u32 s37, s37, 1
    s_cmp_eq_u32 s37, 20
    s_cselect_b32 s37, 0, s37
    buffer_load_dwordx4 v8, s[16:19], s34 offen offset:64 lds
    v_mfma_f32_32x32x16_bf16 v[112:127], v[60:63], v[52:55], v[112:127]
    s_waitcnt lgkmcnt(0)
    ds_read_b128 v[48:51], v13 offset:0
    ds_read_b128 v[52:55], v13 offset:4096
    v_mfma_f32_32x32x16_bf16 v[64:79], v[40:43], v[32:35], v[64:79]
    ds_read_b64_tr_b16 v[56:57], v14 offset:28672
    ds_read_b64_tr_b16 v[58:59], v14 offset:28928
    v_mfma_f32_32x32x16_bf16 v[80:95], v[44:47], v[32:35], v[80:95]
    ds_read_b64_tr_b16 v[60:61], v14 offset:29696
    ds_read_b64_tr_b16 v[62:63], v14 offset:29952
    v_mfma_f32_32x32x16_bf16 v[96:111], v[40:43], v[36:39], v[96:111]
    v_mfma_f32_32x32x16_bf16 v[112:127], v[44:47], v[36:39], v[112:127]
    s_waitcnt vmcnt(8) lgkmcnt(0)
    s_barrier
    ds_read_b128 v[32:35], v10 offset:16384
    ds_read_b128 v[36:39], v10 offset:20480
    v_mfma_f32_32x32x16_bf16 v[64:79], v[56:59], v[48:51], v[64:79]
    ds_read_b64_tr_b16 v[40:41], v14 offset:0
    ds_read_b64_tr_b16 v[42:43], v14 offset:256
    v_mfma_f32_32x32x16_bf16 v[80:95], v[60:63], v[48:51], v[80:95]
    ds_read_b64_tr_b16 v[44:45], v14 offset:1024
    ds_read_b64_tr_b16 v[46:47], v14 offset:1280
    v_mfma_f32_32x32x16_bf16 v[96:111], v[56:59], v[52:55], v[96:111]
    s_add_u32 m0, s32, 24576
    s_mul_i32 s34, s37, 122880
    buffer_load_dwordx4 v8, s[16:19], s34 offen lds
    s_add_u32 m0, s32, 25536
    s_add_u32 s37, s37, 1
    s_cmp_eq_u32 s37, 20
    s_cselect_b32 s37, 0, s37
    buffer_load_dwordx4 v8, s[16:19], s34 offen offset:64 lds
    v_mfma_f32_32x32x16_bf16 v[112:127], v[60:63], v[52:55], v[112:127]
    s_add_u32 m0, s31, 0
    s_lshl_b32 s33, s38, 7
    buffer_load_dwordx4 v3, s[12:15], s33 offen lds
    s_add_u32 m0, s31, 1024
    s_nop 0
    buffer_load_dwordx4 v4, s[12:15], s33 offen lds
    s_waitcnt lgkmcnt(0)
    ds_read_b128 v[48:51], v11 offset:16384
    ds_read_b128 v[52:55], v11 offset:20480
    v_mfma_f32_32x32x16_bf16 v[64:79], v[40:43], v[32:35], v[64:79]
    ds_read_b64_tr_b16 v[56:57], v14 offset:4096
    ds_read_b64_tr_b16 v[58:59], v14 offset:4352
    v_mfma_f32_32x32x16_bf16 v[80:95], v[44:47], v[32:35], v[80:95]
    ds_read_b64_tr_b16 v[60:61], v14 offset:5120
    ds_read_b64_tr_b16 v[62:63], v14 offset:5376
    v_mfma_f32_32x32x16_bf16 v[96:111], v[40:43], v[36:39], v[96:111]
    s_add_u32 m0, s31, 2048
    s_add_u32 s33, s33, 20480
    buffer_load_dwordx4 v3, s[12:15], s33 offen lds
    s_add_u32 m0, s31, 3072
    s_add_u32 s38, s38, 1
    s_cmp_eq_u32 s38, 10
    s_cselect_b32 s38, 0, s38
    buffer_load_dwordx4 v4, s[12:15], s33 offen lds
    v_mfma_f32_32x32x16_bf16 v[112:127], v[44:47], v[36:39], v[112:127]
    s_waitcnt vmcnt(12) lgkmcnt(0)
    s_barrier
    ds_read_b128 v[32:35], v12 offset:16384
    ds_read_b128 v[36:39], v12 offset:20480
    v_mfma_f32_32x32x16_bf16 v[64:79], v[56:59], v[48:51], v[64:79]
    ds_read_b64_tr_b16 v[40:41], v14 offset:8192
    ds_read_b64_tr_b16 v[42:43], v14 offset:8448
    v_mfma_f32_32x32x16_bf16 v[80:95], v[60:63], v[48:51], v[80:95]
    ds_read_b64_tr_b16 v[44:45], v14 offset:9216
    ds_read_b64_tr_b16 v[46:47], v14 offset:9472
    v_mfma_f32_32x32x16_bf16 v[96:111], v[56:59], v[52:55], v[96:111]
    s_add_u32 m0, s32, 0
    s_mul_i32 s34, s37, 122880
    buffer_load_dwordx4 v8, s[16:19], s34 offen lds
    s_add_u32 m0, s32, 960
    s_add_u32 s37, s37, 1
    s_cmp_eq_u32 s37, 20
    s_cselect_b32 s37, 0, s37
    buffer_load_dwordx4 v8, s[16:19], s34 offen offset:64 lds
    v_mfma_f32_32x32x16_bf16 v[112:127], v[60:63], v[52:55], v[112:127]
    s_waitcnt lgkmcnt(0)
    ds_read_b128 v[48:51], v13 offset:16384
    ds_read_b128 v[52:55], v13 offset:20480
    v_mfma_f32_32x32x16_bf16 v[64:79], v[40:43], v[32:35], v[64:79]
    ds_read_b64_tr_b16 v[56:57], v14 offset:12288
    ds_read_b64_tr_b16 v[58:59], v14 offset:12544
    v_mfma_f32_32x32x16_bf16 v[80:95], v[44:47], v[32:35], v[80:95]
    ds_read_b64_tr_b16 v[60:61], v14 offset:13312
    ds_read_b64_tr_b16 v[62:63], v14 offset:13568
    v_mfma_f32_32x32x16_bf16 v[96:111], v[40:43], v[36:39], v[96:111]
    v_mfma_f32_32x32x16_bf16 v[112:127], v[44:47], v[36:39], v[112:127]
    s_waitcnt vmcnt(8) lgkmcnt(0)
    s_barrier
    ds_read_b128 v[32:35], v10 offset:32768
    ds_read_b128 v[36:39], v10 offset:36864
    v_mfma_f32_32x32x16_bf16 v[64:79], v[56:59], v[48:51], v[64:79]
    ds_read_b64_tr_b16 v[40:41], v14 offset:16384
    ds_read_b64_tr_b16 v[42:43], v14 offset:16640
    v_mfma_f32_32x32x16_bf16 v[80:95], v[60:63], v[48:51], v[80:95]
    ds_read_b64_tr_b16 v[44:45], v14 offset:17408
    ds_read_b64_tr_b16 v[46:47], v14 offset:17664
    v_mfma_f32_32x32x16_bf16 v[96:111], v[56:59], v[52:55], v[96:111]
    s_add_u32 m0, s32, 8192
    s_mul_i32 s34, s37, 122880
    buffer_load_dwordx4 v8, s[16:19], s34 offen lds
    s_add_u32 m0, s32, 9152
    s_add_u32 s37, s37, 1
    s_cmp_eq_u32 s37, 20
    s_cselect_b32 s37, 0, s37
    buffer_load_dwordx4 v8, s[16:19], s34 offen offset:64 lds
    v_mfma_f32_32x32x16_bf16 v[112:127], v[60:63], v[52:55], v[112:127]
    s_add_u32 m0, s31, 16384
    s_lshl_b32 s33, s38, 7
    buffer_load_dwordx4 v3, s[12:15], s33 offen lds
    s_add_u32 m0, s31, 17408
    s_nop 0
    buffer_load_dwordx4 v4, s[12:15], s33 offen lds
    s_waitcnt lgkmcnt(0)
    ds_read_b128 v[48:51], v11 offset:32768
    ds_read_b128 v[52:55], v11 offset:36864
    v_mfma_f32_32x32x16_bf16 v[64:79], v[40:43], v[32:35], v[64:79]
    ds_read_b64_tr_b16 v[56:57], v14 offset:20480
    ds_read_b64_tr_b16 v[58:59], v14 offset:20736
    v_mfma_f32_32x32x16_bf16 v[80:95], v[44:47], v[32:35], v[80:95]
    ds_read_b64_tr_b16 v[60:61], v14 offset:21504
    ds_read_b64_tr_b16 v[62:63], v14 offset:21760
    v_mfma_f32_32x32x16_bf16 v[96:111], v[40:43], v[36:39], v[96:111]
    s_add_u32 m0, s31, 18432
    s_add_u32 s33, s33, 20480
    buffer_load_dwordx4 v3, s[12:15], s33 offen lds
    s_add_u32 m0, s31, 19456
    s_add_u32 s38, s38, 1
    s_cmp_eq_u32 s38, 10
    s_cselect_b32 s38, 0, s38
    buffer_load_dwordx4 v4, s[12:15], s33 offen lds
    v_mfma_f32_32x32x16_bf16 v[112:127], v[44:47], v[36:39], v[112:127]
    s_waitcnt vmcnt(12) lgkmcnt(0)
    s_barrier
    ds_read_b128 v[32:35], v12 offset:32768
    ds_read_b128 v[36:39], v12 offset:36864
    v_mfma_f32_32x32x16_bf16 v[64:79], v[56:59], v[48:51], v[64:79]
    ds_read_b64_tr_b16 v[40:41], v14 offset:24576
    ds_read_b64_tr_b16 v[42:43], v14 offset:24832
    v_mfma_f32_32x32x16_bf16 v[80:95], v[60:63], v[48:51], v[80:95]
    ds_read_b64_tr_b16 v[44:45], v14 offset:25600
    ds_read_b64_tr_b16 v[46:47], v14 offset:25856
    v_mfma_f32_32x32x16_bf16 v[96:111], v[56:59], v[52:55], v[96:111]
    s_add_u32 m0, s32, 16384
    s_mul_i32 s34, s37, 122880
    buffer_load_dwordx4 v8, s[16:19], s34 offen lds
    s_add_u32 m0, s32, 17344
    s_add_u32 s37, s37, 1
    s_cmp_eq_u32 s37, 20
    s_cselect_b32 s37, 0, s37
    buffer_load_dwordx4 v8, s[16:19], s34 offen offset:64 lds
    v_mfma_f32_32x32x16_bf16 v[112:127], v[60:63], v[52:55], v[112:127]
    s_waitcnt lgkmcnt(0)
    ds_read_b128 v[48:51], v13 offset:32768
    ds_read_b128 v[52:55], v13 offset:36864
    v_mfma_f32_32x32x16_bf16 v[64:79], v[40:43], v[32:35], v[64:79]
    ds_read_b64_tr_b16 v[56:57], v14 offset:28672
    ds_read_b64_tr_b16 v[58:59], v14 offset:28928
    v_mfma_f32_32x32x16_bf16 v[80:95], v[44:47], v[32:35], v[80:95]
    ds_read_b64_tr_b16 v[60:61], v14 offset:29696
    ds_read_b64_tr_b16 v[62:63], v14 offset:29952
    v_mfma_f32_32x32x16_bf16 v[96:111], v[40:43], v[36:39], v[96:111]
    v_mfma_f32_32x32x16_bf16 v[112:127], v[44:47], v[36:39], v[112:127]
    s_waitcnt vmcnt(8) lgkmcnt(0)
    s_barrier
    ds_read_b128 v[32:35], v10 offset:0
    ds_read_b128 v[36:39], v10 offset:4096
    v_mfma_f32_32x32x16_bf16 v[64:79], v[56:59], v[48:51], v[64:79]
    ds_read_b64_tr_b16 v[40:41], v14 offset:0
    ds_read_b64_tr_b16 v[42:43], v14 offset:256
    v_mfma_f32_32x32x16_bf16 v[80:95], v[60:63], v[48:51], v[80:95]
    ds_read_b64_tr_b16 v[44:45], v14 offset:1024
    ds_read_b64_tr_b16 v[46:47], v14 offset:1280
    v_mfma_f32_32x32x16_bf16 v[96:111], v[56:59], v[52:55], v[96:111]
    s_add_u32 m0, s32, 24576
    s_mul_i32 s34, s37, 122880
    buffer_load_dwordx4 v8, s[16:19], s34 offen lds
    s_add_u32 m0, s32, 25536
    s_add_u32 s37, s37, 1
    s_cmp_eq_u32 s37, 20
    s_cselect_b32 s37, 0, s37
    buffer_load_dwordx4 v8, s[16:19], s34 offen offset:64 lds
    v_mfma_f32_32x32x16_bf16 v[112:127], v[60:63], v[52:55], v[112:127]
    s_add_u32 m0, s31, 32768
    s_lshl_b32 s33, s38, 7
    buffer_load_dwordx4 v3, s[12:15], s33 offen lds
    s_add_u32 m0, s31, 33792
    s_nop 0
    buffer_load_dwordx4 v4, s[12:15], s33 offen lds
    s_waitcnt lgkmcnt(0)
    ds_read_b128 v[48:51], v11 offset:0
    ds_read_b128 v[52:55], v11 offset:4096
    v_mfma_f32_32x32x16_bf16 v[64:79], v[40:43], v[32:35], v[64:79]
    ds_read_b64_tr_b16 v[56:57], v14 offset:4096
    ds_read_b64_tr_b16 v[58:59], v14 offset:4352
    v_mfma_f32_32x32x16_bf16 v[80:95], v[44:47], v[32:35], v[80:95]
    ds_read_b64_tr_b16 v[60:61], v14 offset:5120
    ds_read_b64_tr_b16 v[62:63], v14 offset:5376
    v_mfma_f32_32x32x16_bf16 v[96:111], v[40:43], v[36:39], v[96:111]
    s_add_u32 m0, s31, 34816
    s_add_u32 s33, s33, 20480
    buffer_load_dwordx4 v3, s[12:15], s33 offen lds
    s_add_u32 m0, s31, 35840
    s_add_u32 s38, s38, 1
    s_cmp_eq_u32 s38, 10
    s_cselect_b32 s38, 0, s38
    buffer_load_dwordx4 v4, s[12:15], s33 offen lds
    v_mfma_f32_32x32x16_bf16 v[112:127], v[44:47], v[36:39], v[112:127]
    s_waitcnt vmcnt(12) lgkmcnt(0)
    s_barrier
    ds_read_b128 v[32:35], v12 offset:0
    ds_read_b128 v[36:39], v12 offset:4096
    v_mfma_f32_32x32x16_bf16 v[64:79], v[56:59], v[48:51], v[64:79]
    ds_read_b64_tr_b16 v[40:41], v14 offset:8192
    ds_read_b64_tr_b16 v[42:43], v14 offset:8448
    v_mfma_f32_32x32x16_bf16 v[80:95], v[60:63], v[48:51], v[80:95]
    ds_read_b64_tr_b16 v[44:45], v14 offset:9216
    ds_read_b64_tr_b16 v[46:47], v14 offset:9472
    v_mfma_f32_32x32x16_bf16 v[96:111], v[56:59], v[52:55], v[96:111]
    s_add_u32 m0, s32, 0
    s_mul_i32 s34, s37, 122880
    buffer_load_dwordx4 v8, s[16:19], s34 offen lds
    s_add_u32 m0, s32, 960
    s_add_u32 s37, s37, 1
    s_cmp_eq_u32 s37, 20
    s_cselect_b32 s37, 0, s37
    buffer_load_dwordx4 v8, s[16:19], s34 offen offset:64 lds
    v_mfma_f32_32x32x16_bf16 v[112:127], v[60:63], v[52:55], v[112:127]
    s_waitcnt lgkmcnt(0)
    ds_read_b128 v[48:51], v13 offset:0
    ds_read_b128 v[52:55], v13 offset:4096
    v_mfma_f32_32x32x16_bf16 v[64:79], v[40:43], v[32:35], v[64:79]
    ds_read_b64_tr_b16 v[56:57], v14 offset:12288
    ds_read_b64_tr_b16 v[58:59], v14 offset:12544
    v_mfma_f32_32x32x16_bf16 v[80:95], v[44:47], v[32:35], v[80:95]
    ds_read_b64_tr_b16 v[60:61], v14 offset:13312
    ds_read_b64_tr_b16 v[62:63], v14 offset:13568
    v_mfma_f32_32x32x16_bf16 v[96:111], v[40:43], v[36:39], v[96:111]
    v_mfma_f32_32x32x16_bf16 v[112:127], v[44:47], v[36:39], v[112:127]
    s_waitcnt vmcnt(8) lgkmcnt(0)
    s_barrier
    ds_read_b128 v[32:35], v10 offset:16384
    ds_read_b128 v[36:39], v10 offset:20480
    v_mfma_f32_32x32x16_bf16 v[64:79], v[56:59], v[48:51], v[64:79]
    ds_read_b64_tr_b16 v[40:41], v14 offset:16384
    ds_read_b64_tr_b16 v[42:43], v14 offset:16640
    v_mfma_f32_32x32x16_bf16 v[80:95], v[60:63], v[48:51], v[80:95]
    ds_read_b64_tr_b16 v[44:45], v14 offset:17408
    ds_read_b64_tr_b16 v[46:47], v14 offset:17664
    v_mfma_f32_32x32x16_bf16 v[96:111], v[56:59], v[52:55], v[96:111]
    s_add_u32 m0, s32, 8192
    s_mul_i32 s34, s37, 122880
    buffer_load_dwordx4 v8, s[16:19], s34 offen lds
    s_add_u32 m0, s32, 9152
    s_add_u32 s37, s37, 1
    s_cmp_eq_u32 s37, 20
    s_cselect_b32 s37, 0, s37
    buffer_load_dwordx4 v8, s[16:19], s34 offen offset:64 lds
    v_mfma_f32_32x32x16_bf16 v[112:127], v[60:63], v[52:55], v[112:127]
    s_add_u32 m0, s31, 0
    s_lshl_b32 s33, s38, 7
    buffer_load_dwordx4 v3, s[12:15], s33 offen lds
    s_add_u32 m0, s31, 1024
    s_nop 0
    buffer_load_dwordx4 v4, s[12:15], s33 offen lds
    s_waitcnt lgkmcnt(0)
    ds_read_b128 v[48:51], v11 offset:16384
    ds_read_b128 v[52:55], v11 offset:20480
    v_mfma_f32_32x32x16_bf16 v[64:79], v[40:43], v[32:35], v[64:79]
    ds_read_b64_tr_b16 v[56:57], v14 offset:20480
    ds_read_b64_tr_b16 v[58:59], v14 offset:20736
    v_mfma_f32_32x32x16_bf16 v[80:95], v[44:47], v[32:35], v[80:95]
    ds_read_b64_tr_b16 v[60:61], v14 offset:21504
    ds_read_b64_tr_b16 v[62:63], v14 offset:21760
    v_mfma_f32_32x32x16_bf16 v[96:111], v[40:43], v[36:39], v[96:111]
    s_add_u32 m0, s31, 2048
    s_add_u32 s33, s33, 20480
    buffer_load_dwordx4 v3, s[12:15], s33 offen lds
    s_add_u32 m0, s31, 3072
    s_add_u32 s38, s38, 1
    s_cmp_eq_u32 s38, 10
    s_cselect_b32 s38, 0, s38
    buffer_load_dwordx4 v4, s[12:15], s33 offen lds
    v_mfma_f32_32x32x16_bf16 v[112:127], v[44:47], v[36:39], v[112:127]
    s_waitcnt vmcnt(12) lgkmcnt(0)
    s_barrier
    ds_read_b128 v[32:35], v12 offset:16384
    ds_read_b128 v[36:39], v12 offset:20480
    v_mfma_f32_32x32x16_bf16 v[64:79], v[56:59], v[48:51], v[64:79]
    ds_read_b64_tr_b16 v[40:41], v14 offset:24576
    ds_read_b64_tr_b16 v[42:43], v14 offset:24832
    v_mfma_f32_32x32x16_bf16 v[80:95], v[60:63], v[48:51], v[80:95]
    ds_read_b64_tr_b16 v[44:45], v14 offset:25600
    ds_read_b64_tr_b16 v[46:47], v14 offset:25856
    v_mfma_f32_32x32x16_bf16 v[96:111], v[56:59], v[52:55], v[96:111]
    s_add_u32 m0, s32, 16384
    s_mul_i32 s34, s37, 122880
    buffer_load_dwordx4 v8, s[16:19], s34 offen lds
    s_add_u32 m0, s32, 17344
    s_add_u32 s37, s37, 1
    s_cmp_eq_u32 s37, 20
    s_cselect_b32 s37, 0, s37
    buffer_load_dwordx4 v8, s[16:19], s34 offen offset:64 lds
    v_mfma_f32_32x32x16_bf16 v[112:127], v[60:63], v[52:55], v[112:127]
    s_waitcnt lgkmcnt(0)
    ds_read_b128 v[48:51], v13 offset:16384
    ds_read_b128 v[52:55], v13 offset:20480
    v_mfma_f32_32x32x16_bf16 v[64:79], v[40:43], v[32:35], v[64:79]
    ds_read_b64_tr_b16 v[56:57], v14 offset:28672
    ds_read_b64_tr_b16 v[58:59], v14 offset:28928
    v_mfma_f32_32x32x16_bf16 v[80:95], v[44:47], v[32:35], v[80:95]
    ds_read_b64_tr_b16 v[60:61], v14 offset:29696
    ds_read_b64_tr_b16 v[62:63], v14 offset:29952
    v_mfma_f32_32x32x16_bf16 v[96:111], v[40:43], v[36:39], v[96:111]
    v_mfma_f32_32x32x16_bf16 v[112:127], v[44:47], v[36:39], v[112:127]
    s_waitcnt vmcnt(8) lgkmcnt(0)
    s_barrier
    ds_read_b128 v[32:35], v10 offset:32768
    ds_read_b128 v[36:39], v10 offset:36864
    v_mfma_f32_32x32x16_bf16 v[64:79], v[56:59], v[48:51], v[64:79]
    ds_read_b64_tr_b16 v[40:41], v14 offset:0
    ds_read_b64_tr_b16 v[42:43], v14 offset:256
    v_mfma_f32_32x32x16_bf16 v[80:95], v[60:63], v[48:51], v[80:95]
    ds_read_b64_tr_b16 v[44:45], v14 offset:1024
    ds_read_b64_tr_b16 v[46:47], v14 offset:1280
    v_mfma_f32_32x32x16_bf16 v[96:111], v[56:59], v[52:55], v[96:111]
    s_add_u32 m0, s32, 24576
    s_mul_i32 s34, s37, 122880
    buffer_load_dwordx4 v8, s[16:19], s34 offen lds
    s_add_u32 m0, s32, 25536
    s_add_u32 s37, s37, 1
    s_cmp_eq_u32 s37, 20
    s_cselect_b32 s37, 0, s37
    buffer_load_dwordx4 v8, s[16:19], s34 offen offset:64 lds
    v_mfma_f32_32x32x16_bf16 v[112:127], v[60:63], v[52:55], v[112:127]
    s_waitcnt lgkmcnt(0)
    ds_read_b128 v[48:51], v11 offset:32768
    ds_read_b128 v[52:55], v11 offset:36864
    v_mfma_f32_32x32x16_bf16 v[64:79], v[40:43], v[32:35], v[64:79]
    ds_read_b64_tr_b16 v[56:57], v14 offset:4096
    ds_read_b64_tr_b16 v[58:59], v14 offset:4352
    v_mfma_f32_32x32x16_bf16 v[80:95], v[44:47], v[32:35], v[80:95]
    ds_read_b64_tr_b16 v[60:61], v14 offset:5120
    ds_read_b64_tr_b16 v[62:63], v14 offset:5376
    v_mfma_f32_32x32x16_bf16 v[96:111], v[40:43], v[36:39], v[96:111]
    v_mfma_f32_32x32x16_bf16 v[112:127], v[44:47], v[36:39], v[112:127]
    s_waitcnt vmcnt(8) lgkmcnt(0)
    s_barrier
    ds_read_b128 v[32:35], v12 offset:32768
    ds_read_b128 v[36:39], v12 offset:36864
    v_mfma_f32_32x32x16_bf16 v[64:79], v[56:59], v[48:51], v[64:79]
    ds_read_b64_tr_b16 v[40:41], v14 offset:8192
    ds_read_b64_tr_b16 v[42:43], v14 offset:8448
    v_mfma_f32_32x32x16_bf16 v[80:95], v[60:63], v[48:51], v[80:95]
    ds_read_b64_tr_b16 v[44:45], v14 offset:9216
    ds_read_b64_tr_b16 v[46:47], v14 offset:9472
    v_mfma_f32_32x32x16_bf16 v[96:111], v[56:59], v[52:55], v[96:111]
    v_mfma_f32_32x32x16_bf16 v[112:127], v[60:63], v[52:55], v[112:127]
    s_waitcnt lgkmcnt(0)
    ds_read_b128 v[48:51], v13 offset:32768
    ds_read_b128 v[52:55], v13 offset:36864
    v_mfma_f32_32x32x16_bf16 v[64:79], v[40:43], v[32:35], v[64:79]
    ds_read_b64_tr_b16 v[56:57], v14 offset:12288
    ds_read_b64_tr_b16 v[58:59], v14 offset:12544
    v_mfma_f32_32x32x16_bf16 v[80:95], v[44:47], v[32:35], v[80:95]
    ds_read_b64_tr_b16 v[60:61], v14 offset:13312
    ds_read_b64_tr_b16 v[62:63], v14 offset:13568
    v_mfma_f32_32x32x16_bf16 v[96:111], v[40:43], v[36:39], v[96:111]
    v_mfma_f32_32x32x16_bf16 v[112:127], v[44:47], v[36:39], v[112:127]
    s_waitcnt vmcnt(2) lgkmcnt(0)
    s_barrier
    ds_read_b128 v[32:35], v10 offset:0
    ds_read_b128 v[36:39], v10 offset:4096
    v_mfma_f32_32x32x16_bf16 v[64:79], v[56:59], v[48:51], v[64:79]
    ds_read_b64_tr_b16 v[40:41], v14 offset:16384
    ds_read_b64_tr_b16 v[42:43], v14 offset:16640
    v_mfma_f32_32x32x16_bf16 v[80:95], v[60:63], v[48:51], v[80:95]
    ds_read_b64_tr_b16 v[44:45], v14 offset:17408
    ds_read_b64_tr_b16 v[46:47], v14 offset:17664
    v_mfma_f32_32x32x16_bf16 v[96:111], v[56:59], v[52:55], v[96:111]
    v_mfma_f32_32x32x16_bf16 v[112:127], v[60:63], v[52:55], v[112:127]
    s_waitcnt lgkmcnt(0)
    ds_read_b128 v[48:51], v11 offset:0
    ds_read_b128 v[52:55], v11 offset:4096
    v_mfma_f32_32x32x16_bf16 v[64:79], v[40:43], v[32:35], v[64:79]
    ds_read_b64_tr_b16 v[56:57], v14 offset:20480
    ds_read_b64_tr_b16 v[58:59], v14 offset:20736
    v_mfma_f32_32x32x16_bf16 v[80:95], v[44:47], v[32:35], v[80:95]
    ds_read_b64_tr_b16 v[60:61], v14 offset:21504
    ds_read_b64_tr_b16 v[62:63], v14 offset:21760
    v_mfma_f32_32x32x16_bf16 v[96:111], v[40:43], v[36:39], v[96:111]
    v_mfma_f32_32x32x16_bf16 v[112:127], v[44:47], v[36:39], v[112:127]
    s_waitcnt vmcnt(0) lgkmcnt(0)
    s_barrier
    ds_read_b128 v[32:35], v12 offset:0
    ds_read_b128 v[36:39], v12 offset:4096
    v_mfma_f32_32x32x16_bf16 v[64:79], v[56:59], v[48:51], v[64:79]
    ds_read_b64_tr_b16 v[40:41], v14 offset:24576
    ds_read_b64_tr_b16 v[42:43], v14 offset:24832
    v_mfma_f32_32x32x16_bf16 v[80:95], v[60:63], v[48:51], v[80:95]
    ds_read_b64_tr_b16 v[44:45], v14 offset:25600
    ds_read_b64_tr_b16 v[46:47], v14 offset:25856
    v_mfma_f32_32x32x16_bf16 v[96:111], v[56:59], v[52:55], v[96:111]
    v_mfma_f32_32x32x16_bf16 v[112:127], v[60:63], v[52:55], v[112:127]
    s_waitcnt lgkmcnt(0)
    ds_read_b128 v[48:51], v13 offset:0
    ds_read_b128 v[52:55], v13 offset:4096
    v_mfma_f32_32x32x16_bf16 v[64:79], v[40:43], v[32:35], v[64:79]
    ds_read_b64_tr_b16 v[56:57], v14 offset:28672
    ds_read_b64_tr_b16 v[58:59], v14 offset:28928
    v_mfma_f32_32x32x16_bf16 v[80:95], v[44:47], v[32:35], v[80:95]
    ds_read_b64_tr_b16 v[60:61], v14 offset:29696
    ds_read_b64_tr_b16 v[62:63], v14 offset:29952
    v_mfma_f32_32x32x16_bf16 v[96:111], v[40:43], v[36:39], v[96:111]
    v_mfma_f32_32x32x16_bf16 v[112:127], v[44:47], v[36:39], v[112:127]
    s_waitcnt lgkmcnt(0)
    v_mfma_f32_32x32x16_bf16 v[64:79], v[56:59], v[48:51], v[64:79]
    v_mfma_f32_32x32x16_bf16 v[80:95], v[60:63], v[48:51], v[80:95]
    v_mfma_f32_32x32x16_bf16 v[96:111], v[56:59], v[52:55], v[96:111]
    v_mfma_f32_32x32x16_bf16 v[112:127], v[60:63], v[52:55], v[112:127]
    buffer_load_dword v19, v18, s[52:55], 0 offen sc1
    s_cmp_lg_u32 s39, 0
    s_cbranch_scc1 A_noscale
    s_mov_b32 s56, 0x3ea52b5c
    s_mov_b32 s57, 0x3ea52b5c
    s_nop 6
    v_pk_mul_f32 v[64:65], v[64:65], s[56:57]
    v_pk_mul_f32 v[66:67], v[66:67], s[56:57]
    v_pk_mul_f32 v[68:69], v[68:69], s[56:57]
    v_pk_mul_f32 v[70:71], v[70:71], s[56:57]
    v_pk_mul_f32 v[72:73], v[72:73], s[56:57]
    v_pk_mul_f32 v[74:75], v[74:75], s[56:57]
    v_pk_mul_f32 v[76:77], v[76:77], s[56:57]
    v_pk_mul_f32 v[78:79], v[78:79], s[56:57]
    v_pk_mul_f32 v[80:81], v[80:81], s[56:57]
    v_pk_mul_f32 v[82:83], v[82:83], s[56:57]
    v_pk_mul_f32 v[84:85], v[84:85], s[56:57]
    v_pk_mul_f32 v[86:87], v[86:87], s[56:57]
    v_pk_mul_f32 v[88:89], v[88:89], s[56:57]
    v_pk_mul_f32 v[90:91], v[90:91], s[56:57]
    v_pk_mul_f32 v[92:93], v[92:93], s[56:57]
    v_pk_mul_f32 v[94:95], v[94:95], s[56:57]
    v_pk_mul_f32 v[96:97], v[96:97], s[56:57]
    v_pk_mul_f32 v[98:99], v[98:99], s[56:57]
    v_pk_mul_f32 v[100:101], v[100:101], s[56:57]
    v_pk_mul_f32 v[102:103], v[102:103], s[56:57]
    v_pk_mul_f32 v[104:105], v[104:105], s[56:57]
    v_pk_mul_f32 v[106:107], v[106:107], s[56:57]
    v_pk_mul_f32 v[108:109], v[108:109], s[56:57]
    v_pk_mul_f32 v[110:111], v[110:111], s[56:57]
    v_pk_mul_f32 v[112:113], v[112:113], s[56:57]
    v_pk_mul_f32 v[114:115], v[114:115], s[56:57]
    v_pk_mul_f32 v[116:117], v[116:117], s[56:57]
    v_pk_mul_f32 v[118:119], v[118:119], s[56:57]
    v_pk_mul_f32 v[120:121], v[120:121], s[56:57]
    v_pk_mul_f32 v[122:123], v[122:123], s[56:57]
    v_pk_mul_f32 v[124:125], v[124:125], s[56:57]
    v_pk_mul_f32 v[126:127], v[126:127], s[56:57]
A_noscale:
    s_nop 7
    s_nop 1
    v_cvt_pk_bf16_f32 v32, v64, v65
    v_cvt_pk_bf16_f32 v33, v66, v67
    v_cvt_pk_bf16_f32 v34, v68, v69
    v_cvt_pk_bf16_f32 v35, v70, v71
    buffer_store_dwordx4 v[32:35], v128, s[20:23], 0 offen offset:0 sc1
    v_cvt_pk_bf16_f32 v36, v96, v97
    v_cvt_pk_bf16_f32 v37, v98, v99
    v_cvt_pk_bf16_f32 v38, v100, v101
    v_cvt_pk_bf16_f32 v39, v102, v103
    buffer_store_dwordx4 v[36:39], v128, s[20:23], 0 offen offset:1024 sc1
    v_cvt_pk_bf16_f32 v40, v72, v73
    v_cvt_pk_bf16_f32 v41, v74, v75
    v_cvt_pk_bf16_f32 v42, v76, v77
    v_cvt_pk_bf16_f32 v43, v78, v79
    buffer_store_dwordx4 v[40:43], v129, s[20:23], 0 offen offset:0 sc1
    v_cvt_pk_bf16_f32 v44, v104, v105
    v_cvt_pk_bf16_f32 v45, v106, v107
    v_cvt_pk_bf16_f32 v46, v108, v109
    v_cvt_pk_bf16_f32 v47, v110, v111
    buffer_store_dwordx4 v[44:47], v129, s[20:23], 0 offen offset:1024 sc1
    v_cvt_pk_bf16_f32 v48, v80, v81
    v_cvt_pk_bf16_f32 v49, v82, v83
    v_cvt_pk_bf16_f32 v50, v84, v85
    v_cvt_pk_bf16_f32 v51, v86, v87
    buffer_store_dwordx4 v[48:51], v130, s[20:23], 0 offen offset:0 sc1
    v_cvt_pk_bf16_f32 v52, v112, v113
    v_cvt_pk_bf16_f32 v53, v114, v115
    v_cvt_pk_bf16_f32 v54, v116, v117
    v_cvt_pk_bf16_f32 v55, v118, v119
    buffer_store_dwordx4 v[52:55], v130, s[20:23], 0 offen offset:1024 sc1
    v_cvt_pk_bf16_f32 v56, v88, v89
    v_cvt_pk_bf16_f32 v57, v90, v91
    v_cvt_pk_bf16_f32 v58, v92, v93
    v_cvt_pk_bf16_f32 v59, v94, v95
    buffer_store_dwordx4 v[56:59], v131, s[20:23], 0 offen offset:0 sc1
    v_cvt_pk_bf16_f32 v60, v120, v121
    v_cvt_pk_bf16_f32 v61, v122, v123
    v_cvt_pk_bf16_f32 v62, v124, v125
    v_cvt_pk_bf16_f32 v63, v126, v127
    buffer_store_dwordx4 v[60:63], v131, s[20:23], 0 offen offset:1024 sc1
    s_cmp_eq_u64 s[40:41], 0
    s_cbranch_scc1 A_notail0
    v_mov_b32 v148, v32
    v_mov_b32 v149, v33
    v_mov_b32 v150, v36
    v_mov_b32 v151, v37
    v_mov_b32 v152, v34
    v_mov_b32 v153, v35
    v_mov_b32 v154, v38
    v_mov_b32 v155, v39
    buffer_store_dwordx4 v[148:151], v132, s[20:23], 0 offen sc1
    buffer_store_dwordx4 v[152:155], v132, s[20:23], s44 offen sc1
A_notail0:
    s_cmp_eq_u64 s[42:43], 0
    s_cbranch_scc1 A_notail1
    v_mov_b32 v156, v40
    v_mov_b32 v157, v41
    v_mov_b32 v158, v44
    v_mov_b32 v159, v45
    v_mov_b32 v160, v42
    v_mov_b32 v161, v43
    v_mov_b32 v162, v46
    v_mov_b32 v163, v47
    buffer_store_dwordx4 v[156:159], v133, s[20:23], 0 offen sc1
    buffer_store_dwordx4 v[160:163], v133, s[20:23], s44 offen sc1
A_notail1:
    s_cmp_eq_u64 s[48:49], 0
    s_cbranch_scc1 A_notail2
    v_mov_b32 v164, v48
    v_mov_b32 v165, v49
    v_mov_b32 v166, v52
    v_mov_b32 v167, v53
    v_mov_b32 v168, v50
    v_mov_b32 v169, v51
    v_mov_b32 v170, v54
    v_mov_b32 v171, v55
    buffer_store_dwordx4 v[164:167], v134, s[20:23], 0 offen sc1
    buffer_store_dwordx4 v[168:171], v134, s[20:23], s44 offen sc1
A_notail2:
    s_cmp_eq_u64 s[50:51], 0
    s_cbranch_scc1 A_notail3
    v_mov_b32 v172, v56
    v_mov_b32 v173, v57
    v_mov_b32 v174, v60
    v_mov_b32 v175, v61
    v_mov_b32 v176, v58
    v_mov_b32 v177, v59
    v_mov_b32 v178, v62
    v_mov_b32 v179, v63
    buffer_store_dwordx4 v[172:175], v135, s[20:23], 0 offen sc1
    buffer_store_dwordx4 v[176:179], v135, s[20:23], s44 offen sc1
A_notail3:
    s_branch A_publish
A_vpath:
    s_mov_b32 s52, s8
    s_mov_b32 s53, s9
    s_mov_b32 s54, 0x100
    s_mov_b32 s55, 0x00020000
    v_and_b32 v7, 3, v2
    v_lshl_add_u32 v14, v7, 3, v14
    s_mul_i32 s45, s42, 2560
    s_add_u32 s45, s45, s41
    s_add_u32 s45, s45, 10240
    v_mul_u32_u24 v26, 320, v6
    v_add_u32 v26, s45, v26
    v_add_u32 v27, s40, v5
    v_add_u32 v28, 0, v27
    v_mul_u32_u24 v29, 3277, v28
    v_lshrrev_b32 v29, 16, v29
    v_mul_u32_u24 v30, 20, v29
    v_sub_u32 v30, v28, v30
    v_mul_lo_u32 v29, v29, s44
    v_lshl_add_u32 v30, v30, 4, v26
    v_add_u32 v128, v29, v30
    v_add_u32 v28, 32, v27
    v_mul_u32_u24 v29, 3277, v28
    v_lshrrev_b32 v29, 16, v29
    v_mul_u32_u24 v30, 20, v29
    v_sub_u32 v30, v28, v30
    v_mul_lo_u32 v29, v29, s44
    v_lshl_add_u32 v30, v30, 4, v26
    v_add_u32 v129, v29, v30
    s_waitcnt vmcnt(8)
    s_barrier
    ds_read_b128 v[32:35], v10 offset:0
    ds_read_b128 v[36:39], v10 offset:4096
    ds_read_b64_tr_b16 v[40:41], v14 offset:0
    ds_read_b64_tr_b16 v[42:43], v14 offset:256
    ds_read_b64_tr_b16 v[44:45], v14 offset:1024
    ds_read_b64_tr_b16 v[46:47], v14 offset:1280
    s_waitcnt lgkmcnt(0)
    ds_read_b128 v[48:51], v11 offset:0
    ds_read_b128 v[52:55], v11 offset:4096
    v_mfma_f32_32x32x16_bf16 v[64:79], v[32:35], v[40:43], 0
    ds_read_b64_tr_b16 v[56:57], v14 offset:4096
    ds_read_b64_tr_b16 v[58:59], v14 offset:4352
    v_mfma_f32_32x32x16_bf16 v[80:95], v[32:35], v[44:47], 0
    ds_read_b64_tr_b16 v[60:61], v14 offset:5120
    ds_read_b64_tr_b16 v[62:63], v14 offset:5376
    v_mfma_f32_32x32x16_bf16 v[96:111], v[36:39], v[40:43], 0
    s_add_u32 m0, s32, 24576
    s_mul_i32 s34, s37, 122880
    buffer_load_dwordx4 v8, s[16:19], s34 offen lds
    s_add_u32 m0, s32, 25536
    s_add_u32 s37, s37, 1
    s_cmp_eq_u32 s37, 20
    s_cselect_b32 s37, 0, s37
    buffer_load_dwordx4 v8, s[16:19], s34 offen offset:64 lds
    v_mfma_f32_32x32x16_bf16 v[112:127], v[36:39], v[44:47], 0
    s_waitcnt vmcnt(8) lgkmcnt(0)
    s_barrier
    ds_read_b128 v[32:35], v12 offset:0
    ds_read_b128 v[36:39], v12 offset:4096
    v_mfma_f32_32x32x16_bf16 v[64:79], v[48:51], v[56:59], v[64:79]
    ds_read_b64_tr_b16 v[40:41], v14 offset:8192
    ds_read_b64_tr_b16 v[42:43], v14 offset:8448
    v_mfma_f32_32x32x16_bf16 v[80:95], v[48:51], v[60:63], v[80:95]
    ds_read_b64_tr_b16 v[44:45], v14 offset:9216
    ds_read_b64_tr_b16 v[46:47], v14 offset:9472
    v_mfma_f32_32x32x16_bf16 v[96:111], v[52:55], v[56:59], v[96:111]
    s_add_u32 m0, s31, 32768
    s_lshl_b32 s33, s38, 7
    buffer_load_dwordx4 v3, s[12:15], s33 offen lds
    s_add_u32 m0, s31, 33792
    s_nop 0
    buffer_load_dwordx4 v4, s[12:15], s33 offen lds
    v_mfma_f32_32x32x16_bf16 v[112:127], v[52:55], v[60:63], v[112:127]
    s_add_u32 m0, s31, 34816
    s_add_u32 s33, s33, 20480
    buffer_load_dwordx4 v3, s[12:15], s33 offen lds
    s_add_u32 m0, s31, 35840
    s_add_u32 s38, s38, 1
    s_cmp_eq_u32 s38, 10
    s_cselect_b32 s38, 0, s38
    buffer_load_dwordx4 v4, s[12:15], s33 offen lds
    s_waitcnt lgkmcnt(0)
    ds_read_b128 v[48:51], v13 offset:0
    ds_read_b128 v[52:55], v13 offset:4096
    v_mfma_f32_32x32x16_bf16 v[64:79], v[32:35], v[40:43], v[64:79]
    ds_read_b64_tr_b16 v[56:57], v14 offset:12288
    ds_read_b64_tr_b16 v[58:59], v14 offset:12544
    v_mfma_f32_32x32x16_bf16 v[80:95], v[32:35], v[44:47], v[80:95]
    ds_read_b64_tr_b16 v[60:61], v14 offset:13312
    ds_read_b64_tr_b16 v[62:63], v14 offset:13568
    v_mfma_f32_32x32x16_bf16 v[96:111], v[36:39], v[40:43], v[96:111]
    s_add_u32 m0, s32, 0
    s_mul_i32 s34, s37, 122880
    buffer_load_dwordx4 v8, s[16:19], s34 offen lds
    s_add_u32 m0, s32, 960
    s_add_u32 s37, s37, 1
    s_cmp_eq_u32 s37, 20
    s_cselect_b32 s37, 0, s37
    buffer_load_dwordx4 v8, s[16:19], s34 offen offset:64 lds
    v_mfma_f32_32x32x16_bf16 v[112:127], v[36:39], v[44:47], v[112:127]
    s_waitcnt vmcnt(8) lgkmcnt(0)
    s_barrier
    ds_read_b128 v[32:35], v10 offset:16384
    ds_read_b128 v[36:39], v10 offset:20480
    v_mfma_f32_32x32x16_bf16 v[64:79], v[48:51], v[56:59], v[64:79]
    ds_read_b64_tr_b16 v[40:41], v14 offset:16384
    ds_read_b64_tr_b16 v[42:43], v14 offset:16640
    v_mfma_f32_32x32x16_bf16 v[80:95], v[48:51], v[60:63], v[80:95]
    ds_read_b64_tr_b16 v[44:45], v14 offset:17408
    ds_read_b64_tr_b16 v[46:47], v14 offset:17664
    v_mfma_f32_32x32x16_bf16 v[96:111], v[52:55], v[56:59], v[96:111]
    s_add_u32 m0, s32, 8192
    s_mul_i32 s34, s37, 122880
    buffer_load_dwordx4 v8, s[16:19], s34 offen lds
    s_add_u32 m0, s32, 9152
    s_add_u32 s37, s37, 1
    s_cmp_eq_u32 s37, 20
    s_cselect_b32 s37, 0, s37
    buffer_load_dwordx4 v8, s[16:19], s34 offen offset:64 lds
    v_mfma_f32_32x32x16_bf16 v[112:127], v[52:55], v[60:63], v[112:127]
    s_add_u32 m0, s31, 0
    s_lshl_b32 s33, s38, 7
    buffer_load_dwordx4 v3, s[12:15], s33 offen lds
    s_add_u32 m0, s31, 1024
    s_nop 0
    buffer_load_dwordx4 v4, s[12:15], s33 offen lds
    s_waitcnt lgkmcnt(0)
    ds_read_b128 v[48:51], v11 offset:16384
    ds_read_b128 v[52:55], v11 offset:20480
    v_mfma_f32_32x32x16_bf16 v[64:79], v[32:35], v[40:43], v[64:79]
    ds_read_b64_tr_b16 v[56:57], v14 offset:20480
    ds_read_b64_tr_b16 v[58:59], v14 offset:20736
    v_mfma_f32_32x32x16_bf16 v[80:95], v[32:35], v[44:47], v[80:95]
    ds_read_b64_tr_b16 v[60:61], v14 offset:21504
    ds_read_b64_tr_b16 v[62:63], v14 offset:21760
    v_mfma_f32_32x32x16_bf16 v[96:111], v[36:39], v[40:43], v[96:111]
    s_add_u32 m0, s31, 2048
    s_add_u32 s33, s33, 20480
    buffer_load_dwordx4 v3, s[12:15], s33 offen lds
    s_add_u32 m0, s31, 3072
    s_add_u32 s38, s38, 1
    s_cmp_eq_u32 s38, 10
    s_cselect_b32 s38, 0, s38
    buffer_load_dwordx4 v4, s[12:15], s33 offen lds
    v_mfma_f32_32x32x16_bf16 v[112:127], v[36:39], v[44:47], v[112:127]
    s_waitcnt vmcnt(12) lgkmcnt(0)
    s_barrier
    ds_read_b128 v[32:35], v12 offset:16384
    ds_read_b128 v[36:39], v12 offset:20480
    v_mfma_f32_32x32x16_bf16 v[64:79], v[48:51], v[56:59], v[64:79]
    ds_read_b64_tr_b16 v[40:41], v14 offset:24576
    ds_read_b64_tr_b16 v[42:43], v14 offset:24832
    v_mfma_f32_32x32x16_bf16 v[80:95], v[48:51], v[60:63], v[80:95]
    ds_read_b64_tr_b16 v[44:45], v14 offset:25600
    ds_read_b64_tr_b16 v[46:47], v14 offset:25856
    v_mfma_f32_32x32x16_bf16 v[96:111], v[52:55], v[56:59], v[96:111]
    s_add_u32 m0, s32, 16384
    s_mul_i32 s34, s37, 122880
    buffer_load_dwordx4 v8, s[16:19], s34 offen lds
    s_add_u32 m0, s32, 17344
    s_add_u32 s37, s37, 1
    s_cmp_eq_u32 s37, 20
    s_cselect_b32 s37, 0, s37
    buffer_load_dwordx4 v8, s[16:19], s34 offen offset:64 lds
    v_mfma_f32_32x32x16_bf16 v[112:127], v[52:55], v[60:63], v[112:127]
    s_waitcnt lgkmcnt(0)
    ds_read_b128 v[48:51], v13 offset:16384
    ds_read_b128 v[52:55], v13 offset:20480
    v_mfma_f32_32x32x16_bf16 v[64:79], v[32:35], v[40:43], v[64:79]
    ds_read_b64_tr_b16 v[56:57], v14 offset:28672
    ds_read_b64_tr_b16 v[58:59], v14 offset:28928
    v_mfma_f32_32x32x16_bf16 v[80:95], v[32:35], v[44:47], v[80:95]
    ds_read_b64_tr_b16 v[60:61], v14 offset:29696
    ds_read_b64_tr_b16 v[62:63], v14 offset:29952
    v_mfma_f32_32x32x16_bf16 v[96:111], v[36:39], v[40:43], v[96:111]
    v_mfma_f32_32x32x16_bf16 v[112:127], v[36:39], v[44:47], v[112:127]
    s_waitcnt vmcnt(8) lgkmcnt(0)
    s_barrier
    ds_read_b128 v[32:35], v10 offset:32768
    ds_read_b128 v[36:39], v10 offset:36864
    v_mfma_f32_32x32x16_bf16 v[64:79], v[48:51], v[56:59], v[64:79]
    ds_read_b64_tr_b16 v[40:41], v14 offset:0
    ds_read_b64_tr_b16 v[42:43], v14 offset:256
    v_mfma_f32_32x32x16_bf16 v[80:95], v[48:51], v[60:63], v[80:95]
    ds_read_b64_tr_b16 v[44:45], v14 offset:1024
    ds_read_b64_tr_b16 v[46:47], v14 offset:1280
    v_mfma_f32_32x32x16_bf16 v[96:111], v[52:55], v[56:59], v[96:111]
    s_add_u32 m0, s32, 24576
    s_mul_i32 s34, s37, 122880
    buffer_load_dwordx4 v8, s[16:19], s34 offen lds
    s_add_u32 m0, s32, 25536
    s_add_u32 s37, s37, 1
    s_cmp_eq_u32 s37, 20
    s_cselect_b32 s37, 0, s37
    buffer_load_dwordx4 v8, s[16:19], s34 offen offset:64 lds
    v_mfma_f32_32x32x16_bf16 v[112:127], v[52:55], v[60:63], v[112:127]
    s_add_u32 m0, s31, 16384
    s_lshl_b32 s33, s38, 7
    buffer_load_dwordx4 v3, s[12:15], s33 offen lds
    s_add_u32 m0, s31, 17408
    s_nop 0
    buffer_load_dwordx4 v4, s[12:15], s33 offen lds
    s_waitcnt lgkmcnt(0)
    ds_read_b128 v[48:51], v11 offset:32768
    ds_read_b128 v[52:55], v11 offset:36864
    v_mfma_f32_32x32x16_bf16 v[64:79], v[32:35], v[40:43], v[64:79]
    ds_read_b64_tr_b16 v[56:57], v14 offset:4096
    ds_read_b64_tr_b16 v[58:59], v14 offset:4352
    v_mfma_f32_32x32x16_bf16 v[80:95], v[32:35], v[44:47], v[80:95]
    ds_read_b64_tr_b16 v[60:61], v14 offset:5120
    ds_read_b64_tr_b16 v[62:63], v14 offset:5376
    v_mfma_f32_32x32x16_bf16 v[96:111], v[36:39], v[40:43], v[96:111]
    s_add_u32 m0, s31, 18432
    s_add_u32 s33, s33, 20480
    buffer_load_dwordx4 v3, s[12:15], s33 offen lds
    s_add_u32 m0, s31, 19456
    s_add_u32 s38, s38, 1
    s_cmp_eq_u32 s38, 10
    s_cselect_b32 s38, 0, s38
    buffer_load_dwordx4 v4, s[12:15], s33 offen lds
    v_mfma_f32_32x32x16_bf16 v[112:127], v[36:39], v[44:47], v[112:127]
    s_waitcnt vmcnt(12) lgkmcnt(0)
    s_barrier
    ds_read_b128 v[32:35], v12 offset:32768
    ds_read_b128 v[36:39], v12 offset:36864
    v_mfma_f32_32x32x16_bf16 v[64:79], v[48:51], v[56:59], v[64:79]
    ds_read_b64_tr_b16 v[40:41], v14 offset:8192
    ds_read_b64_tr_b16 v[42:43], v14 offset:8448
    v_mfma_f32_32x32x16_bf16 v[80:95], v[48:51], v[60:63], v[80:95]
    ds_read_b64_tr_b16 v[44:45], v14 offset:9216
    ds_read_b64_tr_b16 v[46:47], v14 offset:9472
    v_mfma_f32_32x32x16_bf16 v[96:111], v[52:55], v[56:59], v[96:111]
    s_add_u32 m0, s32, 0
    s_mul_i32 s34, s37, 122880
    buffer_load_dwordx4 v8, s[16:19], s34 offen lds
    s_add_u32 m0, s32, 960
    s_add_u32 s37, s37, 1
    s_cmp_eq_u32 s37, 20
    s_cselect_b32 s37, 0, s37
    buffer_load_dwordx4 v8, s[16:19], s34 offen offset:64 lds
    v_mfma_f32_32x32x16_bf16 v[112:127], v[52:55], v[60:63], v[112:127]
    s_waitcnt lgkmcnt(0)
    ds_read_b128 v[48:51], v13 offset:32768
    ds_read_b128 v[52:55], v13 offset:36864
    v_mfma_f32_32x32x16_bf16 v[64:79], v[32:35], v[40:43], v[64:79]
    ds_read_b64_tr_b16 v[56:57], v14 offset:12288
    ds_read_b64_tr_b16 v[58:59], v14 offset:12544
    v_mfma_f32_32x32x16_bf16 v[80:95], v[32:35], v[44:47], v[80:95]
    ds_read_b64_tr_b16 v[60:61], v14 offset:13312
    ds_read_b64_tr_b16 v[62:63], v14 offset:13568
    v_mfma_f32_32x32x16_bf16 v[96:111], v[36:39], v[40:43], v[96:111]
    v_mfma_f32_32x32x16_bf16 v[112:127], v[36:39], v[44:47], v[112:127]
    s_waitcnt vmcnt(8) lgkmcnt(0)
    s_barrier
    ds_read_b128 v[32:35], v10 offset:0
    ds_read_b128 v[36:39], v10 offset:4096
    v_mfma_f32_32x32x16_bf16 v[64:79], v[48:51], v[56:59], v[64:79]
    ds_read_b64_tr_b16 v[40:41], v14 offset:16384
    ds_read_b64_tr_b16 v[42:43], v14 offset:16640
    v_mfma_f32_32x32x16_bf16 v[80:95], v[48:51], v[60:63], v[80:95]
    ds_read_b64_tr_b16 v[44:45], v14 offset:17408
    ds_read_b64_tr_b16 v[46:47], v14 offset:17664
    v_mfma_f32_32x32x16_bf16 v[96:111], v[52:55], v[56:59], v[96:111]
    s_add_u32 m0, s32, 8192
    s_mul_i32 s34, s37, 122880
    buffer_load_dwordx4 v8, s[16:19], s34 offen lds
    s_add_u32 m0, s32, 9152
    s_add_u32 s37, s37, 1
    s_cmp_eq_u32 s37, 20
    s_cselect_b32 s37, 0, s37
    buffer_load_dwordx4 v8, s[16:19], s34 offen offset:64 lds
    v_mfma_f32_32x32x16_bf16 v[112:127], v[52:55], v[60:63], v[112:127]
    s_add_u32 m0, s31, 32768
    s_lshl_b32 s33, s38, 7
    buffer_load_dwordx4 v3, s[12:15], s33 offen lds
    s_add_u32 m0, s31, 33792
    s_nop 0
    buffer_load_dwordx4 v4, s[12:15], s33 offen lds
    s_waitcnt lgkmcnt(0)
    ds_read_b128 v[48:51], v11 offset:0
    ds_read_b128 v[52:55], v11 offset:4096
    v_mfma_f32_32x32x16_bf16 v[64:79], v[32:35], v[40:43], v[64:79]
    ds_read_b64_tr_b16 v[56:57], v14 offset:20480
    ds_read_b64_tr_b16 v[58:59], v14 offset:20736
    v_mfma_f32_32x32x16_bf16 v[80:95], v[32:35], v[44:47], v[80:95]
    ds_read_b64_tr_b16 v[60:61], v14 offset:21504
    ds_read_b64_tr_b16 v[62:63], v14 offset:21760
    v_mfma_f32_32x32x16_bf16 v[96:111], v[36:39], v[40:43], v[96:111]
    s_add_u32 m0, s31, 34816
    s_add_u32 s33, s33, 20480
    buffer_load_dwordx4 v3, s[12:15], s33 offen lds
    s_add_u32 m0, s31, 35840
    s_add_u32 s38, s38, 1
    s_cmp_eq_u32 s38, 10
    s_cselect_b32 s38, 0, s38
    buffer_load_dwordx4 v4, s[12:15], s33 offen lds
    v_mfma_f32_32x32x16_bf16 v[112:127], v[36:39], v[44:47], v[112:127]
    s_waitcnt vmcnt(12) lgkmcnt(0)
    s_barrier
    ds_read_b128 v[32:35], v12 offset:0
    ds_read_b128 v[36:39], v12 offset:4096
    v_mfma_f32_32x32x16_bf16 v[64:79], v[48:51], v[56:59], v[64:79]
    ds_read_b64_tr_b16 v[40:41], v14 offset:24576
    ds_read_b64_tr_b16 v[42:43], v14 offset:24832
    v_mfma_f32_32x32x16_bf16 v[80:95], v[48:51], v[60:63], v[80:95]
    ds_read_b64_tr_b16 v[44:45], v14 offset:25600
    ds_read_b64_tr_b16 v[46:47], v14 offset:25856
    v_mfma_f32_32x32x16_bf16 v[96:111], v[52:55], v[56:59], v[96:111]
    s_add_u32 m0, s32, 16384
    s_mul_i32 s34, s37, 122880
    buffer_load_dwordx4 v8, s[16:19], s34 offen lds
    s_add_u32 m0, s32, 17344
    s_add_u32 s37, s37, 1
    s_cmp_eq_u32 s37, 20
    s_cselect_b32 s37, 0, s37
    buffer_load_dwordx4 v8, s[16:19], s34 offen offset:64 lds
    v_mfma_f32_32x32x16_bf16 v[112:127], v[52:55], v[60:63], v[112:127]
    s_waitcnt lgkmcnt(0)
    ds_read_b128 v[48:51], v13 offset:0
    ds_read_b128 v[52:55], v13 offset:4096
    v_mfma_f32_32x32x16_bf16 v[64:79], v[32:35], v[40:43], v[64:79]
    ds_read_b64_tr_b16 v[56:57], v14 offset:28672
    ds_read_b64_tr_b16 v[58:59], v14 offset:28928
    v_mfma_f32_32x32x16_bf16 v[80:95], v[32:35], v[44:47], v[80:95]
    ds_read_b64_tr_b16 v[60:61], v14 offset:29696
    ds_read_b64_tr_b16 v[62:63], v14 offset:29952
    v_mfma_f32_32x32x16_bf16 v[96:111], v[36:39], v[40:43], v[96:111]
    v_mfma_f32_32x32x16_bf16 v[112:127], v[36:39], v[44:47], v[112:127]
    s_waitcnt vmcnt(8) lgkmcnt(0)
    s_barrier
    ds_read_b128 v[32:35], v10 offset:16384
    ds_read_b128 v[36:39], v10 offset:20480
    v_mfma_f32_32x32x16_bf16 v[64:79], v[48:51], v[56:59], v[64:79]
    ds_read_b64_tr_b16 v[40:41], v14 offset:0
    ds_read_b64_tr_b16 v[42:43], v14 offset:256
    v_mfma_f32_32x32x16_bf16 v[80:95], v[48:51], v[60:63], v[80:95]
    ds_read_b64_tr_b16 v[44:45], v14 offset:1024
    ds_read_b64_tr_b16 v[46:47], v14 offset:1280
    v_mfma_f32_32x32x16_bf16 v[96:111], v[52:55], v[56:59], v[96:111]
    s_add_u32 m0, s32, 24576
    s_mul_i32 s34, s37, 122880
    buffer_load_dwordx4 v8, s[16:19], s34 offen lds
    s_add_u32 m0, s32, 25536
    s_add_u32 s37, s37, 1
    s_cmp_eq_u32 s37, 20
    s_cselect_b32 s37, 0, s37
    buffer_load_dwordx4 v8, s[16:19], s34 offen offset:64 lds
    v_mfma_f32_32x32x16_bf16 v[112:127], v[52:55], v[60:63], v[112:127]
    s_add_u32 m0, s31, 0
    s_lshl_b32 s33, s38, 7
    buffer_load_dwordx4 v3, s[12:15], s33 offen lds
    s_add_u32 m0, s31, 1024
    s_nop 0
    buffer_load_dwordx4 v4, s[12:15], s33 offen lds
    s_waitcnt lgkmcnt(0)
    ds_read_b128 v[48:51], v11 offset:16384
    ds_read_b128 v[52:55], v11 offset:20480
    v_mfma_f32_32x32x16_bf16 v[64:79], v[32:35], v[40:43], v[64:79]
    ds_read_b64_tr_b16 v[56:57], v14 offset:4096
    ds_read_b64_tr_b16 v[58:59], v14 offset:4352
    v_mfma_f32_32x32x16_bf16 v[80:95], v[32:35], v[44:47], v[80:95]
    ds_read_b64_tr_b16 v[60:61], v14 offset:5120
    ds_read_b64_tr_b16 v[62:63], v14 offset:5376
    v_mfma_f32_32x32x16_bf16 v[96:111], v[36:39], v[40:43], v[96:111]
    s_add_u32 m0, s31, 2048
    s_add_u32 s33, s33, 20480
    buffer_load_dwordx4 v3, s[12:15], s33 offen lds
    s_add_u32 m0, s31, 3072
    s_add_u32 s38, s38, 1
    s_cmp_eq_u32 s38, 10
    s_cselect_b32 s38, 0, s38
    buffer_load_dwordx4 v4, s[12:15], s33 offen lds
    v_mfma_f32_32x32x16_bf16 v[112:127], v[36:39], v[44:47], v[112:127]
    s_waitcnt vmcnt(12) lgkmcnt(0)
    s_barrier
    ds_read_b128 v[32:35], v12 offset:16384
    ds_read_b128 v[36:39], v12 offset:20480
    v_mfma_f32_32x32x16_bf16 v[64:79], v[48:51], v[56:59], v[64:79]
    ds_read_b64_tr_b16 v[40:41], v14 offset:8192
    ds_read_b64_tr_b16 v[42:43], v14 offset:8448
    v_mfma_f32_32x32x16_bf16 v[80:95], v[48:51], v[60:63], v[80:95]
    ds_read_b64_tr_b16 v[44:45], v14 offset:9216
    ds_read_b64_tr_b16 v[46:47], v14 offset:9472
    v_mfma_f32_32x32x16_bf16 v[96:111], v[52:55], v[56:59], v[96:111]
    s_add_u32 m0, s32, 0
    s_mul_i32 s34, s37, 122880
    buffer_load_dwordx4 v8, s[16:19], s34 offen lds
    s_add_u32 m0, s32, 960
    s_add_u32 s37, s37, 1
    s_cmp_eq_u32 s37, 20
    s_cselect_b32 s37, 0, s37
    buffer_load_dwordx4 v8, s[16:19], s34 offen offset:64 lds
    v_mfma_f32_32x32x16_bf16 v[112:127], v[52:55], v[60:63], v[112:127]
    s_waitcnt lgkmcnt(0)
    ds_read_b128 v[48:51], v13 offset:16384
    ds_read_b128 v[52:55], v13 offset:20480
    v_mfma_f32_32x32x16_bf16 v[64:79], v[32:35], v[40:43], v[64:79]
    ds_read_b64_tr_b16 v[56:57], v14 offset:12288
    ds_read_b64_tr_b16 v[58:59], v14 offset:12544
    v_mfma_f32_32x32x16_bf16 v[80:95], v[32:35], v[44:47], v[80:95]
    ds_read_b64_tr_b16 v[60:61], v14 offset:13312
    ds_read_b64_tr_b16 v[62:63], v14 offset:13568
    v_mfma_f32_32x32x16_bf16 v[96:111], v[36:39], v[40:43], v[96:111]
    v_mfma_f32_32x32x16_bf16 v[112:127], v[36:39], v[44:47], v[112:127]
    s_waitcnt vmcnt(8) lgkmcnt(0)
    s_barrier
    ds_read_b128 v[32:35], v10 offset:32768
    ds_read_b128 v[36:39], v10 offset:36864
    v_mfma_f32_32x32x16_bf16 v[64:79], v[48:51], v[56:59], v[64:79]
    ds_read_b64_tr_b16 v[40:41], v14 offset:16384
    ds_read_b64_tr_b16 v[42:43], v14 offset:16640
    v_mfma_f32_32x32x16_bf16 v[80:95], v[48:51], v[60:63], v[80:95]
    ds_read_b64_tr_b16 v[44:45], v14 offset:17408
    ds_read_b64_tr_b16 v[46:47], v14 offset:17664
    v_mfma_f32_32x32x16_bf16 v[96:111], v[52:55], v[56:59], v[96:111]
    s_add_u32 m0, s32, 8192
    s_mul_i32 s34, s37, 122880
    buffer_load_dwordx4 v8, s[16:19], s34 offen lds
    s_add_u32 m0, s32, 9152
    s_add_u32 s37, s37, 1
    s_cmp_eq_u32 s37, 20
    s_cselect_b32 s37, 0, s37
    buffer_load_dwordx4 v8, s[16:19], s34 offen offset:64 lds
    v_mfma_f32_32x32x16_bf16 v[112:127], v[52:55], v[60:63], v[112:127]
    s_add_u32 m0, s31, 16384
    s_lshl_b32 s33, s38, 7
    buffer_load_dwordx4 v3, s[12:15], s33 offen lds
    s_add_u32 m0, s31, 17408
    s_nop 0
    buffer_load_dwordx4 v4, s[12:15], s33 offen lds
    s_waitcnt lgkmcnt(0)
    ds_read_b128 v[48:51], v11 offset:32768
    ds_read_b128 v[52:55], v11 offset:36864
    v_mfma_f32_32x32x16_bf16 v[64:79], v[32:35], v[40:43], v[64:79]
    ds_read_b64_tr_b16 v[56:57], v14 offset:20480
    ds_read_b64_tr_b16 v[58:59], v14 offset:20736
    v_mfma_f32_32x32x16_bf16 v[80:95], v[32:35], v[44:47], v[80:95]
    ds_read_b64_tr_b16 v[60:61], v14 offset:21504
    ds_read_b64_tr_b16 v[62:63], v14 offset:21760
    v_mfma_f32_32x32x16_bf16 v[96:111], v[36:39], v[40:43], v[96:111]
    s_add_u32 m0, s31, 18432
    s_add_u32 s33, s33, 20480
    buffer_load_dwordx4 v3, s[12:15], s33 offen lds
    s_add_u32 m0, s31, 19456
    s_add_u32 s38, s38, 1
    s_cmp_eq_u32 s38, 10
    s_cselect_b32 s38, 0, s38
    buffer_load_dwordx4 v4, s[12:15], s33 offen lds
    v_mfma_f32_32x32x16_bf16 v[112:127], v[36:39], v[44:47], v[112:127]
    s_waitcnt vmcnt(12) lgkmcnt(0)
    s_barrier
    ds_read_b128 v[32:35], v12 offset:32768
    ds_read_b128 v[36:39], v12 offset:36864
    v_mfma_f32_32x32x16_bf16 v[64:79], v[48:51], v[56:59], v[64:79]
    ds_read_b64_tr_b16 v[40:41], v14 offset:24576
    ds_read_b64_tr_b16 v[42:43], v14 offset:24832
    v_mfma_f32_32x32x16_bf16 v[80:95], v[48:51], v[60:63], v[80:95]
    ds_read_b64_tr_b16 v[44:45], v14 offset:25600
    ds_read_b64_tr_b16 v[46:47], v14 offset:25856
    v_mfma_f32_32x32x16_bf16 v[96:111], v[52:55], v[56:59], v[96:111]
    s_add_u32 m0, s32, 16384
    s_mul_i32 s34, s37, 122880
    buffer_load_dwordx4 v8, s[16:19], s34 offen lds
    s_add_u32 m0, s32, 17344
    s_add_u32 s37, s37, 1
    s_cmp_eq_u32 s37, 20
    s_cselect_b32 s37, 0, s37
    buffer_load_dwordx4 v8, s[16:19], s34 offen offset:64 lds
    v_mfma_f32_32x32x16_bf16 v[112:127], v[52:55], v[60:63], v[112:127]
    s_waitcnt lgkmcnt(0)
    ds_read_b128 v[48:51], v13 offset:32768
    ds_read_b128 v[52:55], v13 offset:36864
    v_mfma_f32_32x32x16_bf16 v[64:79], v[32:35], v[40:43], v[64:79]
    ds_read_b64_tr_b16 v[56:57], v14 offset:28672
    ds_read_b64_tr_b16 v[58:59], v14 offset:28928
    v_mfma_f32_32x32x16_bf16 v[80:95], v[32:35], v[44:47], v[80:95]
    ds_read_b64_tr_b16 v[60:61], v14 offset:29696
    ds_read_b64_tr_b16 v[62:63], v14 offset:29952
    v_mfma_f32_32x32x16_bf16 v[96:111], v[36:39], v[40:43], v[96:111]
    v_mfma_f32_32x32x16_bf16 v[112:127], v[36:39], v[44:47], v[112:127]
    s_waitcnt vmcnt(8) lgkmcnt(0)
    s_barrier
    ds_read_b128 v[32:35], v10 offset:0
    ds_read_b128 v[36:39], v10 offset:4096
    v_mfma_f32_32x32x16_bf16 v[64:79], v[48:51], v[56:59], v[64:79]
    ds_read_b64_tr_b16 v[40:41], v14 offset:0
    ds_read_b64_tr_b16 v[42:43], v14 offset:256
    v_mfma_f32_32x32x16_bf16 v[80:95], v[48:51], v[60:63], v[80:95]
    ds_read_b64_tr_b16 v[44:45], v14 offset:1024
    ds_read_b64_tr_b16 v[46:47], v14 offset:1280
    v_mfma_f32_32x32x16_bf16 v[96:111], v[52:55], v[56:59], v[96:111]
    s_add_u32 m0, s32, 24576
    s_mul_i32 s34, s37, 122880
    buffer_load_dwordx4 v8, s[16:19], s34 offen lds
    s_add_u32 m0, s32, 25536
    s_add_u32 s37, s37, 1
    s_cmp_eq_u32 s37, 20
    s_cselect_b32 s37, 0, s37
    buffer_load_dwordx4 v8, s[16:19], s34 offen offset:64 lds
    v_mfma_f32_32x32x16_bf16 v[112:127], v[52:55], v[60:63], v[112:127]
    s_add_u32 m0, s31, 32768
    s_lshl_b32 s33, s38, 7
    buffer_load_dwordx4 v3, s[12:15], s33 offen lds
    s_add_u32 m0, s31, 33792
    s_nop 0
    buffer_load_dwordx4 v4, s[12:15], s33 offen lds
    s_waitcnt lgkmcnt(0)
    ds_read_b128 v[48:51], v11 offset:0
    ds_read_b128 v[52:55], v11 offset:4096
    v_mfma_f32_32x32x16_bf16 v[64:79], v[32:35], v[40:43], v[64:79]
    ds_read_b64_tr_b16 v[56:57], v14 offset:4096
    ds_read_b64_tr_b16 v[58:59], v14 offset:4352
    v_mfma_f32_32x32x16_bf16 v[80:95], v[32:35], v[44:47], v[80:95]
    ds_read_b64_tr_b16 v[60:61], v14 offset:5120
    ds_read_b64_tr_b16 v[62:63], v14 offset:5376
    v_mfma_f32_32x32x16_bf16 v[96:111], v[36:39], v[40:43], v[96:111]
    s_add_u32 m0, s31, 34816
    s_add_u32 s33, s33, 20480
    buffer_load_dwordx4 v3, s[12:15], s33 offen lds
    s_add_u32 m0, s31, 35840
    s_add_u32 s38, s38, 1
    s_cmp_eq_u32 s38, 10
    s_cselect_b32 s38, 0, s38
    buffer_load_dwordx4 v4, s[12:15], s33 offen lds
    v_mfma_f32_32x32x16_bf16 v[112:127], v[36:39], v[44:47], v[112:127]
    s_waitcnt vmcnt(12) lgkmcnt(0)
    s_barrier
    ds_read_b128 v[32:35], v12 offset:0
    ds_read_b128 v[36:39], v12 offset:4096
    v_mfma_f32_32x32x16_bf16 v[64:79], v[48:51], v[56:59], v[64:79]
    ds_read_b64_tr_b16 v[40:41], v14 offset:8192
    ds_read_b64_tr_b16 v[42:43], v14 offset:8448
    v_mfma_f32_32x32x16_bf16 v[80:95], v[48:51], v[60:63], v[80:95]
    ds_read_b64_tr_b16 v[44:45], v14 offset:9216
    ds_read_b64_tr_b16 v[46:47], v14 offset:9472
    v_mfma_f32_32x32x16_bf16 v[96:111], v[52:55], v[56:59], v[96:111]
    s_add_u32 m0, s32, 0
    s_mul_i32 s34, s37, 122880
    buffer_load_dwordx4 v8, s[16:19], s34 offen lds
    s_add_u32 m0, s32, 960
    s_add_u32 s37, s37, 1
    s_cmp_eq_u32 s37, 20
    s_cselect_b32 s37, 0, s37
    buffer_load_dwordx4 v8, s[16:19], s34 offen offset:64 lds
    v_mfma_f32_32x32x16_bf16 v[112:127], v[52:55], v[60:63], v[112:127]
    s_waitcnt lgkmcnt(0)
    ds_read_b128 v[48:51], v13 offset:0
    ds_read_b128 v[52:55], v13 offset:4096
    v_mfma_f32_32x32x16_bf16 v[64:79], v[32:35], v[40:43], v[64:79]
    ds_read_b64_tr_b16 v[56:57], v14 offset:12288
    ds_read_b64_tr_b16 v[58:59], v14 offset:12544
    v_mfma_f32_32x32x16_bf16 v[80:95], v[32:35], v[44:47], v[80:95]
    ds_read_b64_tr_b16 v[60:61], v14 offset:13312
    ds_read_b64_tr_b16 v[62:63], v14 offset:13568
    v_mfma_f32_32x32x16_bf16 v[96:111], v[36:39], v[40:43], v[96:111]
    v_mfma_f32_32x32x16_bf16 v[112:127], v[36:39], v[44:47], v[112:127]
    s_waitcnt vmcnt(8) lgkmcnt(0)
    s_barrier
    ds_read_b128 v[32:35], v10 offset:16384
    ds_read_b128 v[36:39], v10 offset:20480
    v_mfma_f32_32x32x16_bf16 v[64:79], v[48:51], v[56:59], v[64:79]
    ds_read_b64_tr_b16 v[40:41], v14 offset:16384
    ds_read_b64_tr_b16 v[42:43], v14 offset:16640
    v_mfma_f32_32x32x16_bf16 v[80:95], v[48:51], v[60:63], v[80:95]
    ds_read_b64_tr_b16 v[44:45], v14 offset:17408
    ds_read_b64_tr_b16 v[46:47], v14 offset:17664
    v_mfma_f32_32x32x16_bf16 v[96:111], v[52:55], v[56:59], v[96:111]
    s_add_u32 m0, s32, 8192
    s_mul_i32 s34, s37, 122880
    buffer_load_dwordx4 v8, s[16:19], s34 offen lds
    s_add_u32 m0, s32, 9152
    s_add_u32 s37, s37, 1
    s_cmp_eq_u32 s37, 20
    s_cselect_b32 s37, 0, s37
    buffer_load_dwordx4 v8, s[16:19], s34 offen offset:64 lds
    v_mfma_f32_32x32x16_bf16 v[112:127], v[52:55], v[60:63], v[112:127]
    s_add_u32 m0, s31, 0
    s_lshl_b32 s33, s38, 7
    buffer_load_dwordx4 v3, s[12:15], s33 offen lds
    s_add_u32 m0, s31, 1024
    s_nop 0
    buffer_load_dwordx4 v4, s[12:15], s33 offen lds
    s_waitcnt lgkmcnt(0)
    ds_read_b128 v[48:51], v11 offset:16384
    ds_read_b128 v[52:55], v11 offset:20480
    v_mfma_f32_32x32x16_bf16 v[64:79], v[32:35], v[40:43], v[64:79]
    ds_read_b64_tr_b16 v[56:57], v14 offset:20480
    ds_read_b64_tr_b16 v[58:59], v14 offset:20736
    v_mfma_f32_32x32x16_bf16 v[80:95], v[32:35], v[44:47], v[80:95]
    ds_read_b64_tr_b16 v[60:61], v14 offset:21504
    ds_read_b64_tr_b16 v[62:63], v14 offset:21760
    v_mfma_f32_32x32x16_bf16 v[96:111], v[36:39], v[40:43], v[96:111]
    s_add_u32 m0, s31, 2048
    s_add_u32 s33, s33, 20480
    buffer_load_dwordx4 v3, s[12:15], s33 offen lds
    s_add_u32 m0, s31, 3072
    s_add_u32 s38, s38, 1
    s_cmp_eq_u32 s38, 10
    s_cselect_b32 s38, 0, s38
    buffer_load_dwordx4 v4, s[12:15], s33 offen lds
    v_mfma_f32_32x32x16_bf16 v[112:127], v[36:39], v[44:47], v[112:127]
    s_waitcnt vmcnt(12) lgkmcnt(0)
    s_barrier
    ds_read_b128 v[32:35], v12 offset:16384
    ds_read_b128 v[36:39], v12 offset:20480
    v_mfma_f32_32x32x16_bf16 v[64:79], v[48:51], v[56:59], v[64:79]
    ds_read_b64_tr_b16 v[40:41], v14 offset:24576
    ds_read_b64_tr_b16 v[42:43], v14 offset:24832
    v_mfma_f32_32x32x16_bf16 v[80:95], v[48:51], v[60:63], v[80:95]
    ds_read_b64_tr_b16 v[44:45], v14 offset:25600
    ds_read_b64_tr_b16 v[46:47], v14 offset:25856
    v_mfma_f32_32x32x16_bf16 v[96:111], v[52:55], v[56:59], v[96:111]
    s_add_u32 m0, s32, 16384
    s_mul_i32 s34, s37, 122880
    buffer_load_dwordx4 v8, s[16:19], s34 offen lds
    s_add_u32 m0, s32, 17344
    s_add_u32 s37, s37, 1
    s_cmp_eq_u32 s37, 20
    s_cselect_b32 s37, 0, s37
    buffer_load_dwordx4 v8, s[16:19], s34 offen offset:64 lds
    v_mfma_f32_32x32x16_bf16 v[112:127], v[52:55], v[60:63], v[112:127]
    s_waitcnt lgkmcnt(0)
    ds_read_b128 v[48:51], v13 offset:16384
    ds_read_b128 v[52:55], v13 offset:20480
    v_mfma_f32_32x32x16_bf16 v[64:79], v[32:35], v[40:43], v[64:79]
    ds_read_b64_tr_b16 v[56:57], v14 offset:28672
    ds_read_b64_tr_b16 v[58:59], v14 offset:28928
    v_mfma_f32_32x32x16_bf16 v[80:95], v[32:35], v[44:47], v[80:95]
    ds_read_b64_tr_b16 v[60:61], v14 offset:29696
    ds_read_b64_tr_b16 v[62:63], v14 offset:29952
    v_mfma_f32_32x32x16_bf16 v[96:111], v[36:39], v[40:43], v[96:111]
    v_mfma_f32_32x32x16_bf16 v[112:127], v[36:39], v[44:47], v[112:127]
    s_waitcnt vmcnt(8) lgkmcnt(0)
    s_barrier
    ds_read_b128 v[32:35], v10 offset:32768
    ds_read_b128 v[36:39], v10 offset:36864
    v_mfma_f32_32x32x16_bf16 v[64:79], v[48:51], v[56:59], v[64:79]
    ds_read_b64_tr_b16 v[40:41], v14 offset:0
    ds_read_b64_tr_b16 v[42:43], v14 offset:256
    v_mfma_f32_32x32x16_bf16 v[80:95], v[48:51], v[60:63], v[80:95]
    ds_read_b64_tr_b16 v[44:45], v14 offset:1024
    ds_read_b64_tr_b16 v[46:47], v14 offset:1280
    v_mfma_f32_32x32x16_bf16 v[96:111], v[52:55], v[56:59], v[96:111]
    s_add_u32 m0, s32, 24576
    s_mul_i32 s34, s37, 122880
    buffer_load_dwordx4 v8, s[16:19], s34 offen lds
    s_add_u32 m0, s32, 25536
    s_add_u32 s37, s37, 1
    s_cmp_eq_u32 s37, 20
    s_cselect_b32 s37, 0, s37
    buffer_load_dwordx4 v8, s[16:19], s34 offen offset:64 lds
    v_mfma_f32_32x32x16_bf16 v[112:127], v[52:55], v[60:63], v[112:127]
    s_waitcnt lgkmcnt(0)
    ds_read_b128 v[48:51], v11 offset:32768
    ds_read_b128 v[52:55], v11 offset:36864
    v_mfma_f32_32x32x16_bf16 v[64:79], v[32:35], v[40:43], v[64:79]
    ds_read_b64_tr_b16 v[56:57], v14 offset:4096
    ds_read_b64_tr_b16 v[58:59], v14 offset:4352
    v_mfma_f32_32x32x16_bf16 v[80:95], v[32:35], v[44:47], v[80:95]
    ds_read_b64_tr_b16 v[60:61], v14 offset:5120
    ds_read_b64_tr_b16 v[62:63], v14 offset:5376
    v_mfma_f32_32x32x16_bf16 v[96:111], v[36:39], v[40:43], v[96:111]
    v_mfma_f32_32x32x16_bf16 v[112:127], v[36:39], v[44:47], v[112:127]
    s_waitcnt vmcnt(8) lgkmcnt(0)
    s_barrier
    ds_read_b128 v[32:35], v12 offset:32768
    ds_read_b128 v[36:39], v12 offset:36864
    v_mfma_f32_32x32x16_bf16 v[64:79], v[48:51], v[56:59], v[64:79]
    ds_read_b64_tr_b16 v[40:41], v14 offset:8192
    ds_read_b64_tr_b16 v[42:43], v14 offset:8448
    v_mfma_f32_32x32x16_bf16 v[80:95], v[48:51], v[60:63], v[80:95]
    ds_read_b64_tr_b16 v[44:45], v14 offset:9216
    ds_read_b64_tr_b16 v[46:47], v14 offset:9472
    v_mfma_f32_32x32x16_bf16 v[96:111], v[52:55], v[56:59], v[96:111]
    v_mfma_f32_32x32x16_bf16 v[112:127], v[52:55], v[60:63], v[112:127]
    s_waitcnt lgkmcnt(0)
    ds_read_b128 v[48:51], v13 offset:32768
    ds_read_b128 v[52:55], v13 offset:36864
    v_mfma_f32_32x32x16_bf16 v[64:79], v[32:35], v[40:43], v[64:79]
    ds_read_b64_tr_b16 v[56:57], v14 offset:12288
    ds_read_b64_tr_b16 v[58:59], v14 offset:12544
    v_mfma_f32_32x32x16_bf16 v[80:95], v[32:35], v[44:47], v[80:95]
    ds_read_b64_tr_b16 v[60:61], v14 offset:13312
    ds_read_b64_tr_b16 v[62:63], v14 offset:13568
    v_mfma_f32_32x32x16_bf16 v[96:111], v[36:39], v[40:43], v[96:111]
    v_mfma_f32_32x32x16_bf16 v[112:127], v[36:39], v[44:47], v[112:127]
    s_waitcnt vmcnt(2) lgkmcnt(0)
    s_barrier
    ds_read_b128 v[32:35], v10 offset:0
    ds_read_b128 v[36:39], v10 offset:4096
    v_mfma_f32_32x32x16_bf16 v[64:79], v[48:51], v[56:59], v[64:79]
    ds_read_b64_tr_b16 v[40:41], v14 offset:16384
    ds_read_b64_tr_b16 v[42:43], v14 offset:16640
    v_mfma_f32_32x32x16_bf16 v[80:95], v[48:51], v[60:63], v[80:95]
    ds_read_b64_tr_b16 v[44:45], v14 offset:17408
    ds_read_b64_tr_b16 v[46:47], v14 offset:17664
    v_mfma_f32_32x32x16_bf16 v[96:111], v[52:55], v[56:59], v[96:111]
    v_mfma_f32_32x32x16_bf16 v[112:127], v[52:55], v[60:63], v[112:127]
    s_waitcnt lgkmcnt(0)
    ds_read_b128 v[48:51], v11 offset:0
    ds_read_b128 v[52:55], v11 offset:4096
    v_mfma_f32_32x32x16_bf16 v[64:79], v[32:35], v[40:43], v[64:79]
    ds_read_b64_tr_b16 v[56:57], v14 offset:20480
    ds_read_b64_tr_b16 v[58:59], v14 offset:20736
    v_mfma_f32_32x32x16_bf16 v[80:95], v[32:35], v[44:47], v[80:95]
    ds_read_b64_tr_b16 v[60:61], v14 offset:21504
    ds_read_b64_tr_b16 v[62:63], v14 offset:21760
    v_mfma_f32_32x32x16_bf16 v[96:111], v[36:39], v[40:43], v[96:111]
    v_mfma_f32_32x32x16_bf16 v[112:127], v[36:39], v[44:47], v[112:127]
    s_waitcnt vmcnt(0) lgkmcnt(0)
    s_barrier
    ds_read_b128 v[32:35], v12 offset:0
    ds_read_b128 v[36:39], v12 offset:4096
    v_mfma_f32_32x32x16_bf16 v[64:79], v[48:51], v[56:59], v[64:79]
    ds_read_b64_tr_b16 v[40:41], v14 offset:24576
    ds_read_b64_tr_b16 v[42:43], v14 offset:24832
    v_mfma_f32_32x32x16_bf16 v[80:95], v[48:51], v[60:63], v[80:95]
    ds_read_b64_tr_b16 v[44:45], v14 offset:25600
    ds_read_b64_tr_b16 v[46:47], v14 offset:25856
    v_mfma_f32_32x32x16_bf16 v[96:111], v[52:55], v[56:59], v[96:111]
    v_mfma_f32_32x32x16_bf16 v[112:127], v[52:55], v[60:63], v[112:127]
    s_waitcnt lgkmcnt(0)
    ds_read_b128 v[48:51], v13 offset:0
    ds_read_b128 v[52:55], v13 offset:4096
    v_mfma_f32_32x32x16_bf16 v[64:79], v[32:35], v[40:43], v[64:79]
    ds_read_b64_tr_b16 v[56:57], v14 offset:28672
    ds_read_b64_tr_b16 v[58:59], v14 offset:28928
    v_mfma_f32_32x32x16_bf16 v[80:95], v[32:35], v[44:47], v[80:95]
    ds_read_b64_tr_b16 v[60:61], v14 offset:29696
    ds_read_b64_tr_b16 v[62:63], v14 offset:29952
    v_mfma_f32_32x32x16_bf16 v[96:111], v[36:39], v[40:43], v[96:111]
    v_mfma_f32_32x32x16_bf16 v[112:127], v[36:39], v[44:47], v[112:127]
    s_waitcnt lgkmcnt(0)
    v_mfma_f32_32x32x16_bf16 v[64:79], v[48:51], v[56:59], v[64:79]
    v_mfma_f32_32x32x16_bf16 v[80:95], v[48:51], v[60:63], v[80:95]
    v_mfma_f32_32x32x16_bf16 v[96:111], v[52:55], v[56:59], v[96:111]
    v_mfma_f32_32x32x16_bf16 v[112:127], v[52:55], v[60:63], v[112:127]
    buffer_load_dword v19, v18, s[52:55], 0 offen sc1
    s_nop 7
    s_nop 2
    v_cvt_pk_bf16_f32 v32, v64, v65
    v_cvt_pk_bf16_f32 v33, v66, v67
    v_cvt_pk_bf16_f32 v34, v68, v69
    v_cvt_pk_bf16_f32 v35, v70, v71
    buffer_store_dwordx4 v[32:35], v128, s[20:23], 0 offen offset:0 sc1
    v_cvt_pk_bf16_f32 v36, v72, v73
    v_cvt_pk_bf16_f32 v37, v74, v75
    v_cvt_pk_bf16_f32 v38, v76, v77
    v_cvt_pk_bf16_f32 v39, v78, v79
    buffer_store_dwordx4 v[36:39], v128, s[20:23], 0 offen offset:640 sc1
    v_cvt_pk_bf16_f32 v40, v80, v81
    v_cvt_pk_bf16_f32 v41, v82, v83
    v_cvt_pk_bf16_f32 v42, v84, v85
    v_cvt_pk_bf16_f32 v43, v86, v87
    buffer_store_dwordx4 v[40:43], v129, s[20:23], 0 offen offset:0 sc1
    v_cvt_pk_bf16_f32 v44, v88, v89
    v_cvt_pk_bf16_f32 v45, v90, v91
    v_cvt_pk_bf16_f32 v46, v92, v93
    v_cvt_pk_bf16_f32 v47, v94, v95
    buffer_store_dwordx4 v[44:47], v129, s[20:23], 0 offen offset:640 sc1
    v_cvt_pk_bf16_f32 v48, v96, v97
    v_cvt_pk_bf16_f32 v49, v98, v99
    v_cvt_pk_bf16_f32 v50, v100, v101
    v_cvt_pk_bf16_f32 v51, v102, v103
    buffer_store_dwordx4 v[48:51], v128, s[20:23], 0 offen offset:1280 sc1
    v_cvt_pk_bf16_f32 v52, v104, v105
    v_cvt_pk_bf16_f32 v53, v106, v107
    v_cvt_pk_bf16_f32 v54, v108, v109
    v_cvt_pk_bf16_f32 v55, v110, v111
    buffer_store_dwordx4 v[52:55], v128, s[20:23], 0 offen offset:1920 sc1
    v_cvt_pk_bf16_f32 v56, v112, v113
    v_cvt_pk_bf16_f32 v57, v114, v115
    v_cvt_pk_bf16_f32 v58, v116, v117
    v_cvt_pk_bf16_f32 v59, v118, v119
    buffer_store_dwordx4 v[56:59], v129, s[20:23], 0 offen offset:1280 sc1
    v_cvt_pk_bf16_f32 v60, v120, v121
    v_cvt_pk_bf16_f32 v61, v122, v123
    v_cvt_pk_bf16_f32 v62, v124, v125
    v_cvt_pk_bf16_f32 v63, v126, v127
    buffer_store_dwordx4 v[60:63], v129, s[20:23], 0 offen offset:1920 sc1
    s_branch A_publish
A_gate:
    s_load_dwordx2 s[34:35], s[0:1], 56
    s_waitcnt lgkmcnt(0)
    s_mov_b32 s12, s4
    s_mov_b32 s13, s5
    s_mov_b32 s14, 0x280000
    s_mov_b32 s15, 0x00020000
    s_mov_b32 s16, s34
    s_mov_b32 s17, s35
    s_mov_b32 s18, 0x500
    s_mov_b32 s19, 0x00020000
    s_add_u32 s20, s10, 0xa00000
    s_addc_u32 s21, s11, 0
    s_mov_b32 s22, 0x2000
    s_mov_b32 s23, 0x00020000
    s_add_u32 s60, s10, 0x1800000
    s_addc_u32 s61, s11, 0
    s_mov_b32 s62, 0x20000
    s_mov_b32 s63, 0x00020000
    s_mov_b32 s52, s8
    s_mov_b32 s53, s9
    s_mov_b32 s54, 0x100
    s_mov_b32 s55, 0x00020000
    v_and_b32 v5, 15, v2
    v_lshrrev_b32 v6, 4, v2
    v_lshlrev_b32 v7, 4, v5
    v_add_u32 v8, s30, v6
    v_mul_u32_u24 v9, 1280, v8
    v_add_u32 v9, v9, v7
    v_lshlrev_b32 v8, 2, v8
    buffer_load_dwordx4 v[20:23], v7, s[16:19], 0 offen offset:0
    buffer_load_dwordx4 v[24:27], v7, s[16:19], 0 offen offset:256
    buffer_load_dwordx4 v[28:31], v7, s[16:19], 0 offen offset:512
    buffer_load_dwordx4 v[32:35], v7, s[16:19], 0 offen offset:768
    buffer_load_dwordx4 v[36:39], v7, s[16:19], 0 offen offset:1024
    s_mov_b32 s33, 0
    buffer_load_dwordx4 v[40:43], v9, s[12:15], s33 offen offset:0
    buffer_load_dwordx4 v[44:47], v9, s[12:15], s33 offen offset:256
    buffer_load_dwordx4 v[48:51], v9, s[12:15], s33 offen offset:512
    buffer_load_dwordx4 v[52:55], v9, s[12:15], s33 offen offset:768
    buffer_load_dwordx4 v[56:59], v9, s[12:15], s33 offen offset:1024
    s_mov_b32 s33, 5120
    buffer_load_dwordx4 v[60:63], v9, s[12:15], s33 offen offset:0
    buffer_load_dwordx4 v[64:67], v9, s[12:15], s33 offen offset:256
    buffer_load_dwordx4 v[68:71], v9, s[12:15], s33 offen offset:512
    buffer_load_dwordx4 v[72:75], v9, s[12:15], s33 offen offset:768
    buffer_load_dwordx4 v[76:79], v9, s[12:15], s33 offen offset:1024
    s_mov_b32 s33, 10240
    buffer_load_dwordx4 v[80:83], v9, s[12:15], s33 offen offset:0
    buffer_load_dwordx4 v[84:87], v9, s[12:15], s33 offen offset:256
    buffer_load_dwordx4 v[88:91], v9, s[12:15], s33 offen offset:512
    buffer_load_dwordx4 v[92:95], v9, s[12:15], s33 offen offset:768
    buffer_load_dwordx4 v[96:99], v9, s[12:15], s33 offen offset:1024
    s_mov_b32 s33, 15360
    buffer_load_dwordx4 v[100:103], v9, s[12:15], s33 offen offset:0
    buffer_load_dwordx4 v[104:107], v9, s[12:15], s33 offen offset:256
    buffer_load_dwordx4 v[108:111], v9, s[12:15], s33 offen offset:512
    buffer_load_dwordx4 v[112:115], v9, s[12:15], s33 offen offset:768
    buffer_load_dwordx4 v[116:119], v9, s[12:15], s33 offen offset:1024
    s_mov_b32 s33, 20480
    buffer_load_dwordx4 v[120:123], v9, s[12:15], s33 offen offset:0
    buffer_load_dwordx4 v[124:127], v9, s[12:15], s33 offen offset:256
    buffer_load_dwordx4 v[128:131], v9, s[12:15], s33 offen offset:512
    buffer_load_dwordx4 v[132:135], v9, s[12:15], s33 offen offset:768
    buffer_load_dwordx4 v[136:139], v9, s[12:15], s33 offen offset:1024
    s_mov_b32 s33, 25600
    buffer_load_dwordx4 v[140:143], v9, s[12:15], s33 offen offset:0
    buffer_load_dwordx4 v[144:147], v9, s[12:15], s33 offen offset:256
    buffer_load_dwordx4 v[148:151], v9, s[12:15], s33 offen offset:512
    buffer_load_dwordx4 v[152:155], v9, s[12:15], s33 offen offset:768
    buffer_load_dwordx4 v[156:159], v9, s[12:15], s33 offen offset:1024
    s_mov_b32 s33, 30720
    buffer_load_dwordx4 v[160:163], v9, s[12:15], s33 offen offset:0
    buffer_load_dwordx4 v[164:167], v9, s[12:15], s33 offen offset:256
    buffer_load_dwordx4 v[168:171], v9, s[12:15], s33 offen offset:512
    buffer_load_dwordx4 v[172:175], v9, s[12:15], s33 offen offset:768
    buffer_load_dwordx4 v[176:179], v9, s[12:15], s33 offen offset:1024
    s_mov_b32 s33, 35840
    buffer_load_dwordx4 v[180:183], v9, s[12:15], s33 offen offset:0
    buffer_load_dwordx4 v[184:187], v9, s[12:15], s33 offen offset:256
    buffer_load_dwordx4 v[188:191], v9, s[12:15], s33 offen offset:512
    buffer_load_dwordx4 v[192:195], v9, s[12:15], s33 offen offset:768
    buffer_load_dwordx4 v[196:199], v9, s[12:15], s33 offen offset:1024
    v_mov_b32 v200, 0
    v_mov_b32 v201, 0
    v_mov_b32 v202, 0
    v_mov_b32 v203, 0
    v_mov_b32 v204, 0
    v_mov_b32 v205, 0
    v_mov_b32 v206, 0
    v_mov_b32 v207, 0
    s_waitcnt vmcnt(35)
    v_dot2_f32_bf16 v200, v40, v20, v200
    v_dot2_f32_bf16 v200, v41, v21, v200
    v_dot2_f32_bf16 v200, v42, v22, v200
    v_dot2_f32_bf16 v200, v43, v23, v200
    v_dot2_f32_bf16 v200, v44, v24, v200
    v_dot2_f32_bf16 v200, v45, v25, v200
    v_dot2_f32_bf16 v200, v46, v26, v200
    v_dot2_f32_bf16 v200, v47, v27, v200
    v_dot2_f32_bf16 v200, v48, v28, v200
    v_dot2_f32_bf16 v200, v49, v29, v200
    v_dot2_f32_bf16 v200, v50, v30, v200
    v_dot2_f32_bf16 v200, v51, v31, v200
    v_dot2_f32_bf16 v200, v52, v32, v200
    v_dot2_f32_bf16 v200, v53, v33, v200
    v_dot2_f32_bf16 v200, v54, v34, v200
    v_dot2_f32_bf16 v200, v55, v35, v200
    v_dot2_f32_bf16 v200, v56, v36, v200
    v_dot2_f32_bf16 v200, v57, v37, v200
    v_dot2_f32_bf16 v200, v58, v38, v200
    v_dot2_f32_bf16 v200, v59, v39, v200
    s_waitcnt vmcnt(30)
    v_dot2_f32_bf16 v201, v60, v20, v201
    v_dot2_f32_bf16 v201, v61, v21, v201
    v_dot2_f32_bf16 v201, v62, v22, v201
    v_dot2_f32_bf16 v201, v63, v23, v201
    v_dot2_f32_bf16 v201, v64, v24, v201
    v_dot2_f32_bf16 v201, v65, v25, v201
    v_dot2_f32_bf16 v201, v66, v26, v201
    v_dot2_f32_bf16 v201, v67, v27, v201
    v_dot2_f32_bf16 v201, v68, v28, v201
    v_dot2_f32_bf16 v201, v69, v29, v201
    v_dot2_f32_bf16 v201, v70, v30, v201
    v_dot2_f32_bf16 v201, v71, v31, v201
    v_dot2_f32_bf16 v201, v72, v32, v201
    v_dot2_f32_bf16 v201, v73, v33, v201
    v_dot2_f32_bf16 v201, v74, v34, v201
    v_dot2_f32_bf16 v201, v75, v35, v201
    v_dot2_f32_bf16 v201, v76, v36, v201
    v_dot2_f32_bf16 v201, v77, v37, v201
    v_dot2_f32_bf16 v201, v78, v38, v201
    v_dot2_f32_bf16 v201, v79, v39, v201
    s_waitcnt vmcnt(25)
    v_dot2_f32_bf16 v202, v80, v20, v202
    v_dot2_f32_bf16 v202, v81, v21, v202
    v_dot2_f32_bf16 v202, v82, v22, v202
    v_dot2_f32_bf16 v202, v83, v23, v202
    v_dot2_f32_bf16 v202, v84, v24, v202
    v_dot2_f32_bf16 v202, v85, v25, v202
    v_dot2_f32_bf16 v202, v86, v26, v202
    v_dot2_f32_bf16 v202, v87, v27, v202
    v_dot2_f32_bf16 v202, v88, v28, v202
    v_dot2_f32_bf16 v202, v89, v29, v202
    v_dot2_f32_bf16 v202, v90, v30, v202
    v_dot2_f32_bf16 v202, v91, v31, v202
    v_dot2_f32_bf16 v202, v92, v32, v202
    v_dot2_f32_bf16 v202, v93, v33, v202
    v_dot2_f32_bf16 v202, v94, v34, v202
    v_dot2_f32_bf16 v202, v95, v35, v202
    v_dot2_f32_bf16 v202, v96, v36, v202
    v_dot2_f32_bf16 v202, v97, v37, v202
    v_dot2_f32_bf16 v202, v98, v38, v202
    v_dot2_f32_bf16 v202, v99, v39, v202
    s_waitcnt vmcnt(20)
    v_dot2_f32_bf16 v203, v100, v20, v203
    v_dot2_f32_bf16 v203, v101, v21, v203
    v_dot2_f32_bf16 v203, v102, v22, v203
    v_dot2_f32_bf16 v203, v103, v23, v203
    v_dot2_f32_bf16 v203, v104, v24, v203
    v_dot2_f32_bf16 v203, v105, v25, v203
    v_dot2_f32_bf16 v203, v106, v26, v203
    v_dot2_f32_bf16 v203, v107, v27, v203
    v_dot2_f32_bf16 v203, v108, v28, v203
    v_dot2_f32_bf16 v203, v109, v29, v203
    v_dot2_f32_bf16 v203, v110, v30, v203
    v_dot2_f32_bf16 v203, v111, v31, v203
    v_dot2_f32_bf16 v203, v112, v32, v203
    v_dot2_f32_bf16 v203, v113, v33, v203
    v_dot2_f32_bf16 v203, v114, v34, v203
    v_dot2_f32_bf16 v203, v115, v35, v203
    v_dot2_f32_bf16 v203, v116, v36, v203
    v_dot2_f32_bf16 v203, v117, v37, v203
    v_dot2_f32_bf16 v203, v118, v38, v203
    v_dot2_f32_bf16 v203, v119, v39, v203
    s_waitcnt vmcnt(15)
    v_dot2_f32_bf16 v204, v120, v20, v204
    v_dot2_f32_bf16 v204, v121, v21, v204
    v_dot2_f32_bf16 v204, v122, v22, v204
    v_dot2_f32_bf16 v204, v123, v23, v204
    v_dot2_f32_bf16 v204, v124, v24, v204
    v_dot2_f32_bf16 v204, v125, v25, v204
    v_dot2_f32_bf16 v204, v126, v26, v204
    v_dot2_f32_bf16 v204, v127, v27, v204
    v_dot2_f32_bf16 v204, v128, v28, v204
    v_dot2_f32_bf16 v204, v129, v29, v204
    v_dot2_f32_bf16 v204, v130, v30, v204
    v_dot2_f32_bf16 v204, v131, v31, v204
    v_dot2_f32_bf16 v204, v132, v32, v204
    v_dot2_f32_bf16 v204, v133, v33, v204
    v_dot2_f32_bf16 v204, v134, v34, v204
    v_dot2_f32_bf16 v204, v135, v35, v204
    v_dot2_f32_bf16 v204, v136, v36, v204
    v_dot2_f32_bf16 v204, v137, v37, v204
    v_dot2_f32_bf16 v204, v138, v38, v204
    v_dot2_f32_bf16 v204, v139, v39, v204
    s_waitcnt vmcnt(10)
    v_dot2_f32_bf16 v205, v140, v20, v205
    v_dot2_f32_bf16 v205, v141, v21, v205
    v_dot2_f32_bf16 v205, v142, v22, v205
    v_dot2_f32_bf16 v205, v143, v23, v205
    v_dot2_f32_bf16 v205, v144, v24, v205
    v_dot2_f32_bf16 v205, v145, v25, v205
    v_dot2_f32_bf16 v205, v146, v26, v205
    v_dot2_f32_bf16 v205, v147, v27, v205
    v_dot2_f32_bf16 v205, v148, v28, v205
    v_dot2_f32_bf16 v205, v149, v29, v205
    v_dot2_f32_bf16 v205, v150, v30, v205
    v_dot2_f32_bf16 v205, v151, v31, v205
    v_dot2_f32_bf16 v205, v152, v32, v205
    v_dot2_f32_bf16 v205, v153, v33, v205
    v_dot2_f32_bf16 v205, v154, v34, v205
    v_dot2_f32_bf16 v205, v155, v35, v205
    v_dot2_f32_bf16 v205, v156, v36, v205
    v_dot2_f32_bf16 v205, v157, v37, v205
    v_dot2_f32_bf16 v205, v158, v38, v205
    v_dot2_f32_bf16 v205, v159, v39, v205
    s_waitcnt vmcnt(5)
    v_dot2_f32_bf16 v206, v160, v20, v206
    v_dot2_f32_bf16 v206, v161, v21, v206
    v_dot2_f32_bf16 v206, v162, v22, v206
    v_dot2_f32_bf16 v206, v163, v23, v206
    v_dot2_f32_bf16 v206, v164, v24, v206
    v_dot2_f32_bf16 v206, v165, v25, v206
    v_dot2_f32_bf16 v206, v166, v26, v206
    v_dot2_f32_bf16 v206, v167, v27, v206
    v_dot2_f32_bf16 v206, v168, v28, v206
    v_dot2_f32_bf16 v206, v169, v29, v206
    v_dot2_f32_bf16 v206, v170, v30, v206
    v_dot2_f32_bf16 v206, v171, v31, v206
    v_dot2_f32_bf16 v206, v172, v32, v206
    v_dot2_f32_bf16 v206, v173, v33, v206
    v_dot2_f32_bf16 v206, v174, v34, v206
    v_dot2_f32_bf16 v206, v175, v35, v206
    v_dot2_f32_bf16 v206, v176, v36, v206
    v_dot2_f32_bf16 v206, v177, v37, v206
    v_dot2_f32_bf16 v206, v178, v38, v206
    v_dot2_f32_bf16 v206, v179, v39, v206
    s_waitcnt vmcnt(0)
    v_dot2_f32_bf16 v207, v180, v20, v207
    v_dot2_f32_bf16 v207, v181, v21, v207
    v_dot2_f32_bf16 v207, v182, v22, v207
    v_dot2_f32_bf16 v207, v183, v23, v207
    v_dot2_f32_bf16 v207, v184, v24, v207
    v_dot2_f32_bf16 v207, v185, v25, v207
    v_dot2_f32_bf16 v207, v186, v26, v207
    v_dot2_f32_bf16 v207, v187, v27, v207
    v_dot2_f32_bf16 v207, v188, v28, v207
    v_dot2_f32_bf16 v207, v189, v29, v207
    v_dot2_f32_bf16 v207, v190, v30, v207
    v_dot2_f32_bf16 v207, v191, v31, v207
    v_dot2_f32_bf16 v207, v192, v32, v207
    v_dot2_f32_bf16 v207, v193, v33, v207
    v_dot2_f32_bf16 v207, v194, v34, v207
    v_dot2_f32_bf16 v207, v195, v35, v207
    v_dot2_f32_bf16 v207, v196, v36, v207
    v_dot2_f32_bf16 v207, v197, v37, v207
    v_dot2_f32_bf16 v207, v198, v38, v207
    v_dot2_f32_bf16 v207, v199, v39, v207
    s_nop 3
    v_add_f32_dpp v200, v200, v200 row_ror:8 row_mask:0xf bank_mask:0xf
    v_add_f32_dpp v201, v201, v201 row_ror:8 row_mask:0xf bank_mask:0xf
    v_add_f32_dpp v202, v202, v202 row_ror:8 row_mask:0xf bank_mask:0xf
    v_add_f32_dpp v203, v203, v203 row_ror:8 row_mask:0xf bank_mask:0xf
    v_add_f32_dpp v204, v204, v204 row_ror:8 row_mask:0xf bank_mask:0xf
    v_add_f32_dpp v205, v205, v205 row_ror:8 row_mask:0xf bank_mask:0xf
    v_add_f32_dpp v206, v206, v206 row_ror:8 row_mask:0xf bank_mask:0xf
    v_add_f32_dpp v207, v207, v207 row_ror:8 row_mask:0xf bank_mask:0xf
    v_add_f32_dpp v200, v200, v200 row_ror:4 row_mask:0xf bank_mask:0xf
    v_add_f32_dpp v201, v201, v201 row_ror:4 row_mask:0xf bank_mask:0xf
    v_add_f32_dpp v202, v202, v202 row_ror:4 row_mask:0xf bank_mask:0xf
    v_add_f32_dpp v203, v203, v203 row_ror:4 row_mask:0xf bank_mask:0xf
    v_add_f32_dpp v204, v204, v204 row_ror:4 row_mask:0xf bank_mask:0xf
    v_add_f32_dpp v205, v205, v205 row_ror:4 row_mask:0xf bank_mask:0xf
    v_add_f32_dpp v206, v206, v206 row_ror:4 row_mask:0xf bank_mask:0xf
    v_add_f32_dpp v207, v207, v207 row_ror:4 row_mask:0xf bank_mask:0xf
    v_add_f32_dpp v200, v200, v200 row_ror:2 row_mask:0xf bank_mask:0xf
    v_add_f32_dpp v201, v201, v201 row_ror:2 row_mask:0xf bank_mask:0xf
    v_add_f32_dpp v202, v202, v202 row_ror:2 row_mask:0xf bank_mask:0xf
    v_add_f32_dpp v203, v203, v203 row_ror:2 row_mask:0xf bank_mask:0xf
    v_add_f32_dpp v204, v204, v204 row_ror:2 row_mask:0xf bank_mask:0xf
    v_add_f32_dpp v205, v205, v205 row_ror:2 row_mask:0xf bank_mask:0xf
    v_add_f32_dpp v206, v206, v206 row_ror:2 row_mask:0xf bank_mask:0xf
    v_add_f32_dpp v207, v207, v207 row_ror:2 row_mask:0xf bank_mask:0xf
    v_add_f32_dpp v200, v200, v200 row_ror:1 row_mask:0xf bank_mask:0xf
    v_add_f32_dpp v201, v201, v201 row_ror:1 row_mask:0xf bank_mask:0xf
    v_add_f32_dpp v202, v202, v202 row_ror:1 row_mask:0xf bank_mask:0xf
    v_add_f32_dpp v203, v203, v203 row_ror:1 row_mask:0xf bank_mask:0xf
    v_add_f32_dpp v204, v204, v204 row_ror:1 row_mask:0xf bank_mask:0xf
    v_add_f32_dpp v205, v205, v205 row_ror:1 row_mask:0xf bank_mask:0xf
    v_add_f32_dpp v206, v206, v206 row_ror:1 row_mask:0xf bank_mask:0xf
    v_add_f32_dpp v207, v207, v207 row_ror:1 row_mask:0xf bank_mask:0xf
    s_mov_b32 s34, 0xbfb8aa3b
    v_mul_f32 v200, s34, v200
    v_mul_f32 v201, s34, v201
    v_mul_f32 v202, s34, v202
    v_mul_f32 v203, s34, v203
    v_mul_f32 v204, s34, v204
    v_mul_f32 v205, s34, v205
    v_mul_f32 v206, s34, v206
    v_mul_f32 v207, s34, v207
    v_exp_f32 v200, v200
    v_exp_f32 v201, v201
    v_exp_f32 v202, v202
    v_exp_f32 v203, v203
    v_exp_f32 v204, v204
    v_exp_f32 v205, v205
    v_exp_f32 v206, v206
    v_exp_f32 v207, v207
    v_add_f32 v200, 1.0, v200
    v_add_f32 v201, 1.0, v201
    v_add_f32 v202, 1.0, v202
    v_add_f32 v203, 1.0, v203
    v_add_f32 v204, 1.0, v204
    v_add_f32 v205, 1.0, v205
    v_add_f32 v206, 1.0, v206
    v_add_f32 v207, 1.0, v207
    v_rcp_f32 v200, v200
    v_rcp_f32 v201, v201
    v_rcp_f32 v202, v202
    v_rcp_f32 v203, v203
    v_rcp_f32 v204, v204
    v_rcp_f32 v205, v205
    v_rcp_f32 v206, v206
    v_rcp_f32 v207, v207
    v_cmp_eq_u32 vcc, 0, v5
    s_and_saveexec_b64 s[50:51], vcc
    buffer_store_dword v200, v8, s[20:23], 0 offen offset:0 sc1
    buffer_store_dword v201, v8, s[20:23], 0 offen offset:16 sc1
    buffer_store_dword v202, v8, s[20:23], 0 offen offset:32 sc1
    buffer_store_dword v203, v8, s[20:23], 0 offen offset:48 sc1
    buffer_store_dword v204, v8, s[20:23], 0 offen offset:64 sc1
    buffer_store_dword v205, v8, s[20:23], 0 offen offset:80 sc1
    buffer_store_dword v206, v8, s[20:23], 0 offen offset:96 sc1
    buffer_store_dword v207, v8, s[20:23], 0 offen offset:112 sc1
    s_mov_b64 exec, -1
    s_lshl_b32 s46, s26, 1
    s_add_u32 s46, s46, 32
    s_waitcnt vmcnt(0)
    s_barrier
    s_mov_b32 s52, s8
    s_mov_b32 s53, s9
    s_mov_b32 s54, 0x100
    s_mov_b32 s55, 0x00020000
    s_cmp_lg_u32 s28, 0
    s_cbranch_scc1 G_init_done
    v_mov_b32 v222, 0
    s_mov_b32 s59, 0
G_init:
    buffer_load_dword v223, v222, s[52:55], 0 offen sc1
    s_add_u32 s59, s59, 1
    s_waitcnt vmcnt(0)
    v_readfirstlane_b32 s58, v223
    s_cmp_lg_u32 s58, 0
    s_cbranch_scc1 G_init_done
    s_cmp_gt_u32 s59, 0x100000
    s_cbranch_scc1 G_init_done
    s_sleep 8
    s_branch G_init
G_init_done:
    s_cmp_lg_u32 s28, 0
    s_cbranch_scc1 G_sig
    s_lshl_b32 s58, s46, 8
    s_add_u32 s100, s60, s58
    s_addc_u32 s101, s61, 0
    s_mov_b32 s95, 0x20000
    s_atomic_add s95, s[100:101], 0
    s_atomic_add s95, s[100:101], 256
    G_sig:
    s_branch AT_start
A_publish:
    s_waitcnt vmcnt(0)
    v_readfirstlane_b32 s49, v19
    s_barrier
    s_cmp_lg_u32 s49, 0
    s_cbranch_scc1 A_init_done
    s_mov_b32 s52, s8
    s_mov_b32 s53, s9
    s_mov_b32 s54, 0x100
    s_mov_b32 s55, 0x00020000
    s_cmp_lg_u32 s28, 0
    s_cbranch_scc1 A_init_done
    v_mov_b32 v222, 0
    s_mov_b32 s59, 0
A_init:
    buffer_load_dword v223, v222, s[52:55], 0 offen sc1
    s_add_u32 s59, s59, 1
    s_waitcnt vmcnt(0)
    v_readfirstlane_b32 s58, v223
    s_cmp_lg_u32 s58, 0
    s_cbranch_scc1 A_init_done
    s_cmp_gt_u32 s59, 0x100000
    s_cbranch_scc1 A_init_done
    s_sleep 8
    s_branch A_init
A_init_done:
    s_cmp_lg_u32 s28, 0
    s_cbranch_scc1 A_sig
    s_lshl_b32 s58, s96, 8
    s_add_u32 s100, s60, s58
    s_addc_u32 s101, s61, 0
    s_mov_b32 s95, 0x20000
    s_atomic_add s95, s[100:101], 0
    s_atomic_add s95, s[100:101], 256
    s_atomic_add s95, s[100:101], 512
    s_atomic_add s95, s[100:101], 768
    s_atomic_add s95, s[100:101], 1024
    s_atomic_add s95, s[100:101], 1280
    s_atomic_add s95, s[100:101], 1536
    s_cmp_lg_u32 s97, 2
    s_cbranch_scc1 A_sig
    s_atomic_add s95, s[100:101], 1792
    A_sig:
AT_start:
    s_setprio 1
    s_and_b32 s24, s2, 31
    s_lshr_b32 s25, s2, 5
    v_and_b32 v3, 31, v0
    v_bfe_u32 v4, v0, 5, 1
    s_mul_i32 s26, s24, 163840
    s_mul_i32 s27, s25, 20480
    s_add_u32 s27, s27, s26
    v_lshlrev_b32 v5, 4, v2
    v_lshlrev_b32 v6, 4, v3
    s_mul_i32 s29, s28, 5120
    v_add_u32 v8, s29, v5
    v_add_u32 v9, 0x1000, v8
    s_lshl_b32 s30, s28, 11
    v_add_u32 v10, s30, v5
    s_lshl_b32 s30, s28, 9
    s_add_u32 s30, s30, 8192
    v_lshl_add_u32 v11, v4, 3, v6
    v_add_u32 v11, s30, v11
    s_mov_b32 s44, 0
    s_mov_b32 s46, 0x000fffff
    s_mov_b32 s47, 0x000fffff
    s_bitcmp1_b32 0x02081040, s24
    s_cselect_b32 s50, 96, 48
    s_lshl_b32 s50, s50, 17
    s_lshl_b32 s43, s24, 8
    s_add_u32 s51, s43, 0x6800
    v_mov_b32 v220, s51
    s_add_u32 s51, s2, 256
    s_add_u32 s27, s27, 0x500000
    s_add_u32 s16, s10, s27
    s_addc_u32 s17, s11, 0
    s_mov_b32 s18, 0x5000
    s_mov_b32 s19, 0x00020000
    s_add_u32 s12, s10, s26
    s_addc_u32 s13, s11, 0
    s_mov_b32 s14, 0x28000
    s_mov_b32 s15, 0x00020000
    s_add_u32 s32, s10, 0x1100000
    s_addc_u32 s33, s11, 0
    s_mov_b32 s34, 0x280000
    s_mov_b32 s35, 0x00020000
AT_pass:
    v_lshlrev_b32 v5, 4, v2
    v_add_u32 v7, 8192, v6
    v_mul_u32_u24 v13, 320, v4
    v_add_u32 v13, v13, v6
    v_add_u32 v13, 10240, v13
    v_or_b32 v1, 4, v3
    v_cmp_eq_u32 vcc, 28, v1
    v_mov_b32 v1, 0x3f803f80
    s_mov_b32 s36, 0
    v_cndmask_b32 v1, 0, v1, vcc
    s_mov_b32 s37, 0
    v_mov_b32 v188, v1
    v_mov_b32 v189, v1
    v_mov_b32 v190, v1
    v_mov_b32 v191, v1
    v_mov_b32 v192, v1
    v_mov_b32 v193, v1
    v_mov_b32 v194, v1
    v_mov_b32 v195, v1
    v_mov_b32 v196, v1
    v_mov_b32 v197, v1
    v_mov_b32 v198, v1
    v_mov_b32 v199, v1
    v_mov_b32 v200, v1
    v_mov_b32 v201, v1
    v_mov_b32 v202, v1
    v_mov_b32 v203, v1
    v_mov_b32 v204, v1
    v_mov_b32 v205, v1
    v_mov_b32 v206, v1
    v_mov_b32 v207, v1
    v_mov_b32 v208, v1
    v_mov_b32 v209, v1
    v_mov_b32 v210, v1
    v_mov_b32 v211, v1
    v_mov_b32 v212, v1
    v_mov_b32 v213, v1
    v_mov_b32 v214, v1
    v_mov_b32 v215, v1
    v_mov_b32 v216, v1
    v_mov_b32 v217, v1
    v_mov_b32 v218, v1
    v_mov_b32 v219, v1
    v_mov_b32 v112, 0
    v_mov_b32 v113, 0
    v_mov_b32 v114, 0
    v_mov_b32 v115, 0
    v_mov_b32 v116, 0
    v_mov_b32 v117, 0
    v_mov_b32 v118, 0
    v_mov_b32 v119, 0
    v_mov_b32 v120, 0
    v_mov_b32 v121, 0
    v_mov_b32 v122, 0
    v_mov_b32 v123, 0
    v_mov_b32 v124, 0
    v_mov_b32 v125, 0
    v_mov_b32 v126, 0
    v_mov_b32 v127, 0
    v_mov_b32 v128, 0
    v_mov_b32 v129, 0
    v_mov_b32 v130, 0
    v_mov_b32 v131, 0
    v_mov_b32 v132, 0
    v_mov_b32 v133, 0
    v_mov_b32 v134, 0
    v_mov_b32 v135, 0
    v_mov_b32 v136, 0
    v_mov_b32 v137, 0
    v_mov_b32 v138, 0
    v_mov_b32 v139, 0
    v_mov_b32 v140, 0
    v_mov_b32 v141, 0
    v_mov_b32 v142, 0
    v_mov_b32 v143, 0
    v_mov_b32 v76, 0
    v_mov_b32 v77, 0
    v_mov_b32 v78, 0
    v_mov_b32 v79, 0
    v_mov_b32 v156, 0
    v_mov_b32 v157, 0
    s_cmp_eq_u32 s44, 1
    s_cbranch_scc1 AT_nowait
    s_cmp_lg_u32 s28, 0
    s_cbranch_scc1 AT_poll_done
    s_add_u32 s98, s60, s43
    s_addc_u32 s99, s61, 0
    s_mov_b32 s59, 0
    AT_poll:
    s_load_dword s56, s[98:99], 34816 glc
    s_load_dword s57, s[98:99], 43008 glc
    s_load_dword s58, s[98:99], 51200 glc
    s_add_u32 s59, s59, 1
    s_waitcnt lgkmcnt(0)
    s_add_u32 s58, s58, s56
    s_add_u32 s58, s58, s57
    s_cmp_ge_u32 s58, s50
    s_cbranch_scc1 AT_poll_done
    s_cmp_gt_u32 s59, 0x100000
    s_cbranch_scc1 AT_poll_done
    s_sleep 2
    s_branch AT_poll
    AT_poll_done:
    s_cmp_lg_u32 s28, 0
    s_cbranch_scc1 AT_go
    s_lshl_b32 s58, s51, 8
    s_add_u32 s100, s60, s58
    s_addc_u32 s101, s61, 0
    s_mov_b32 s95, 0x20000
    s_atomic_add s95, s[100:101], 4
    AT_go:
    s_barrier
    buffer_load_dwordx4 v[160:163], v10, s[16:19], 0 offen sc1
    buffer_load_dwordx4 v[164:167], v10, s[16:19], 0 offen offset:1024 sc1
    buffer_load_dwordx2 v[168:169], v11, s[16:19], 0 offen sc1
AT_nowait:
    buffer_load_dwordx4 v[172:175], v5, s[12:15], 0 offen sc1
    buffer_load_dwordx4 v[180:183], v7, s[12:15], 0 offen sc1
    s_add_u32 m0, s37, s29
    s_nop 0
    buffer_load_dwordx4 v8, s[12:15], s36 offen sc1 lds
    buffer_load_dwordx4 v8, s[12:15], s36 offen offset:1024 sc1 lds
    buffer_load_dwordx4 v8, s[12:15], s36 offen offset:2048 sc1 lds
    buffer_load_dwordx4 v8, s[12:15], s36 offen offset:3072 sc1 lds
    s_add_u32 m0, m0, 0x1000
    s_nop 0
    buffer_load_dwordx4 v9, s[12:15], s36 offen sc1 lds
    s_add_u32 m0, m0, 16384
    s_add_u32 s45, s36, 20480
    buffer_load_dwordx4 v8, s[12:15], s45 offen sc1 lds
    buffer_load_dwordx4 v8, s[12:15], s45 offen offset:1024 sc1 lds
    buffer_load_dwordx4 v8, s[12:15], s45 offen offset:2048 sc1 lds
    buffer_load_dwordx4 v8, s[12:15], s45 offen offset:3072 sc1 lds
    s_add_u32 m0, m0, 0x1000
    s_nop 0
    buffer_load_dwordx4 v9, s[12:15], s45 offen sc1 lds
    s_mov_b32 s36, 40960
    s_mov_b32 s37, 40960
    s_waitcnt vmcnt(10)
    v_mfma_f32_32x32x16_bf16 v[16:31], v[172:175], v[160:163], 0
    v_mfma_f32_32x32x16_bf16 v[32:47], v[172:175], v[164:167], 0
    s_add_u32 m0, s37, s29
    s_nop 0
    buffer_load_dwordx4 v8, s[12:15], s36 offen sc1 lds
    buffer_load_dwordx4 v8, s[12:15], s36 offen offset:1024 sc1 lds
    buffer_load_dwordx4 v8, s[12:15], s36 offen offset:2048 sc1 lds
    buffer_load_dwordx4 v8, s[12:15], s36 offen offset:3072 sc1 lds
    s_add_u32 m0, m0, 0x1000
    s_nop 0
    buffer_load_dwordx4 v9, s[12:15], s36 offen sc1 lds
    s_nop 0
    v_mfma_f32_32x32x4_2b_bf16 v[16:47], v[180:181], v[168:169], v[16:47]
    s_add_u32 m0, m0, 16384
    s_add_u32 s45, s36, 20480
    buffer_load_dwordx4 v8, s[12:15], s45 offen sc1 lds
    buffer_load_dwordx4 v8, s[12:15], s45 offen offset:1024 sc1 lds
    buffer_load_dwordx4 v8, s[12:15], s45 offen offset:2048 sc1 lds
    buffer_load_dwordx4 v8, s[12:15], s45 offen offset:3072 sc1 lds
    s_add_u32 m0, m0, 0x1000
    s_nop 0
    buffer_load_dwordx4 v9, s[12:15], s45 offen sc1 lds
    s_mov_b32 s38, 0
    s_mov_b32 s39, 40960
    s_nop 6
    s_cmp_eq_u32 s44, 1
    s_cbranch_scc1 AT_havemax
    v_max3_f32 v80, v16, v17, v18
    v_max3_f32 v80, v80, v19, v20
    v_max3_f32 v80, v80, v21, v22
    v_max3_f32 v80, v80, v23, v24
    v_max3_f32 v80, v80, v25, v26
    v_max3_f32 v80, v80, v27, v28
    v_max3_f32 v80, v80, v29, v30
    v_max_f32 v80, v80, v31
    v_max3_f32 v96, v32, v33, v34
    v_max3_f32 v96, v96, v35, v36
    v_max3_f32 v96, v96, v37, v38
    v_max3_f32 v96, v96, v39, v40
    v_max3_f32 v96, v96, v41, v42
    v_max3_f32 v96, v96, v43, v44
    v_max3_f32 v96, v96, v45, v46
    v_max_f32 v96, v96, v47
    v_mov_b32 v81, v80
    v_mov_b32 v97, v96
    s_nop 1
    v_permlane32_swap_b32 v80, v81
    v_permlane32_swap_b32 v96, v97
    v_max_f32 v80, v80, v81
    v_sub_f32 v80, 0, v80
    v_max_f32 v96, v96, v97
    v_sub_f32 v96, 0, v96
    v_mov_b32 v81, v80
    v_mov_b32 v97, v96
    v_mov_b32 v82, v80
    v_mov_b32 v98, v96
    v_mov_b32 v83, v80
    v_mov_b32 v99, v96
    v_mov_b32 v84, v80
    v_mov_b32 v100, v96
    v_mov_b32 v85, v80
    v_mov_b32 v101, v96
    v_mov_b32 v86, v80
    v_mov_b32 v102, v96
    v_mov_b32 v87, v80
    v_mov_b32 v103, v96
    v_mov_b32 v88, v80
    v_mov_b32 v104, v96
    v_mov_b32 v89, v80
    v_mov_b32 v105, v96
    v_mov_b32 v90, v80
    v_mov_b32 v106, v96
    v_mov_b32 v91, v80
    v_mov_b32 v107, v96
    v_mov_b32 v92, v80
    v_mov_b32 v108, v96
    v_mov_b32 v93, v80
    v_mov_b32 v109, v96
    v_mov_b32 v94, v80
    v_mov_b32 v110, v96
    v_mov_b32 v95, v80
    v_mov_b32 v111, v96
AT_havemax:
    s_waitcnt vmcnt(10)
    s_barrier
    ds_read_b128 v[176:179], v5 offset:1024
    s_mov_b64 exec, s[46:47]
    ds_read_b128 v[188:191], v13 offset:0
    ds_read_b128 v[192:195], v13 offset:640
    ds_read_b128 v[196:199], v13 offset:1280
    ds_read_b128 v[200:203], v13 offset:1920
    s_mov_b64 exec, -1
    v_add_f32 v16, v16, v80
    v_add_f32 v17, v17, v81
    v_add_f32 v18, v18, v82
    v_add_f32 v19, v19, v83
    v_add_f32 v20, v20, v84
    v_add_f32 v21, v21, v85
    v_add_f32 v22, v22, v86
    v_add_f32 v23, v23, v87
    v_add_f32 v24, v24, v88
    v_add_f32 v25, v25, v89
    v_add_f32 v26, v26, v90
    v_add_f32 v27, v27, v91
    v_add_f32 v28, v28, v92
    v_add_f32 v29, v29, v93
    v_add_f32 v30, v30, v94
    v_add_f32 v31, v31, v95
    v_add_f32 v32, v32, v96
    v_add_f32 v33, v33, v97
    v_add_f32 v34, v34, v98
    v_add_f32 v35, v35, v99
    v_add_f32 v36, v36, v100
    v_add_f32 v37, v37, v101
    v_add_f32 v38, v38, v102
    v_add_f32 v39, v39, v103
    v_add_f32 v40, v40, v104
    v_add_f32 v41, v41, v105
    v_add_f32 v42, v42, v106
    v_add_f32 v43, v43, v107
    v_add_f32 v44, v44, v108
    v_add_f32 v45, v45, v109
    v_add_f32 v46, v46, v110
    v_add_f32 v47, v47, v111
    s_branch AT_mid
.p2align 6
AT_loop:
    s_waitcnt vmcnt(0) lgkmcnt(0)
    s_barrier
    v_add_u32 v5, s39, v5
    v_add_u32 v7, s39, v7
    v_add_u32 v13, s39, v13
    s_sub_u32 s39, 0, s39
    s_add_u32 s36, s36, 40960
    s_sub_u32 s37, 40960, s37
    v_exp_f32 v16, v16
    v_exp_f32 v17, v17
    v_exp_f32 v18, v18
    v_exp_f32 v19, v19
    v_cvt_pk_bf16_f32 v158, v76, v77
    v_cvt_pk_bf16_f32 v159, v78, v79
    s_waitcnt lgkmcnt(0)
    v_mfma_f32_32x32x16_bf16 v[48:63], v[176:179], v[160:163], v[80:95]
    v_exp_f32 v20, v20
    v_exp_f32 v21, v21
    v_exp_f32 v22, v22
    v_exp_f32 v23, v23
    v_cvt_pk_bf16_f32 v144, v16, v17
    v_cvt_pk_bf16_f32 v145, v18, v19
    v_mfma_f32_32x32x16_bf16 v[128:143], v[200:203], v[156:159], v[128:143]
    v_exp_f32 v24, v24
    v_exp_f32 v25, v25
    v_exp_f32 v26, v26
    v_exp_f32 v27, v27
    v_cvt_pk_bf16_f32 v146, v20, v21
    v_cvt_pk_bf16_f32 v147, v22, v23
    v_mfma_f32_32x32x16_bf16 v[64:79], v[176:179], v[164:167], v[96:111]
    s_mov_b64 exec, s[46:47]
    ds_read_b128 v[188:191], v13 offset:0
    ds_read_b128 v[192:195], v13 offset:640
    ds_read_b128 v[196:199], v13 offset:1280
    ds_read_b128 v[200:203], v13 offset:1920
    s_mov_b64 exec, -1
    v_exp_f32 v28, v28
    v_exp_f32 v29, v29
    v_exp_f32 v30, v30
    v_exp_f32 v31, v31
    v_cvt_pk_bf16_f32 v148, v24, v25
    v_cvt_pk_bf16_f32 v149, v26, v27
    v_mfma_f32_32x32x16_bf16 v[112:127], v[204:207], v[144:147], v[112:127]
    v_exp_f32 v32, v32
    v_exp_f32 v33, v33
    v_exp_f32 v34, v34
    v_exp_f32 v35, v35
    v_cvt_pk_bf16_f32 v150, v28, v29
    v_cvt_pk_bf16_f32 v151, v30, v31
    v_mfma_f32_32x32x4_2b_bf16 v[48:79], v[186:187], v[168:169], v[48:79]
    ds_read_b128 v[172:175], v5 offset:0
    ds_read_b128 v[180:183], v7 offset:0
    v_exp_f32 v36, v36
    v_exp_f32 v37, v37
    v_exp_f32 v38, v38
    v_exp_f32 v39, v39
    v_cvt_pk_bf16_f32 v152, v32, v33
    v_cvt_pk_bf16_f32 v153, v34, v35
    v_exp_f32 v40, v40
    v_exp_f32 v41, v41
    v_mfma_f32_32x32x16_bf16 v[112:127], v[208:211], v[148:151], v[112:127]
    v_exp_f32 v42, v42
    v_exp_f32 v43, v43
    v_cvt_pk_bf16_f32 v154, v36, v37
    v_cvt_pk_bf16_f32 v155, v38, v39
    v_exp_f32 v44, v44
    v_exp_f32 v45, v45
    v_mfma_f32_32x32x16_bf16 v[128:143], v[204:207], v[152:155], v[128:143]
    v_exp_f32 v46, v46
    v_exp_f32 v47, v47
    v_cvt_pk_bf16_f32 v156, v40, v41
    v_cvt_pk_bf16_f32 v157, v42, v43
    v_exp_f32 v48, v48
    v_exp_f32 v49, v49
    v_exp_f32 v50, v50
    v_exp_f32 v51, v51
    v_cvt_pk_bf16_f32 v158, v44, v45
    v_cvt_pk_bf16_f32 v159, v46, v47
    s_waitcnt lgkmcnt(0)
    v_mfma_f32_32x32x16_bf16 v[16:31], v[172:175], v[160:163], v[80:95]
    v_exp_f32 v52, v52
    v_exp_f32 v53, v53
    v_exp_f32 v54, v54
    v_exp_f32 v55, v55
    v_cvt_pk_bf16_f32 v144, v48, v49
    v_cvt_pk_bf16_f32 v145, v50, v51
    v_mfma_f32_32x32x16_bf16 v[128:143], v[208:211], v[156:159], v[128:143]
    v_exp_f32 v56, v56
    v_exp_f32 v57, v57
    v_exp_f32 v58, v58
    v_exp_f32 v59, v59
    v_cvt_pk_bf16_f32 v146, v52, v53
    v_cvt_pk_bf16_f32 v147, v54, v55
    v_mfma_f32_32x32x16_bf16 v[32:47], v[172:175], v[164:167], v[96:111]
    v_exp_f32 v60, v60
    v_exp_f32 v61, v61
    v_exp_f32 v62, v62
    v_exp_f32 v63, v63
    v_cvt_pk_bf16_f32 v148, v56, v57
    v_cvt_pk_bf16_f32 v149, v58, v59
    v_mfma_f32_32x32x16_bf16 v[112:127], v[212:215], v[144:147], v[112:127]
    v_exp_f32 v64, v64
    v_exp_f32 v65, v65
    v_exp_f32 v66, v66
    v_exp_f32 v67, v67
    v_cvt_pk_bf16_f32 v150, v60, v61
    v_cvt_pk_bf16_f32 v151, v62, v63
    v_mfma_f32_32x32x4_2b_bf16 v[16:47], v[180:181], v[168:169], v[16:47]
    ds_read_b128 v[176:179], v5 offset:1024
    v_exp_f32 v68, v68
    v_exp_f32 v69, v69
    v_exp_f32 v70, v70
    v_exp_f32 v71, v71
    v_cvt_pk_bf16_f32 v152, v64, v65
    v_cvt_pk_bf16_f32 v153, v66, v67
    v_exp_f32 v72, v72
    v_exp_f32 v73, v73
    v_mfma_f32_32x32x16_bf16 v[112:127], v[216:219], v[148:151], v[112:127]
    v_exp_f32 v74, v74
    v_exp_f32 v75, v75
    v_cvt_pk_bf16_f32 v154, v68, v69
    v_cvt_pk_bf16_f32 v155, v70, v71
    v_exp_f32 v76, v76
    v_exp_f32 v77, v77
    v_mfma_f32_32x32x16_bf16 v[128:143], v[212:215], v[152:155], v[128:143]
    v_exp_f32 v78, v78
    v_exp_f32 v79, v79
    v_cvt_pk_bf16_f32 v156, v72, v73
    v_cvt_pk_bf16_f32 v157, v74, v75
    s_cmp_eq_u32 s38, 4
    s_cbranch_scc1 AT_done
AT_mid:
    v_exp_f32 v16, v16
    v_exp_f32 v17, v17
    v_exp_f32 v18, v18
    v_exp_f32 v19, v19
    v_cvt_pk_bf16_f32 v158, v76, v77
    v_cvt_pk_bf16_f32 v159, v78, v79
    s_waitcnt lgkmcnt(0)
    v_mfma_f32_32x32x16_bf16 v[48:63], v[176:179], v[160:163], v[80:95]
    v_exp_f32 v20, v20
    v_exp_f32 v21, v21
    v_exp_f32 v22, v22
    v_exp_f32 v23, v23
    v_cvt_pk_bf16_f32 v144, v16, v17
    v_cvt_pk_bf16_f32 v145, v18, v19
    v_mfma_f32_32x32x16_bf16 v[128:143], v[216:219], v[156:159], v[128:143]
    v_exp_f32 v24, v24
    v_exp_f32 v25, v25
    v_exp_f32 v26, v26
    v_exp_f32 v27, v27
    v_cvt_pk_bf16_f32 v146, v20, v21
    v_cvt_pk_bf16_f32 v147, v22, v23
    v_mfma_f32_32x32x16_bf16 v[64:79], v[176:179], v[164:167], v[96:111]
    s_mov_b64 exec, s[46:47]
    ds_read_b128 v[204:207], v13 offset:2560
    ds_read_b128 v[208:211], v13 offset:3200
    ds_read_b128 v[212:215], v13 offset:3840
    ds_read_b128 v[216:219], v13 offset:4480
    s_mov_b64 exec, -1
    v_exp_f32 v28, v28
    v_exp_f32 v29, v29
    v_exp_f32 v30, v30
    v_exp_f32 v31, v31
    v_cvt_pk_bf16_f32 v148, v24, v25
    v_cvt_pk_bf16_f32 v149, v26, v27
    s_bitcmp1_b32 25, s38
    v_mfma_f32_32x32x16_bf16 v[112:127], v[188:191], v[144:147], v[112:127]
    s_cbranch_scc1 AT_nd2
    s_add_u32 m0, s37, s29
    s_nop 0
    buffer_load_dwordx4 v8, s[12:15], s36 offen sc1 lds
AT_nd2:
    v_exp_f32 v32, v32
    v_exp_f32 v33, v33
    v_exp_f32 v34, v34
    v_exp_f32 v35, v35
    v_cvt_pk_bf16_f32 v150, v28, v29
    v_cvt_pk_bf16_f32 v151, v30, v31
    v_mfma_f32_32x32x4_2b_bf16 v[48:79], v[182:183], v[168:169], v[48:79]
    ds_read_b128 v[172:175], v5 offset:2048
    ds_read_b128 v[184:187], v7 offset:512
    v_exp_f32 v36, v36
    v_exp_f32 v37, v37
    v_exp_f32 v38, v38
    v_exp_f32 v39, v39
    v_cvt_pk_bf16_f32 v152, v32, v33
    v_cvt_pk_bf16_f32 v153, v34, v35
    v_exp_f32 v40, v40
    v_exp_f32 v41, v41
    v_mfma_f32_32x32x16_bf16 v[112:127], v[192:195], v[148:151], v[112:127]
    v_exp_f32 v42, v42
    v_exp_f32 v43, v43
    v_cvt_pk_bf16_f32 v154, v36, v37
    v_cvt_pk_bf16_f32 v155, v38, v39
    v_exp_f32 v44, v44
    v_exp_f32 v45, v45
    v_mfma_f32_32x32x16_bf16 v[128:143], v[188:191], v[152:155], v[128:143]
    v_exp_f32 v46, v46
    v_exp_f32 v47, v47
    v_cvt_pk_bf16_f32 v156, v40, v41
    v_cvt_pk_bf16_f32 v157, v42, v43
    v_exp_f32 v48, v48
    v_exp_f32 v49, v49
    v_exp_f32 v50, v50
    v_exp_f32 v51, v51
    v_cvt_pk_bf16_f32 v158, v44, v45
    v_cvt_pk_bf16_f32 v159, v46, v47
    s_waitcnt lgkmcnt(0)
    v_mfma_f32_32x32x16_bf16 v[16:31], v[172:175], v[160:163], v[80:95]
    v_exp_f32 v52, v52
    v_exp_f32 v53, v53
    v_exp_f32 v54, v54
    v_exp_f32 v55, v55
    v_cvt_pk_bf16_f32 v144, v48, v49
    v_cvt_pk_bf16_f32 v145, v50, v51
    v_mfma_f32_32x32x16_bf16 v[128:143], v[192:195], v[156:159], v[128:143]
    v_exp_f32 v56, v56
    v_exp_f32 v57, v57
    v_exp_f32 v58, v58
    v_exp_f32 v59, v59
    v_cvt_pk_bf16_f32 v146, v52, v53
    v_cvt_pk_bf16_f32 v147, v54, v55
    v_mfma_f32_32x32x16_bf16 v[32:47], v[172:175], v[164:167], v[96:111]
    v_exp_f32 v60, v60
    v_exp_f32 v61, v61
    v_exp_f32 v62, v62
    v_exp_f32 v63, v63
    v_cvt_pk_bf16_f32 v148, v56, v57
    v_cvt_pk_bf16_f32 v149, v58, v59
    s_bitcmp1_b32 25, s38
    v_mfma_f32_32x32x16_bf16 v[112:127], v[196:199], v[144:147], v[112:127]
    s_cbranch_scc1 AT_nd3
    buffer_load_dwordx4 v8, s[12:15], s36 offen offset:1024 sc1 lds
AT_nd3:
    v_exp_f32 v64, v64
    v_exp_f32 v65, v65
    v_exp_f32 v66, v66
    v_exp_f32 v67, v67
    v_cvt_pk_bf16_f32 v150, v60, v61
    v_cvt_pk_bf16_f32 v151, v62, v63
    v_mfma_f32_32x32x4_2b_bf16 v[16:47], v[184:185], v[168:169], v[16:47]
    ds_read_b128 v[176:179], v5 offset:3072
    v_exp_f32 v68, v68
    v_exp_f32 v69, v69
    v_exp_f32 v70, v70
    v_exp_f32 v71, v71
    v_cvt_pk_bf16_f32 v152, v64, v65
    v_cvt_pk_bf16_f32 v153, v66, v67
    v_exp_f32 v72, v72
    v_exp_f32 v73, v73
    v_mfma_f32_32x32x16_bf16 v[112:127], v[200:203], v[148:151], v[112:127]
    v_exp_f32 v74, v74
    v_exp_f32 v75, v75
    v_cvt_pk_bf16_f32 v154, v68, v69
    v_cvt_pk_bf16_f32 v155, v70, v71
    v_exp_f32 v76, v76
    v_exp_f32 v77, v77
    v_mfma_f32_32x32x16_bf16 v[128:143], v[196:199], v[152:155], v[128:143]
    v_exp_f32 v78, v78
    v_exp_f32 v79, v79
    v_cvt_pk_bf16_f32 v156, v72, v73
    v_cvt_pk_bf16_f32 v157, v74, v75
    v_exp_f32 v16, v16
    v_exp_f32 v17, v17
    v_exp_f32 v18, v18
    v_exp_f32 v19, v19
    v_cvt_pk_bf16_f32 v158, v76, v77
    v_cvt_pk_bf16_f32 v159, v78, v79
    s_waitcnt lgkmcnt(0)
    v_mfma_f32_32x32x16_bf16 v[48:63], v[176:179], v[160:163], v[80:95]
    v_exp_f32 v20, v20
    v_exp_f32 v21, v21
    v_exp_f32 v22, v22
    v_exp_f32 v23, v23
    v_cvt_pk_bf16_f32 v144, v16, v17
    v_cvt_pk_bf16_f32 v145, v18, v19
    v_mfma_f32_32x32x16_bf16 v[128:143], v[200:203], v[156:159], v[128:143]
    v_exp_f32 v24, v24
    v_exp_f32 v25, v25
    v_exp_f32 v26, v26
    v_exp_f32 v27, v27
    v_cvt_pk_bf16_f32 v146, v20, v21
    v_cvt_pk_bf16_f32 v147, v22, v23
    v_mfma_f32_32x32x16_bf16 v[64:79], v[176:179], v[164:167], v[96:111]
    s_mov_b64 exec, s[46:47]
    ds_read_b128 v[188:191], v13 offset:5120
    ds_read_b128 v[192:195], v13 offset:5760
    ds_read_b128 v[196:199], v13 offset:6400
    ds_read_b128 v[200:203], v13 offset:7040
    s_mov_b64 exec, -1
    v_exp_f32 v28, v28
    v_exp_f32 v29, v29
    v_exp_f32 v30, v30
    v_exp_f32 v31, v31
    v_cvt_pk_bf16_f32 v148, v24, v25
    v_cvt_pk_bf16_f32 v149, v26, v27
    s_bitcmp1_b32 25, s38
    v_mfma_f32_32x32x16_bf16 v[112:127], v[204:207], v[144:147], v[112:127]
    s_cbranch_scc1 AT_nd4
    buffer_load_dwordx4 v8, s[12:15], s36 offen offset:2048 sc1 lds
AT_nd4:
    v_exp_f32 v32, v32
    v_exp_f32 v33, v33
    v_exp_f32 v34, v34
    v_exp_f32 v35, v35
    v_cvt_pk_bf16_f32 v150, v28, v29
    v_cvt_pk_bf16_f32 v151, v30, v31
    v_mfma_f32_32x32x4_2b_bf16 v[48:79], v[186:187], v[168:169], v[48:79]
    ds_read_b128 v[172:175], v5 offset:4096
    ds_read_b128 v[180:183], v7 offset:1024
    v_exp_f32 v36, v36
    v_exp_f32 v37, v37
    v_exp_f32 v38, v38
    v_exp_f32 v39, v39
    v_cvt_pk_bf16_f32 v152, v32, v33
    v_cvt_pk_bf16_f32 v153, v34, v35
    v_exp_f32 v40, v40
    v_exp_f32 v41, v41
    v_mfma_f32_32x32x16_bf16 v[112:127], v[208:211], v[148:151], v[112:127]
    v_exp_f32 v42, v42
    v_exp_f32 v43, v43
    v_cvt_pk_bf16_f32 v154, v36, v37
    v_cvt_pk_bf16_f32 v155, v38, v39
    v_exp_f32 v44, v44
    v_exp_f32 v45, v45
    v_mfma_f32_32x32x16_bf16 v[128:143], v[204:207], v[152:155], v[128:143]
    v_exp_f32 v46, v46
    v_exp_f32 v47, v47
    v_cvt_pk_bf16_f32 v156, v40, v41
    v_cvt_pk_bf16_f32 v157, v42, v43
    v_exp_f32 v48, v48
    v_exp_f32 v49, v49
    v_exp_f32 v50, v50
    v_exp_f32 v51, v51
    v_cvt_pk_bf16_f32 v158, v44, v45
    v_cvt_pk_bf16_f32 v159, v46, v47
    s_waitcnt lgkmcnt(0)
    v_mfma_f32_32x32x16_bf16 v[16:31], v[172:175], v[160:163], v[80:95]
    v_exp_f32 v52, v52
    v_exp_f32 v53, v53
    v_exp_f32 v54, v54
    v_exp_f32 v55, v55
    v_cvt_pk_bf16_f32 v144, v48, v49
    v_cvt_pk_bf16_f32 v145, v50, v51
    v_mfma_f32_32x32x16_bf16 v[128:143], v[208:211], v[156:159], v[128:143]
    v_exp_f32 v56, v56
    v_exp_f32 v57, v57
    v_exp_f32 v58, v58
    v_exp_f32 v59, v59
    v_cvt_pk_bf16_f32 v146, v52, v53
    v_cvt_pk_bf16_f32 v147, v54, v55
    v_mfma_f32_32x32x16_bf16 v[32:47], v[172:175], v[164:167], v[96:111]
    v_exp_f32 v60, v60
    v_exp_f32 v61, v61
    v_exp_f32 v62, v62
    v_exp_f32 v63, v63
    v_cvt_pk_bf16_f32 v148, v56, v57
    v_cvt_pk_bf16_f32 v149, v58, v59
    s_bitcmp1_b32 25, s38
    v_mfma_f32_32x32x16_bf16 v[112:127], v[212:215], v[144:147], v[112:127]
    s_cbranch_scc1 AT_nd5
    buffer_load_dwordx4 v8, s[12:15], s36 offen offset:3072 sc1 lds
AT_nd5:
    v_exp_f32 v64, v64
    v_exp_f32 v65, v65
    v_exp_f32 v66, v66
    v_exp_f32 v67, v67
    v_cvt_pk_bf16_f32 v150, v60, v61
    v_cvt_pk_bf16_f32 v151, v62, v63
    v_mfma_f32_32x32x4_2b_bf16 v[16:47], v[180:181], v[168:169], v[16:47]
    ds_read_b128 v[176:179], v5 offset:5120
    v_exp_f32 v68, v68
    v_exp_f32 v69, v69
    v_exp_f32 v70, v70
    v_exp_f32 v71, v71
    v_cvt_pk_bf16_f32 v152, v64, v65
    v_cvt_pk_bf16_f32 v153, v66, v67
    v_exp_f32 v72, v72
    v_exp_f32 v73, v73
    v_mfma_f32_32x32x16_bf16 v[112:127], v[216:219], v[148:151], v[112:127]
    v_exp_f32 v74, v74
    v_exp_f32 v75, v75
    v_cvt_pk_bf16_f32 v154, v68, v69
    v_cvt_pk_bf16_f32 v155, v70, v71
    v_exp_f32 v76, v76
    v_exp_f32 v77, v77
    v_mfma_f32_32x32x16_bf16 v[128:143], v[212:215], v[152:155], v[128:143]
    v_exp_f32 v78, v78
    v_exp_f32 v79, v79
    v_cvt_pk_bf16_f32 v156, v72, v73
    v_cvt_pk_bf16_f32 v157, v74, v75
    v_exp_f32 v16, v16
    v_exp_f32 v17, v17
    v_exp_f32 v18, v18
    v_exp_f32 v19, v19
    v_cvt_pk_bf16_f32 v158, v76, v77
    v_cvt_pk_bf16_f32 v159, v78, v79
    s_waitcnt lgkmcnt(0)
    v_mfma_f32_32x32x16_bf16 v[48:63], v[176:179], v[160:163], v[80:95]
    v_exp_f32 v20, v20
    v_exp_f32 v21, v21
    v_exp_f32 v22, v22
    v_exp_f32 v23, v23
    v_cvt_pk_bf16_f32 v144, v16, v17
    v_cvt_pk_bf16_f32 v145, v18, v19
    v_mfma_f32_32x32x16_bf16 v[128:143], v[216:219], v[156:159], v[128:143]
    v_exp_f32 v24, v24
    v_exp_f32 v25, v25
    v_exp_f32 v26, v26
    v_exp_f32 v27, v27
    v_cvt_pk_bf16_f32 v146, v20, v21
    v_cvt_pk_bf16_f32 v147, v22, v23
    v_mfma_f32_32x32x16_bf16 v[64:79], v[176:179], v[164:167], v[96:111]
    s_mov_b64 exec, s[46:47]
    ds_read_b128 v[204:207], v13 offset:7680
    ds_read_b128 v[208:211], v13 offset:8320
    ds_read_b128 v[212:215], v13 offset:8960
    ds_read_b128 v[216:219], v13 offset:9600
    s_mov_b64 exec, -1
    v_exp_f32 v28, v28
    v_exp_f32 v29, v29
    v_exp_f32 v30, v30
    v_exp_f32 v31, v31
    v_cvt_pk_bf16_f32 v148, v24, v25
    v_cvt_pk_bf16_f32 v149, v26, v27
    s_bitcmp1_b32 25, s38
    v_mfma_f32_32x32x16_bf16 v[112:127], v[188:191], v[144:147], v[112:127]
    s_cbranch_scc1 AT_nd6
    s_add_u32 m0, m0, 0x1000
    s_nop 0
    buffer_load_dwordx4 v9, s[12:15], s36 offen sc1 lds
AT_nd6:
    v_exp_f32 v32, v32
    v_exp_f32 v33, v33
    v_exp_f32 v34, v34
    v_exp_f32 v35, v35
    v_cvt_pk_bf16_f32 v150, v28, v29
    v_cvt_pk_bf16_f32 v151, v30, v31
    v_mfma_f32_32x32x4_2b_bf16 v[48:79], v[182:183], v[168:169], v[48:79]
    ds_read_b128 v[172:175], v5 offset:6144
    ds_read_b128 v[184:187], v7 offset:1536
    v_exp_f32 v36, v36
    v_exp_f32 v37, v37
    v_exp_f32 v38, v38
    v_exp_f32 v39, v39
    v_cvt_pk_bf16_f32 v152, v32, v33
    v_cvt_pk_bf16_f32 v153, v34, v35
    v_exp_f32 v40, v40
    v_exp_f32 v41, v41
    v_mfma_f32_32x32x16_bf16 v[112:127], v[192:195], v[148:151], v[112:127]
    v_exp_f32 v42, v42
    v_exp_f32 v43, v43
    v_cvt_pk_bf16_f32 v154, v36, v37
    v_cvt_pk_bf16_f32 v155, v38, v39
    v_exp_f32 v44, v44
    v_exp_f32 v45, v45
    v_mfma_f32_32x32x16_bf16 v[128:143], v[188:191], v[152:155], v[128:143]
    v_exp_f32 v46, v46
    v_exp_f32 v47, v47
    v_cvt_pk_bf16_f32 v156, v40, v41
    v_cvt_pk_bf16_f32 v157, v42, v43
    v_exp_f32 v48, v48
    v_exp_f32 v49, v49
    v_exp_f32 v50, v50
    v_exp_f32 v51, v51
    v_cvt_pk_bf16_f32 v158, v44, v45
    v_cvt_pk_bf16_f32 v159, v46, v47
    s_waitcnt lgkmcnt(0)
    v_mfma_f32_32x32x16_bf16 v[16:31], v[172:175], v[160:163], v[80:95]
    v_exp_f32 v52, v52
    v_exp_f32 v53, v53
    v_exp_f32 v54, v54
    v_exp_f32 v55, v55
    v_cvt_pk_bf16_f32 v144, v48, v49
    v_cvt_pk_bf16_f32 v145, v50, v51
    v_mfma_f32_32x32x16_bf16 v[128:143], v[192:195], v[156:159], v[128:143]
    v_exp_f32 v56, v56
    v_exp_f32 v57, v57
    v_exp_f32 v58, v58
    v_exp_f32 v59, v59
    v_cvt_pk_bf16_f32 v146, v52, v53
    v_cvt_pk_bf16_f32 v147, v54, v55
    v_mfma_f32_32x32x16_bf16 v[32:47], v[172:175], v[164:167], v[96:111]
    v_exp_f32 v60, v60
    v_exp_f32 v61, v61
    v_exp_f32 v62, v62
    v_exp_f32 v63, v63
    v_cvt_pk_bf16_f32 v148, v56, v57
    v_cvt_pk_bf16_f32 v149, v58, v59
    s_bitcmp1_b32 25, s38
    v_mfma_f32_32x32x16_bf16 v[112:127], v[196:199], v[144:147], v[112:127]
    s_cbranch_scc1 AT_nd7
    s_add_u32 m0, m0, 16384
    s_add_u32 s45, s36, 20480
    buffer_load_dwordx4 v8, s[12:15], s45 offen sc1 lds
AT_nd7:
    v_exp_f32 v64, v64
    v_exp_f32 v65, v65
    v_exp_f32 v66, v66
    v_exp_f32 v67, v67
    v_cvt_pk_bf16_f32 v150, v60, v61
    v_cvt_pk_bf16_f32 v151, v62, v63
    v_mfma_f32_32x32x4_2b_bf16 v[16:47], v[184:185], v[168:169], v[16:47]
    ds_read_b128 v[176:179], v5 offset:7168
    v_exp_f32 v68, v68
    v_exp_f32 v69, v69
    v_exp_f32 v70, v70
    v_exp_f32 v71, v71
    v_cvt_pk_bf16_f32 v152, v64, v65
    v_cvt_pk_bf16_f32 v153, v66, v67
    v_exp_f32 v72, v72
    v_exp_f32 v73, v73
    v_mfma_f32_32x32x16_bf16 v[112:127], v[200:203], v[148:151], v[112:127]
    v_exp_f32 v74, v74
    v_exp_f32 v75, v75
    v_cvt_pk_bf16_f32 v154, v68, v69
    v_cvt_pk_bf16_f32 v155, v70, v71
    v_exp_f32 v76, v76
    v_exp_f32 v77, v77
    v_mfma_f32_32x32x16_bf16 v[128:143], v[196:199], v[152:155], v[128:143]
    v_exp_f32 v78, v78
    v_exp_f32 v79, v79
    v_cvt_pk_bf16_f32 v156, v72, v73
    v_cvt_pk_bf16_f32 v157, v74, v75
    v_exp_f32 v16, v16
    v_exp_f32 v17, v17
    v_exp_f32 v18, v18
    v_exp_f32 v19, v19
    v_cvt_pk_bf16_f32 v158, v76, v77
    v_cvt_pk_bf16_f32 v159, v78, v79
    s_waitcnt lgkmcnt(0)
    v_mfma_f32_32x32x16_bf16 v[48:63], v[176:179], v[160:163], v[80:95]
    v_exp_f32 v20, v20
    v_exp_f32 v21, v21
    v_exp_f32 v22, v22
    v_exp_f32 v23, v23
    v_cvt_pk_bf16_f32 v144, v16, v17
    v_cvt_pk_bf16_f32 v145, v18, v19
    v_mfma_f32_32x32x16_bf16 v[128:143], v[200:203], v[156:159], v[128:143]
    v_exp_f32 v24, v24
    v_exp_f32 v25, v25
    v_exp_f32 v26, v26
    v_exp_f32 v27, v27
    v_cvt_pk_bf16_f32 v146, v20, v21
    v_cvt_pk_bf16_f32 v147, v22, v23
    v_mfma_f32_32x32x16_bf16 v[64:79], v[176:179], v[164:167], v[96:111]
    s_mov_b64 exec, s[46:47]
    ds_read_b128 v[188:191], v13 offset:20480
    ds_read_b128 v[192:195], v13 offset:21120
    ds_read_b128 v[196:199], v13 offset:21760
    ds_read_b128 v[200:203], v13 offset:22400
    s_mov_b64 exec, -1
    v_exp_f32 v28, v28
    v_exp_f32 v29, v29
    v_exp_f32 v30, v30
    v_exp_f32 v31, v31
    v_cvt_pk_bf16_f32 v148, v24, v25
    v_cvt_pk_bf16_f32 v149, v26, v27
    s_bitcmp1_b32 25, s38
    v_mfma_f32_32x32x16_bf16 v[112:127], v[204:207], v[144:147], v[112:127]
    s_cbranch_scc1 AT_nd8
    buffer_load_dwordx4 v8, s[12:15], s45 offen offset:1024 sc1 lds
AT_nd8:
    v_exp_f32 v32, v32
    v_exp_f32 v33, v33
    v_exp_f32 v34, v34
    v_exp_f32 v35, v35
    v_cvt_pk_bf16_f32 v150, v28, v29
    v_cvt_pk_bf16_f32 v151, v30, v31
    v_mfma_f32_32x32x4_2b_bf16 v[48:79], v[186:187], v[168:169], v[48:79]
    ds_read_b128 v[172:175], v5 offset:20480
    ds_read_b128 v[180:183], v7 offset:20480
    v_exp_f32 v36, v36
    v_exp_f32 v37, v37
    v_exp_f32 v38, v38
    v_exp_f32 v39, v39
    v_cvt_pk_bf16_f32 v152, v32, v33
    v_cvt_pk_bf16_f32 v153, v34, v35
    v_exp_f32 v40, v40
    v_exp_f32 v41, v41
    v_mfma_f32_32x32x16_bf16 v[112:127], v[208:211], v[148:151], v[112:127]
    v_exp_f32 v42, v42
    v_exp_f32 v43, v43
    v_cvt_pk_bf16_f32 v154, v36, v37
    v_cvt_pk_bf16_f32 v155, v38, v39
    v_exp_f32 v44, v44
    v_exp_f32 v45, v45
    v_mfma_f32_32x32x16_bf16 v[128:143], v[204:207], v[152:155], v[128:143]
    v_exp_f32 v46, v46
    v_exp_f32 v47, v47
    v_cvt_pk_bf16_f32 v156, v40, v41
    v_cvt_pk_bf16_f32 v157, v42, v43
    v_exp_f32 v48, v48
    v_exp_f32 v49, v49
    v_exp_f32 v50, v50
    v_exp_f32 v51, v51
    v_cvt_pk_bf16_f32 v158, v44, v45
    v_cvt_pk_bf16_f32 v159, v46, v47
    s_waitcnt lgkmcnt(0)
    v_mfma_f32_32x32x16_bf16 v[16:31], v[172:175], v[160:163], v[80:95]
    v_exp_f32 v52, v52
    v_exp_f32 v53, v53
    v_exp_f32 v54, v54
    v_exp_f32 v55, v55
    v_cvt_pk_bf16_f32 v144, v48, v49
    v_cvt_pk_bf16_f32 v145, v50, v51
    v_mfma_f32_32x32x16_bf16 v[128:143], v[208:211], v[156:159], v[128:143]
    v_exp_f32 v56, v56
    v_exp_f32 v57, v57
    v_exp_f32 v58, v58
    v_exp_f32 v59, v59
    v_cvt_pk_bf16_f32 v146, v52, v53
    v_cvt_pk_bf16_f32 v147, v54, v55
    v_mfma_f32_32x32x16_bf16 v[32:47], v[172:175], v[164:167], v[96:111]
    v_exp_f32 v60, v60
    v_exp_f32 v61, v61
    v_exp_f32 v62, v62
    v_exp_f32 v63, v63
    v_cvt_pk_bf16_f32 v148, v56, v57
    v_cvt_pk_bf16_f32 v149, v58, v59
    s_bitcmp1_b32 25, s38
    v_mfma_f32_32x32x16_bf16 v[112:127], v[212:215], v[144:147], v[112:127]
    s_cbranch_scc1 AT_nd9
    buffer_load_dwordx4 v8, s[12:15], s45 offen offset:2048 sc1 lds
AT_nd9:
    v_exp_f32 v64, v64
    v_exp_f32 v65, v65
    v_exp_f32 v66, v66
    v_exp_f32 v67, v67
    v_cvt_pk_bf16_f32 v150, v60, v61
    v_cvt_pk_bf16_f32 v151, v62, v63
    v_mfma_f32_32x32x4_2b_bf16 v[16:47], v[180:181], v[168:169], v[16:47]
    ds_read_b128 v[176:179], v5 offset:21504
    v_exp_f32 v68, v68
    v_exp_f32 v69, v69
    v_exp_f32 v70, v70
    v_exp_f32 v71, v71
    v_cvt_pk_bf16_f32 v152, v64, v65
    v_cvt_pk_bf16_f32 v153, v66, v67
    v_exp_f32 v72, v72
    v_exp_f32 v73, v73
    v_mfma_f32_32x32x16_bf16 v[112:127], v[216:219], v[148:151], v[112:127]
    v_exp_f32 v74, v74
    v_exp_f32 v75, v75
    v_cvt_pk_bf16_f32 v154, v68, v69
    v_cvt_pk_bf16_f32 v155, v70, v71
    v_exp_f32 v76, v76
    v_exp_f32 v77, v77
    v_mfma_f32_32x32x16_bf16 v[128:143], v[212:215], v[152:155], v[128:143]
    v_exp_f32 v78, v78
    v_exp_f32 v79, v79
    v_cvt_pk_bf16_f32 v156, v72, v73
    v_cvt_pk_bf16_f32 v157, v74, v75
    v_exp_f32 v16, v16
    v_exp_f32 v17, v17
    v_exp_f32 v18, v18
    v_exp_f32 v19, v19
    v_cvt_pk_bf16_f32 v158, v76, v77
    v_cvt_pk_bf16_f32 v159, v78, v79
    s_waitcnt lgkmcnt(0)
    v_mfma_f32_32x32x16_bf16 v[48:63], v[176:179], v[160:163], v[80:95]
    v_exp_f32 v20, v20
    v_exp_f32 v21, v21
    v_exp_f32 v22, v22
    v_exp_f32 v23, v23
    v_cvt_pk_bf16_f32 v144, v16, v17
    v_cvt_pk_bf16_f32 v145, v18, v19
    v_mfma_f32_32x32x16_bf16 v[128:143], v[216:219], v[156:159], v[128:143]
    v_exp_f32 v24, v24
    v_exp_f32 v25, v25
    v_exp_f32 v26, v26
    v_exp_f32 v27, v27
    v_cvt_pk_bf16_f32 v146, v20, v21
    v_cvt_pk_bf16_f32 v147, v22, v23
    v_mfma_f32_32x32x16_bf16 v[64:79], v[176:179], v[164:167], v[96:111]
    s_mov_b64 exec, s[46:47]
    ds_read_b128 v[204:207], v13 offset:23040
    ds_read_b128 v[208:211], v13 offset:23680
    ds_read_b128 v[212:215], v13 offset:24320
    ds_read_b128 v[216:219], v13 offset:24960
    s_mov_b64 exec, -1
    v_exp_f32 v28, v28
    v_exp_f32 v29, v29
    v_exp_f32 v30, v30
    v_exp_f32 v31, v31
    v_cvt_pk_bf16_f32 v148, v24, v25
    v_cvt_pk_bf16_f32 v149, v26, v27
    s_bitcmp1_b32 25, s38
    v_mfma_f32_32x32x16_bf16 v[112:127], v[188:191], v[144:147], v[112:127]
    s_cbranch_scc1 AT_nd10
    buffer_load_dwordx4 v8, s[12:15], s45 offen offset:3072 sc1 lds
AT_nd10:
    v_exp_f32 v32, v32
    v_exp_f32 v33, v33
    v_exp_f32 v34, v34
    v_exp_f32 v35, v35
    v_cvt_pk_bf16_f32 v150, v28, v29
    v_cvt_pk_bf16_f32 v151, v30, v31
    v_mfma_f32_32x32x4_2b_bf16 v[48:79], v[182:183], v[168:169], v[48:79]
    ds_read_b128 v[172:175], v5 offset:22528
    ds_read_b128 v[184:187], v7 offset:20992
    v_exp_f32 v36, v36
    v_exp_f32 v37, v37
    v_exp_f32 v38, v38
    v_exp_f32 v39, v39
    v_cvt_pk_bf16_f32 v152, v32, v33
    v_cvt_pk_bf16_f32 v153, v34, v35
    v_exp_f32 v40, v40
    v_exp_f32 v41, v41
    v_mfma_f32_32x32x16_bf16 v[112:127], v[192:195], v[148:151], v[112:127]
    v_exp_f32 v42, v42
    v_exp_f32 v43, v43
    v_cvt_pk_bf16_f32 v154, v36, v37
    v_cvt_pk_bf16_f32 v155, v38, v39
    v_exp_f32 v44, v44
    v_exp_f32 v45, v45
    v_mfma_f32_32x32x16_bf16 v[128:143], v[188:191], v[152:155], v[128:143]
    v_exp_f32 v46, v46
    v_exp_f32 v47, v47
    v_cvt_pk_bf16_f32 v156, v40, v41
    v_cvt_pk_bf16_f32 v157, v42, v43
    v_exp_f32 v48, v48
    v_exp_f32 v49, v49
    v_exp_f32 v50, v50
    v_exp_f32 v51, v51
    v_cvt_pk_bf16_f32 v158, v44, v45
    v_cvt_pk_bf16_f32 v159, v46, v47
    s_waitcnt lgkmcnt(0)
    v_mfma_f32_32x32x16_bf16 v[16:31], v[172:175], v[160:163], v[80:95]
    v_exp_f32 v52, v52
    v_exp_f32 v53, v53
    v_exp_f32 v54, v54
    v_exp_f32 v55, v55
    v_cvt_pk_bf16_f32 v144, v48, v49
    v_cvt_pk_bf16_f32 v145, v50, v51
    v_mfma_f32_32x32x16_bf16 v[128:143], v[192:195], v[156:159], v[128:143]
    v_exp_f32 v56, v56
    v_exp_f32 v57, v57
    v_exp_f32 v58, v58
    v_exp_f32 v59, v59
    v_cvt_pk_bf16_f32 v146, v52, v53
    v_cvt_pk_bf16_f32 v147, v54, v55
    v_mfma_f32_32x32x16_bf16 v[32:47], v[172:175], v[164:167], v[96:111]
    v_exp_f32 v60, v60
    v_exp_f32 v61, v61
    v_exp_f32 v62, v62
    v_exp_f32 v63, v63
    v_cvt_pk_bf16_f32 v148, v56, v57
    v_cvt_pk_bf16_f32 v149, v58, v59
    s_bitcmp1_b32 25, s38
    v_mfma_f32_32x32x16_bf16 v[112:127], v[196:199], v[144:147], v[112:127]
    s_cbranch_scc1 AT_nd11
    s_add_u32 m0, m0, 0x1000
    s_nop 0
    buffer_load_dwordx4 v9, s[12:15], s45 offen sc1 lds
AT_nd11:
    v_exp_f32 v64, v64
    v_exp_f32 v65, v65
    v_exp_f32 v66, v66
    v_exp_f32 v67, v67
    v_cvt_pk_bf16_f32 v150, v60, v61
    v_cvt_pk_bf16_f32 v151, v62, v63
    v_mfma_f32_32x32x4_2b_bf16 v[16:47], v[184:185], v[168:169], v[16:47]
    ds_read_b128 v[176:179], v5 offset:23552
    v_exp_f32 v68, v68
    v_exp_f32 v69, v69
    v_exp_f32 v70, v70
    v_exp_f32 v71, v71
    v_cvt_pk_bf16_f32 v152, v64, v65
    v_cvt_pk_bf16_f32 v153, v66, v67
    v_exp_f32 v72, v72
    v_exp_f32 v73, v73
    v_mfma_f32_32x32x16_bf16 v[112:127], v[200:203], v[148:151], v[112:127]
    v_exp_f32 v74, v74
    v_exp_f32 v75, v75
    v_cvt_pk_bf16_f32 v154, v68, v69
    v_cvt_pk_bf16_f32 v155, v70, v71
    v_exp_f32 v76, v76
    v_exp_f32 v77, v77
    v_mfma_f32_32x32x16_bf16 v[128:143], v[196:199], v[152:155], v[128:143]
    v_exp_f32 v78, v78
    v_exp_f32 v79, v79
    v_cvt_pk_bf16_f32 v156, v72, v73
    v_cvt_pk_bf16_f32 v157, v74, v75
    v_exp_f32 v16, v16
    v_exp_f32 v17, v17
    v_exp_f32 v18, v18
    v_exp_f32 v19, v19
    v_cvt_pk_bf16_f32 v158, v76, v77
    v_cvt_pk_bf16_f32 v159, v78, v79
    s_waitcnt lgkmcnt(0)
    v_mfma_f32_32x32x16_bf16 v[48:63], v[176:179], v[160:163], v[80:95]
    v_exp_f32 v20, v20
    v_exp_f32 v21, v21
    v_exp_f32 v22, v22
    v_exp_f32 v23, v23
    v_cvt_pk_bf16_f32 v144, v16, v17
    v_cvt_pk_bf16_f32 v145, v18, v19
    v_mfma_f32_32x32x16_bf16 v[128:143], v[200:203], v[156:159], v[128:143]
    v_exp_f32 v24, v24
    v_exp_f32 v25, v25
    v_exp_f32 v26, v26
    v_exp_f32 v27, v27
    v_cvt_pk_bf16_f32 v146, v20, v21
    v_cvt_pk_bf16_f32 v147, v22, v23
    v_mfma_f32_32x32x16_bf16 v[64:79], v[176:179], v[164:167], v[96:111]
    s_mov_b64 exec, s[46:47]
    ds_read_b128 v[188:191], v13 offset:25600
    ds_read_b128 v[192:195], v13 offset:26240
    ds_read_b128 v[196:199], v13 offset:26880
    ds_read_b128 v[200:203], v13 offset:27520
    s_mov_b64 exec, -1
    v_exp_f32 v28, v28
    v_exp_f32 v29, v29
    v_exp_f32 v30, v30
    v_exp_f32 v31, v31
    v_cvt_pk_bf16_f32 v148, v24, v25
    v_cvt_pk_bf16_f32 v149, v26, v27
    v_mfma_f32_32x32x16_bf16 v[112:127], v[204:207], v[144:147], v[112:127]
    v_exp_f32 v32, v32
    v_exp_f32 v33, v33
    v_exp_f32 v34, v34
    v_exp_f32 v35, v35
    v_cvt_pk_bf16_f32 v150, v28, v29
    v_cvt_pk_bf16_f32 v151, v30, v31
    v_mfma_f32_32x32x4_2b_bf16 v[48:79], v[186:187], v[168:169], v[48:79]
    ds_read_b128 v[172:175], v5 offset:24576
    ds_read_b128 v[180:183], v7 offset:21504
    v_exp_f32 v36, v36
    v_exp_f32 v37, v37
    v_exp_f32 v38, v38
    v_exp_f32 v39, v39
    v_cvt_pk_bf16_f32 v152, v32, v33
    v_cvt_pk_bf16_f32 v153, v34, v35
    v_exp_f32 v40, v40
    v_exp_f32 v41, v41
    v_mfma_f32_32x32x16_bf16 v[112:127], v[208:211], v[148:151], v[112:127]
    v_exp_f32 v42, v42
    v_exp_f32 v43, v43
    v_cvt_pk_bf16_f32 v154, v36, v37
    v_cvt_pk_bf16_f32 v155, v38, v39
    v_exp_f32 v44, v44
    v_exp_f32 v45, v45
    v_mfma_f32_32x32x16_bf16 v[128:143], v[204:207], v[152:155], v[128:143]
    v_exp_f32 v46, v46
    v_exp_f32 v47, v47
    v_cvt_pk_bf16_f32 v156, v40, v41
    v_cvt_pk_bf16_f32 v157, v42, v43
    v_exp_f32 v48, v48
    v_exp_f32 v49, v49
    v_exp_f32 v50, v50
    v_exp_f32 v51, v51
    v_cvt_pk_bf16_f32 v158, v44, v45
    v_cvt_pk_bf16_f32 v159, v46, v47
    s_waitcnt lgkmcnt(0)
    v_mfma_f32_32x32x16_bf16 v[16:31], v[172:175], v[160:163], v[80:95]
    v_exp_f32 v52, v52
    v_exp_f32 v53, v53
    v_exp_f32 v54, v54
    v_exp_f32 v55, v55
    v_cvt_pk_bf16_f32 v144, v48, v49
    v_cvt_pk_bf16_f32 v145, v50, v51
    v_mfma_f32_32x32x16_bf16 v[128:143], v[208:211], v[156:159], v[128:143]
    v_exp_f32 v56, v56
    v_exp_f32 v57, v57
    v_exp_f32 v58, v58
    v_exp_f32 v59, v59
    v_cvt_pk_bf16_f32 v146, v52, v53
    v_cvt_pk_bf16_f32 v147, v54, v55
    v_mfma_f32_32x32x16_bf16 v[32:47], v[172:175], v[164:167], v[96:111]
    v_exp_f32 v60, v60
    v_exp_f32 v61, v61
    v_exp_f32 v62, v62
    v_exp_f32 v63, v63
    v_cvt_pk_bf16_f32 v148, v56, v57
    v_cvt_pk_bf16_f32 v149, v58, v59
    v_mfma_f32_32x32x16_bf16 v[112:127], v[212:215], v[144:147], v[112:127]
    v_exp_f32 v64, v64
    v_exp_f32 v65, v65
    v_exp_f32 v66, v66
    v_exp_f32 v67, v67
    v_cvt_pk_bf16_f32 v150, v60, v61
    v_cvt_pk_bf16_f32 v151, v62, v63
    v_mfma_f32_32x32x4_2b_bf16 v[16:47], v[180:181], v[168:169], v[16:47]
    ds_read_b128 v[176:179], v5 offset:25600
    v_exp_f32 v68, v68
    v_exp_f32 v69, v69
    v_exp_f32 v70, v70
    v_exp_f32 v71, v71
    v_cvt_pk_bf16_f32 v152, v64, v65
    v_cvt_pk_bf16_f32 v153, v66, v67
    v_exp_f32 v72, v72
    v_exp_f32 v73, v73
    v_mfma_f32_32x32x16_bf16 v[112:127], v[216:219], v[148:151], v[112:127]
    v_exp_f32 v74, v74
    v_exp_f32 v75, v75
    v_cvt_pk_bf16_f32 v154, v68, v69
    v_cvt_pk_bf16_f32 v155, v70, v71
    v_exp_f32 v76, v76
    v_exp_f32 v77, v77
    v_mfma_f32_32x32x16_bf16 v[128:143], v[212:215], v[152:155], v[128:143]
    v_exp_f32 v78, v78
    v_exp_f32 v79, v79
    v_cvt_pk_bf16_f32 v156, v72, v73
    v_cvt_pk_bf16_f32 v157, v74, v75
    v_exp_f32 v16, v16
    v_exp_f32 v17, v17
    v_exp_f32 v18, v18
    v_exp_f32 v19, v19
    v_cvt_pk_bf16_f32 v158, v76, v77
    v_cvt_pk_bf16_f32 v159, v78, v79
    s_waitcnt lgkmcnt(0)
    v_mfma_f32_32x32x16_bf16 v[48:63], v[176:179], v[160:163], v[80:95]
    v_exp_f32 v20, v20
    v_exp_f32 v21, v21
    v_exp_f32 v22, v22
    v_exp_f32 v23, v23
    v_cvt_pk_bf16_f32 v144, v16, v17
    v_cvt_pk_bf16_f32 v145, v18, v19
    v_mfma_f32_32x32x16_bf16 v[128:143], v[216:219], v[156:159], v[128:143]
    v_exp_f32 v24, v24
    v_exp_f32 v25, v25
    v_exp_f32 v26, v26
    v_exp_f32 v27, v27
    v_cvt_pk_bf16_f32 v146, v20, v21
    v_cvt_pk_bf16_f32 v147, v22, v23
    v_mfma_f32_32x32x16_bf16 v[64:79], v[176:179], v[164:167], v[96:111]
    s_mov_b64 exec, s[46:47]
    ds_read_b128 v[204:207], v13 offset:28160
    ds_read_b128 v[208:211], v13 offset:28800
    ds_read_b128 v[212:215], v13 offset:29440
    ds_read_b128 v[216:219], v13 offset:30080
    s_mov_b64 exec, -1
    v_exp_f32 v28, v28
    v_exp_f32 v29, v29
    v_exp_f32 v30, v30
    v_exp_f32 v31, v31
    v_cvt_pk_bf16_f32 v148, v24, v25
    v_cvt_pk_bf16_f32 v149, v26, v27
    v_mfma_f32_32x32x16_bf16 v[112:127], v[188:191], v[144:147], v[112:127]
    v_exp_f32 v32, v32
    v_exp_f32 v33, v33
    v_exp_f32 v34, v34
    v_exp_f32 v35, v35
    v_cvt_pk_bf16_f32 v150, v28, v29
    v_cvt_pk_bf16_f32 v151, v30, v31
    v_mfma_f32_32x32x4_2b_bf16 v[48:79], v[182:183], v[168:169], v[48:79]
    ds_read_b128 v[172:175], v5 offset:26624
    ds_read_b128 v[184:187], v7 offset:22016
    v_exp_f32 v36, v36
    v_exp_f32 v37, v37
    v_exp_f32 v38, v38
    v_exp_f32 v39, v39
    v_cvt_pk_bf16_f32 v152, v32, v33
    v_cvt_pk_bf16_f32 v153, v34, v35
    v_exp_f32 v40, v40
    v_exp_f32 v41, v41
    v_mfma_f32_32x32x16_bf16 v[112:127], v[192:195], v[148:151], v[112:127]
    v_exp_f32 v42, v42
    v_exp_f32 v43, v43
    v_cvt_pk_bf16_f32 v154, v36, v37
    v_cvt_pk_bf16_f32 v155, v38, v39
    v_exp_f32 v44, v44
    v_exp_f32 v45, v45
    v_mfma_f32_32x32x16_bf16 v[128:143], v[188:191], v[152:155], v[128:143]
    v_exp_f32 v46, v46
    v_exp_f32 v47, v47
    v_cvt_pk_bf16_f32 v156, v40, v41
    v_cvt_pk_bf16_f32 v157, v42, v43
    v_exp_f32 v48, v48
    v_exp_f32 v49, v49
    v_exp_f32 v50, v50
    v_exp_f32 v51, v51
    v_cvt_pk_bf16_f32 v158, v44, v45
    v_cvt_pk_bf16_f32 v159, v46, v47
    s_waitcnt lgkmcnt(0)
    v_mfma_f32_32x32x16_bf16 v[16:31], v[172:175], v[160:163], v[80:95]
    v_exp_f32 v52, v52
    v_exp_f32 v53, v53
    v_exp_f32 v54, v54
    v_exp_f32 v55, v55
    v_cvt_pk_bf16_f32 v144, v48, v49
    v_cvt_pk_bf16_f32 v145, v50, v51
    v_mfma_f32_32x32x16_bf16 v[128:143], v[192:195], v[156:159], v[128:143]
    v_exp_f32 v56, v56
    v_exp_f32 v57, v57
    v_exp_f32 v58, v58
    v_exp_f32 v59, v59
    v_cvt_pk_bf16_f32 v146, v52, v53
    v_cvt_pk_bf16_f32 v147, v54, v55
    v_mfma_f32_32x32x16_bf16 v[32:47], v[172:175], v[164:167], v[96:111]
    v_exp_f32 v60, v60
    v_exp_f32 v61, v61
    v_exp_f32 v62, v62
    v_exp_f32 v63, v63
    v_cvt_pk_bf16_f32 v148, v56, v57
    v_cvt_pk_bf16_f32 v149, v58, v59
    v_mfma_f32_32x32x16_bf16 v[112:127], v[196:199], v[144:147], v[112:127]
    v_exp_f32 v64, v64
    v_exp_f32 v65, v65
    v_exp_f32 v66, v66
    v_exp_f32 v67, v67
    v_cvt_pk_bf16_f32 v150, v60, v61
    v_cvt_pk_bf16_f32 v151, v62, v63
    v_mfma_f32_32x32x4_2b_bf16 v[16:47], v[184:185], v[168:169], v[16:47]
    ds_read_b128 v[176:179], v5 offset:27648
    v_exp_f32 v68, v68
    v_exp_f32 v69, v69
    v_exp_f32 v70, v70
    v_exp_f32 v71, v71
    v_cvt_pk_bf16_f32 v152, v64, v65
    v_cvt_pk_bf16_f32 v153, v66, v67
    v_exp_f32 v72, v72
    v_exp_f32 v73, v73
    v_mfma_f32_32x32x16_bf16 v[112:127], v[200:203], v[148:151], v[112:127]
    v_exp_f32 v74, v74
    v_exp_f32 v75, v75
    v_cvt_pk_bf16_f32 v154, v68, v69
    v_cvt_pk_bf16_f32 v155, v70, v71
    v_exp_f32 v76, v76
    v_exp_f32 v77, v77
    v_mfma_f32_32x32x16_bf16 v[128:143], v[196:199], v[152:155], v[128:143]
    v_exp_f32 v78, v78
    v_exp_f32 v79, v79
    v_cvt_pk_bf16_f32 v156, v72, v73
    v_cvt_pk_bf16_f32 v157, v74, v75
    s_add_u32 s38, s38, 1
    s_branch AT_loop
AT_done:
    v_cvt_pk_bf16_f32 v158, v76, v77
    v_cvt_pk_bf16_f32 v159, v78, v79
    s_lshl_b32 s30, s25, 3
    s_lshl_b32 s31, s28, 1
    v_mfma_f32_32x32x16_bf16 v[128:143], v[216:219], v[156:159], v[128:143]
    v_rcp_f32 v125, v124
    s_add_u32 s30, s30, s31
    s_mul_i32 s30, s30, 40960
    s_and_b32 s41, s24, 1
    s_mul_i32 s41, s41, 20480
    s_add_u32 s30, s30, s41
    s_lshr_b32 s42, s24, 1
    s_lshl_b32 s31, s42, 10
    s_add_u32 s31, s31, s30
    v_lshlrev_b32 v14, 4, v2
    v_add_u32 v14, s31, v14
    s_lshr_b32 s40, s42, 2
    s_add_u32 s40, s40, 16
    s_lshl_b32 s40, s40, 10
    s_add_u32 s40, s40, s30
    s_and_b32 s41, s42, 1
    s_lshl_b32 s41, s41, 9
    s_add_u32 s40, s40, s41
    s_and_b32 s41, s42, 2
    s_lshl_b32 s41, s41, 2
    s_add_u32 s40, s40, s41
    v_add_u32 v15, s40, v6
    s_mov_b32 s41, 40960
    s_mov_b32 s42, 0x5d800000
    v_mul_f32 v112, v112, v125
    v_mul_f32 v113, v113, v125
    v_mul_f32 v114, v114, v125
    v_mul_f32 v115, v115, v125
    v_mul_f32 v116, v116, v125
    v_mul_f32 v117, v117, v125
    v_mul_f32 v118, v118, v125
    v_mul_f32 v119, v119, v125
    v_mul_f32 v120, v120, v125
    v_mul_f32 v121, v121, v125
    v_mul_f32 v122, v122, v125
    v_mul_f32 v123, v123, v125
    v_cvt_pk_bf16_f32 v16, v112, v113
    v_cvt_pk_bf16_f32 v17, v114, v115
    v_cvt_pk_bf16_f32 v18, v116, v117
    v_cvt_pk_bf16_f32 v19, v118, v119
    v_cvt_pk_bf16_f32 v20, v120, v121
    v_cvt_pk_bf16_f32 v21, v122, v123
    buffer_store_dwordx4 v[16:19], v14, s[32:35], 0 offen sc1
    v_rcp_f32 v141, v140
    s_nop 0
    v_mul_f32 v128, v128, v141
    v_mul_f32 v129, v129, v141
    v_mul_f32 v130, v130, v141
    v_mul_f32 v131, v131, v141
    v_mul_f32 v132, v132, v141
    v_mul_f32 v133, v133, v141
    v_mul_f32 v134, v134, v141
    v_mul_f32 v135, v135, v141
    v_mul_f32 v136, v136, v141
    v_mul_f32 v137, v137, v141
    v_mul_f32 v138, v138, v141
    v_mul_f32 v139, v139, v141
    v_cvt_pk_bf16_f32 v24, v128, v129
    v_cvt_pk_bf16_f32 v25, v130, v131
    v_cvt_pk_bf16_f32 v26, v132, v133
    v_cvt_pk_bf16_f32 v27, v134, v135
    v_cvt_pk_bf16_f32 v28, v136, v137
    v_cvt_pk_bf16_f32 v29, v138, v139
    buffer_store_dwordx4 v[24:27], v14, s[32:35], s41 offen sc1
    s_mov_b32 exec_hi, 0
    buffer_store_dwordx2 v[20:21], v15, s[32:35], 0 offen sc1
    buffer_store_dwordx2 v[28:29], v15, s[32:35], s41 offen sc1
    s_mov_b64 exec, -1
    v_cmp_ngt_f32 vcc, s42, v124
    v_cmp_ngt_f32 s[48:49], s42, v140
    s_or_b64 vcc, vcc, s[48:49]
    s_cmp_lg_u64 vcc, 0
    s_cselect_b32 s43, 1, 0
    s_cmp_eq_u32 s44, 1
    s_cselect_b32 s43, 0, s43
    v_mov_b32 v1, s43
    s_lshl_b32 s45, s28, 2
    v_mov_b32 v12, s45
    ds_write_b32 v12, v1
    s_lshl_b32 s30, s25, 2
    s_add_u32 s30, s30, s28
    s_bitcmp0_b32 s24, 0
    s_cselect_b32 s31, 64, 0
    s_add_u32 s30, s30, s31
    s_lshl_b32 s30, s30, 8
    s_add_u32 s100, s60, s30
    s_addc_u32 s101, s61, 0
    s_mov_b32 s95, 0x20000
    v_mov_b32 v12, 0
    s_waitcnt lgkmcnt(0)
    s_barrier
    ds_read_b128 v[172:175], v12
    s_waitcnt lgkmcnt(0)
    v_or_b32 v172, v172, v173
    v_or3_b32 v172, v172, v174, v175
    s_nop 0
    v_readfirstlane_b32 s43, v172
    s_waitcnt vmcnt(0)
    s_cmp_lg_u32 s43, 0
    s_cbranch_scc1 AT_fallback
    s_atomic_add s95, s[100:101], 0
    s_endpgm
AT_fallback:
    s_mov_b32 s36, 0
    s_mov_b32 s37, 0
    v_lshlrev_b32 v5, 4, v2
    v_add_u32 v7, 8192, v6
    v_mov_b32 v80, 0xff800000
    v_mov_b32 v96, 0xff800000
AT_fb_chunk:
    s_barrier
    s_add_u32 m0, s37, s29
    s_nop 0
    buffer_load_dwordx4 v8, s[12:15], s36 offen sc1 lds
    buffer_load_dwordx4 v8, s[12:15], s36 offen offset:1024 sc1 lds
    buffer_load_dwordx4 v8, s[12:15], s36 offen offset:2048 sc1 lds
    buffer_load_dwordx4 v8, s[12:15], s36 offen offset:3072 sc1 lds
    s_add_u32 m0, m0, 0x1000
    s_nop 0
    buffer_load_dwordx4 v9, s[12:15], s36 offen sc1 lds
    s_waitcnt vmcnt(0)
    s_barrier
    ds_read_b128 v[172:175], v5 offset:0
    ds_read_b128 v[180:183], v7 offset:0
    s_waitcnt lgkmcnt(0)
    v_mfma_f32_32x32x16_bf16 v[16:31], v[172:175], v[160:163], 0
    v_mfma_f32_32x32x16_bf16 v[32:47], v[172:175], v[164:167], 0
    s_nop 9
    v_mfma_f32_32x32x4_2b_bf16 v[16:47], v[180:181], v[168:169], v[16:47]
    s_nop 15
    s_nop 3
    v_max3_f32 v80, v80, v16, v17
    v_max3_f32 v80, v80, v18, v19
    v_max3_f32 v80, v80, v20, v21
    v_max3_f32 v80, v80, v22, v23
    v_max3_f32 v80, v80, v24, v25
    v_max3_f32 v80, v80, v26, v27
    v_max3_f32 v80, v80, v28, v29
    v_max3_f32 v80, v80, v30, v31
    v_max3_f32 v96, v96, v32, v33
    v_max3_f32 v96, v96, v34, v35
    v_max3_f32 v96, v96, v36, v37
    v_max3_f32 v96, v96, v38, v39
    v_max3_f32 v96, v96, v40, v41
    v_max3_f32 v96, v96, v42, v43
    v_max3_f32 v96, v96, v44, v45
    v_max3_f32 v96, v96, v46, v47
    ds_read_b128 v[172:175], v5 offset:1024
    ds_read_b128 v[180:183], v7 offset:0
    s_waitcnt lgkmcnt(0)
    v_mfma_f32_32x32x16_bf16 v[16:31], v[172:175], v[160:163], 0
    v_mfma_f32_32x32x16_bf16 v[32:47], v[172:175], v[164:167], 0
    s_nop 9
    v_mfma_f32_32x32x4_2b_bf16 v[16:47], v[182:183], v[168:169], v[16:47]
    s_nop 15
    s_nop 3
    v_max3_f32 v80, v80, v16, v17
    v_max3_f32 v80, v80, v18, v19
    v_max3_f32 v80, v80, v20, v21
    v_max3_f32 v80, v80, v22, v23
    v_max3_f32 v80, v80, v24, v25
    v_max3_f32 v80, v80, v26, v27
    v_max3_f32 v80, v80, v28, v29
    v_max3_f32 v80, v80, v30, v31
    v_max3_f32 v96, v96, v32, v33
    v_max3_f32 v96, v96, v34, v35
    v_max3_f32 v96, v96, v36, v37
    v_max3_f32 v96, v96, v38, v39
    v_max3_f32 v96, v96, v40, v41
    v_max3_f32 v96, v96, v42, v43
    v_max3_f32 v96, v96, v44, v45
    v_max3_f32 v96, v96, v46, v47
    ds_read_b128 v[172:175], v5 offset:2048
    ds_read_b128 v[180:183], v7 offset:512
    s_waitcnt lgkmcnt(0)
    v_mfma_f32_32x32x16_bf16 v[16:31], v[172:175], v[160:163], 0
    v_mfma_f32_32x32x16_bf16 v[32:47], v[172:175], v[164:167], 0
    s_nop 9
    v_mfma_f32_32x32x4_2b_bf16 v[16:47], v[180:181], v[168:169], v[16:47]
    s_nop 15
    s_nop 3
    v_max3_f32 v80, v80, v16, v17
    v_max3_f32 v80, v80, v18, v19
    v_max3_f32 v80, v80, v20, v21
    v_max3_f32 v80, v80, v22, v23
    v_max3_f32 v80, v80, v24, v25
    v_max3_f32 v80, v80, v26, v27
    v_max3_f32 v80, v80, v28, v29
    v_max3_f32 v80, v80, v30, v31
    v_max3_f32 v96, v96, v32, v33
    v_max3_f32 v96, v96, v34, v35
    v_max3_f32 v96, v96, v36, v37
    v_max3_f32 v96, v96, v38, v39
    v_max3_f32 v96, v96, v40, v41
    v_max3_f32 v96, v96, v42, v43
    v_max3_f32 v96, v96, v44, v45
    v_max3_f32 v96, v96, v46, v47
    ds_read_b128 v[172:175], v5 offset:3072
    ds_read_b128 v[180:183], v7 offset:512
    s_waitcnt lgkmcnt(0)
    v_mfma_f32_32x32x16_bf16 v[16:31], v[172:175], v[160:163], 0
    v_mfma_f32_32x32x16_bf16 v[32:47], v[172:175], v[164:167], 0
    s_nop 9
    v_mfma_f32_32x32x4_2b_bf16 v[16:47], v[182:183], v[168:169], v[16:47]
    s_nop 15
    s_nop 3
    v_max3_f32 v80, v80, v16, v17
    v_max3_f32 v80, v80, v18, v19
    v_max3_f32 v80, v80, v20, v21
    v_max3_f32 v80, v80, v22, v23
    v_max3_f32 v80, v80, v24, v25
    v_max3_f32 v80, v80, v26, v27
    v_max3_f32 v80, v80, v28, v29
    v_max3_f32 v80, v80, v30, v31
    v_max3_f32 v96, v96, v32, v33
    v_max3_f32 v96, v96, v34, v35
    v_max3_f32 v96, v96, v36, v37
    v_max3_f32 v96, v96, v38, v39
    v_max3_f32 v96, v96, v40, v41
    v_max3_f32 v96, v96, v42, v43
    v_max3_f32 v96, v96, v44, v45
    v_max3_f32 v96, v96, v46, v47
    ds_read_b128 v[172:175], v5 offset:4096
    ds_read_b128 v[180:183], v7 offset:1024
    s_waitcnt lgkmcnt(0)
    v_mfma_f32_32x32x16_bf16 v[16:31], v[172:175], v[160:163], 0
    v_mfma_f32_32x32x16_bf16 v[32:47], v[172:175], v[164:167], 0
    s_nop 9
    v_mfma_f32_32x32x4_2b_bf16 v[16:47], v[180:181], v[168:169], v[16:47]
    s_nop 15
    s_nop 3
    v_max3_f32 v80, v80, v16, v17
    v_max3_f32 v80, v80, v18, v19
    v_max3_f32 v80, v80, v20, v21
    v_max3_f32 v80, v80, v22, v23
    v_max3_f32 v80, v80, v24, v25
    v_max3_f32 v80, v80, v26, v27
    v_max3_f32 v80, v80, v28, v29
    v_max3_f32 v80, v80, v30, v31
    v_max3_f32 v96, v96, v32, v33
    v_max3_f32 v96, v96, v34, v35
    v_max3_f32 v96, v96, v36, v37
    v_max3_f32 v96, v96, v38, v39
    v_max3_f32 v96, v96, v40, v41
    v_max3_f32 v96, v96, v42, v43
    v_max3_f32 v96, v96, v44, v45
    v_max3_f32 v96, v96, v46, v47
    ds_read_b128 v[172:175], v5 offset:5120
    ds_read_b128 v[180:183], v7 offset:1024
    s_waitcnt lgkmcnt(0)
    v_mfma_f32_32x32x16_bf16 v[16:31], v[172:175], v[160:163], 0
    v_mfma_f32_32x32x16_bf16 v[32:47], v[172:175], v[164:167], 0
    s_nop 9
    v_mfma_f32_32x32x4_2b_bf16 v[16:47], v[182:183], v[168:169], v[16:47]
    s_nop 15
    s_nop 3
    v_max3_f32 v80, v80, v16, v17
    v_max3_f32 v80, v80, v18, v19
    v_max3_f32 v80, v80, v20, v21
    v_max3_f32 v80, v80, v22, v23
    v_max3_f32 v80, v80, v24, v25
    v_max3_f32 v80, v80, v26, v27
    v_max3_f32 v80, v80, v28, v29
    v_max3_f32 v80, v80, v30, v31
    v_max3_f32 v96, v96, v32, v33
    v_max3_f32 v96, v96, v34, v35
    v_max3_f32 v96, v96, v36, v37
    v_max3_f32 v96, v96, v38, v39
    v_max3_f32 v96, v96, v40, v41
    v_max3_f32 v96, v96, v42, v43
    v_max3_f32 v96, v96, v44, v45
    v_max3_f32 v96, v96, v46, v47
    ds_read_b128 v[172:175], v5 offset:6144
    ds_read_b128 v[180:183], v7 offset:1536
    s_waitcnt lgkmcnt(0)
    v_mfma_f32_32x32x16_bf16 v[16:31], v[172:175], v[160:163], 0
    v_mfma_f32_32x32x16_bf16 v[32:47], v[172:175], v[164:167], 0
    s_nop 9
    v_mfma_f32_32x32x4_2b_bf16 v[16:47], v[180:181], v[168:169], v[16:47]
    s_nop 15
    s_nop 3
    v_max3_f32 v80, v80, v16, v17
    v_max3_f32 v80, v80, v18, v19
    v_max3_f32 v80, v80, v20, v21
    v_max3_f32 v80, v80, v22, v23
    v_max3_f32 v80, v80, v24, v25
    v_max3_f32 v80, v80, v26, v27
    v_max3_f32 v80, v80, v28, v29
    v_max3_f32 v80, v80, v30, v31
    v_max3_f32 v96, v96, v32, v33
    v_max3_f32 v96, v96, v34, v35
    v_max3_f32 v96, v96, v36, v37
    v_max3_f32 v96, v96, v38, v39
    v_max3_f32 v96, v96, v40, v41
    v_max3_f32 v96, v96, v42, v43
    v_max3_f32 v96, v96, v44, v45
    v_max3_f32 v96, v96, v46, v47
    ds_read_b128 v[172:175], v5 offset:7168
    ds_read_b128 v[180:183], v7 offset:1536
    s_waitcnt lgkmcnt(0)
    v_mfma_f32_32x32x16_bf16 v[16:31], v[172:175], v[160:163], 0
    v_mfma_f32_32x32x16_bf16 v[32:47], v[172:175], v[164:167], 0
    s_nop 9
    v_mfma_f32_32x32x4_2b_bf16 v[16:47], v[182:183], v[168:169], v[16:47]
    s_nop 15
    s_nop 3
    v_max3_f32 v80, v80, v16, v17
    v_max3_f32 v80, v80, v18, v19
    v_max3_f32 v80, v80, v20, v21
    v_max3_f32 v80, v80, v22, v23
    v_max3_f32 v80, v80, v24, v25
    v_max3_f32 v80, v80, v26, v27
    v_max3_f32 v80, v80, v28, v29
    v_max3_f32 v80, v80, v30, v31
    v_max3_f32 v96, v96, v32, v33
    v_max3_f32 v96, v96, v34, v35
    v_max3_f32 v96, v96, v36, v37
    v_max3_f32 v96, v96, v38, v39
    v_max3_f32 v96, v96, v40, v41
    v_max3_f32 v96, v96, v42, v43
    v_max3_f32 v96, v96, v44, v45
    v_max3_f32 v96, v96, v46, v47
    s_add_u32 s36, s36, 20480
    s_cmp_lt_u32 s36, 163840
    s_cbranch_scc1 AT_fb_chunk
    v_mov_b32 v81, v80
    v_mov_b32 v97, v96
    s_nop 1
    v_permlane32_swap_b32 v80, v81
    v_permlane32_swap_b32 v96, v97
    v_max_f32 v80, v80, v81
    v_sub_f32 v80, 0, v80
    v_max_f32 v96, v96, v97
    v_sub_f32 v96, 0, v96
    v_mov_b32 v81, v80
    v_mov_b32 v97, v96
    v_mov_b32 v82, v80
    v_mov_b32 v98, v96
    v_mov_b32 v83, v80
    v_mov_b32 v99, v96
    v_mov_b32 v84, v80
    v_mov_b32 v100, v96
    v_mov_b32 v85, v80
    v_mov_b32 v101, v96
    v_mov_b32 v86, v80
    v_mov_b32 v102, v96
    v_mov_b32 v87, v80
    v_mov_b32 v103, v96
    v_mov_b32 v88, v80
    v_mov_b32 v104, v96
    v_mov_b32 v89, v80
    v_mov_b32 v105, v96
    v_mov_b32 v90, v80
    v_mov_b32 v106, v96
    v_mov_b32 v91, v80
    v_mov_b32 v107, v96
    v_mov_b32 v92, v80
    v_mov_b32 v108, v96
    v_mov_b32 v93, v80
    v_mov_b32 v109, v96
    v_mov_b32 v94, v80
    v_mov_b32 v110, v96
    v_mov_b32 v95, v80
    v_mov_b32 v111, v96
    s_mov_b32 s44, 1
    s_barrier
    s_branch AT_pass
.p2align 6
B_role:
    s_sub_u32 s3, s2, 256
    s_and_b32 s24, s3, 7
    s_lshr_b32 s25, s3, 3
    s_lshl_b32 s57, s2, 8
    v_mov_b32 v22, s57
    s_waitcnt lgkmcnt(0)
    s_add_u32 s60, s10, 0x1800000
    s_addc_u32 s61, s11, 0
    s_mov_b32 s62, 0x20000
    s_mov_b32 s63, 0x00020000
    s_mov_b32 s20, s8
    s_mov_b32 s21, s9
    s_mov_b32 s22, 0x100
    s_mov_b32 s23, 0x00020000
    s_load_dwordx16 s[64:79], s[0:1], 0
    s_cmp_lg_u32 s3, 255
    s_cbranch_scc1 B_noclear
    v_lshlrev_b32 v24, 8, v0
    v_mov_b32 v28, 0
    s_mov_b32 s29, 0x10000
    buffer_store_dword v28, v24, s[60:63], 0 offen sc1
    buffer_store_dword v28, v24, s[60:63], s29 offen offset:4 sc1
    s_waitcnt vmcnt(0)
    s_barrier
    v_mov_b32 v25, 1
    v_lshlrev_b32 v24, 12, v0
    buffer_store_dword v25, v24, s[20:23], 0 offen sc1
B_noclear:
    s_getpc_b64 s[12:13]
    BPC:
    s_sub_u32 s12, s12, BPC-gated_mix__mha_block__swiglu_ffn__prompt_kernel
    s_subb_u32 s13, s13, 0
    s_mov_b32 s14, CODE_END-gated_mix__mha_block__swiglu_ffn__prompt_kernel
    s_mov_b32 s15, 0x00020000
    s_lshl_b32 s29, s25, 11
    v_lshlrev_b32 v24, 3, v0
    v_add_u32 v24, s29, v24
    buffer_load_dwordx2 v[220:221], v24, s[12:15], 0 offen
    s_waitcnt lgkmcnt(0)
    s_mov_b64 s[4:5], s[64:65]
    s_mov_b64 s[44:45], s[72:73]
    s_mov_b64 s[46:47], s[74:75]
    s_mov_b64 s[48:49], s[68:69]
    s_mov_b64 s[50:51], s[76:77]
    v_and_b32 v3, 31, v0
    v_bfe_u32 v4, v0, 5, 1
    s_lshl_b32 s57, s2, 8
    s_and_b32 s26, s24, 3
    s_lshl_b32 s26, s26, 2
    s_and_b32 s27, s25, 3
    s_add_u32 s26, s26, s27
    s_lshr_b32 s27, s24, 2
    s_lshl_b32 s27, s27, 3
    s_lshr_b32 s29, s25, 2
    s_add_u32 s27, s27, s29
    s_and_b32 s35, s28, 1
    s_lshr_b32 s36, s28, 1
    v_lshrrev_b32 v6, 2, v2
    v_and_b32 v7, 3, v2
    v_lshrrev_b32 v8, 4, v2
    v_sub_u32 v8, 0, v8
    v_and_b32 v8, 3, v8
    v_xor_b32 v8, v8, v7
    s_lshl_b32 s29, s26, 7
    s_lshl_b32 s30, s28, 5
    s_add_u32 s29, s29, s30
    v_add_u32 v9, s29, v6
    v_mul_u32_u24 v9, 1280, v9
    v_lshl_add_u32 v5, v8, 4, v9
    s_lshl_b32 s29, s35, 4
    v_add_u32 v9, s29, v6
    v_mul_u32_u24 v9, 3072, v9
    v_xor_b32 v8, v4, v7
    s_mul_i32 s29, s27, 192
    v_lshl_add_u32 v9, v8, 4, v9
    v_add_u32 v6, s29, v9
    s_lshl_b32 s31, s28, 11
    s_mul_i32 s32, s28, 3072
    s_add_u32 s32, s32, 8192
    s_cmp_eq_u32 s36, 0
    s_cselect_b32 s6, s44, s46
    s_cselect_b32 s7, s45, s47
    s_and_b32 s38, s25, 3
    s_mul_i32 s38, s38, 5
    s_and_b32 s39, s24, 3
    s_add_u32 s38, s38, s39
    s_cmp_ge_u32 s38, 20
    s_cselect_b32 s39, 20, 0
    s_sub_u32 s38, s38, s39
    s_and_b32 s38, s38, 30
    s_mov_b32 s12, s4
    s_mov_b32 s13, s5
    s_mov_b32 s14, 0x280000
    s_mov_b32 s15, 0x00020000
    s_mov_b32 s16, s6
    s_mov_b32 s17, s7
    s_mov_b32 s18, 0x1e0000
    s_mov_b32 s19, 0x00020000
    s_add_u32 s40, s10, 0xb00000
    s_addc_u32 s41, s11, 0
    s_mov_b32 s42, 0x600000
    s_mov_b32 s43, 0x00020000
    v_and_b32 v3, 15, v2
    v_lshrrev_b32 v23, 4, v2
    v_lshrrev_b32 v8, 2, v3
    v_sub_u32 v8, 0, v8
    v_and_b32 v8, 3, v8
    v_xor_b32 v8, v8, v23
    v_lshlrev_b32 v8, 4, v8
    v_lshl_add_u32 v8, v3, 6, v8
    s_lshl_b32 s29, s35, 12
    v_add_u32 v10, s29, v8
    v_and_b32 v7, 1, v2
    v_lshlrev_b32 v7, 3, v7
    v_bfe_u32 v9, v2, 1, 1
    v_lshl_add_u32 v7, v9, 5, v7
    v_bfe_u32 v9, v2, 2, 2
    v_lshl_add_u32 v7, v9, 6, v7
    v_mul_u32_u24 v8, 3072, v4
    v_add_u32 v7, v7, v8
    v_bfe_u32 v9, v2, 4, 1
    v_lshl_add_u32 v7, v9, 9, v7
    v_lshlrev_b32 v9, 4, v9
    v_add_u32 v7, 8192, v7
    s_lshl_b32 s30, s36, 11
    v_add3_u32 v11, v7, v9, s30
    v_xor_b32 v12, 16, v11
    s_lshl_b32 s29, s36, 4
    v_xor_b32 v8, s29, v9
    v_add_u32 v8, 1024, v8
    v_add_u32 v13, v7, v8
    v_add_u32 v14, 40960, v10
    v_add_u32 v15, 40960, v11
    v_add_u32 v16, 40960, v12
    v_add_u32 v17, 40960, v13
    s_lshl_b32 s29, s26, 2
    s_lshl_b32 s30, s35, 1
    s_add_u32 s29, s29, s30
    s_mul_i32 s29, s29, 96
    s_mul_i32 s30, s27, 6
    s_add_u32 s29, s29, s30
    s_lshl_b32 s29, s29, 10
    v_lshlrev_b32 v18, 4, v3
    v_lshl_add_u32 v18, v23, 9, v18
    s_lshl_b32 s30, s36, 12
    s_add_u32 s30, s30, s29
    v_add_u32 v20, s30, v18
    s_lshl_b32 s30, s36, 3
    s_add_u32 s30, s30, s29
    s_add_u32 s30, s30, 2048
    v_add_u32 v19, s30, v18
    s_mov_b32 s37, 98304
    s_mul_i32 s29, s3, 3856
    s_lshr_b32 s29, s29, 16
    s_mul_i32 s30, s29, 17
    s_sub_u32 s30, s3, s30
    s_lshl_b32 s53, s30, 7
    s_lshl_b32 s54, s28, 5
    s_add_u32 s53, s53, s54
    s_mov_b32 s54, 0
    s_mov_b32 s55, 4
    s_mov_b32 s46, 1966080
    s_cmp_ge_u32 s30, 12
    s_cbranch_scc0 B_rp_wd
    s_sub_u32 s30, s30, 12
    s_lshl_b32 s30, s30, 2
    s_add_u32 s30, s30, s28
    s_cmp_ge_u32 s30, 10
    s_cselect_b32 s52, 20, 0
    s_cselect_b32 s53, 10, 0
    s_sub_u32 s30, s30, s53
    s_lshr_b32 s53, s29, 2
    s_add_u32 s53, s53, s29
    s_add_u32 s30, s30, s53
    s_cmp_ge_u32 s30, 10
    s_cselect_b32 s53, 10, 0
    s_sub_u32 s30, s30, s53
    s_mul_i32 s53, s30, 80
    s_mul_i32 s58, s30, 320
    s_sub_u32 s58, s58, 2544
    s_mov_b32 s54, 30720
    s_mov_b32 s50, s48
    s_mov_b32 s51, s49
    s_mov_b32 s46, 819200
    s_cmp_ge_u32 s30, 8
    s_cselect_b32 s53, s58, s53
    s_cselect_b32 s54, 46080, s54
    s_cselect_b32 s55, 2, s55
    s_add_u32 s53, s53, s52
B_rp_wd:
    s_mov_b32 s44, s50
    s_mov_b32 s45, s51
    s_mov_b32 s47, 0x00020000
    s_cmp_lt_u32 s3, 136
    s_cselect_b32 s46, s46, 0
    s_mul_i32 s53, s53, 1280
    s_mul_i32 s30, s29, 160
    s_add_u32 s53, s53, s30
    s_mul_i32 s30, s28, 320
    v_add_u32 v9, s30, v2
    s_add_u32 s96, s29, 96
    s_cmp_lt_u32 s3, 136
    s_cselect_b32 s96, s96, 200
    s_lshl_b32 s97, s26, 1
    s_add_u32 s97, s97, 32
    v_add_u32 v24, 0, v2
    v_mul_u32_u24 v25, 6554, v24
    v_lshrrev_b32 v25, 16, v25
    v_mul_u32_u24 v7, 10, v25
    v_sub_u32 v7, v24, v7
    v_mul_u32_u24 v24, 1280, v25
    v_lshl_add_u32 v24, v7, 4, v24
    v_lshrrev_b32 v25, s55, v25
    v_mul_u32_u24 v25, s54, v25
    v_add_u32 v208, v24, v25
    v_add_u32 v24, 64, v2
    v_mul_u32_u24 v25, 6554, v24
    v_lshrrev_b32 v25, 16, v25
    v_mul_u32_u24 v7, 10, v25
    v_sub_u32 v7, v24, v7
    v_mul_u32_u24 v24, 1280, v25
    v_lshl_add_u32 v24, v7, 4, v24
    v_lshrrev_b32 v25, s55, v25
    v_mul_u32_u24 v25, s54, v25
    v_add_u32 v209, v24, v25
    v_add_u32 v24, 128, v2
    v_mul_u32_u24 v25, 6554, v24
    v_lshrrev_b32 v25, 16, v25
    v_mul_u32_u24 v7, 10, v25
    v_sub_u32 v7, v24, v7
    v_mul_u32_u24 v24, 1280, v25
    v_lshl_add_u32 v24, v7, 4, v24
    v_lshrrev_b32 v25, s55, v25
    v_mul_u32_u24 v25, s54, v25
    v_add_u32 v210, v24, v25
    v_add_u32 v24, 192, v2
    v_mul_u32_u24 v25, 6554, v24
    v_lshrrev_b32 v25, 16, v25
    v_mul_u32_u24 v7, 10, v25
    v_sub_u32 v7, v24, v7
    v_mul_u32_u24 v24, 1280, v25
    v_lshl_add_u32 v24, v7, 4, v24
    v_lshrrev_b32 v25, s55, v25
    v_mul_u32_u24 v25, s54, v25
    v_add_u32 v211, v24, v25
    v_add_u32 v24, 256, v2
    v_mul_u32_u24 v25, 6554, v24
    v_lshrrev_b32 v25, 16, v25
    v_mul_u32_u24 v7, 10, v25
    v_sub_u32 v7, v24, v7
    v_mul_u32_u24 v24, 1280, v25
    v_lshl_add_u32 v24, v7, 4, v24
    v_lshrrev_b32 v25, s55, v25
    v_mul_u32_u24 v25, s54, v25
    v_add_u32 v212, v24, v25
    s_mul_i32 s54, s28, 5120
    s_add_u32 s52, s54, 61440
    v_bfe_u32 v25, v2, 2, 3
    v_mul_u32_u24 v25, 160, v25
    v_and_b32 v7, 3, v2
    v_lshl_add_u32 v25, v7, 3, v25
    v_add_u32 v25, s52, v25
    v_mov_b32 v8, 2400
    v_add_u32 v7, 0, v4
    v_cmp_lt_u32 vcc, 4, v7
    v_lshlrev_b32 v7, 5, v7
    s_nop 0
    v_cndmask_b32 v24, 0, v8, vcc
    v_add3_u32 v213, v25, v7, v24
    v_add_u32 v7, 2, v4
    v_cmp_lt_u32 vcc, 4, v7
    v_lshlrev_b32 v7, 5, v7
    s_nop 0
    v_cndmask_b32 v24, 0, v8, vcc
    v_add3_u32 v214, v25, v7, v24
    v_add_u32 v7, 4, v4
    v_cmp_lt_u32 vcc, 4, v7
    v_lshlrev_b32 v7, 5, v7
    s_nop 0
    v_cndmask_b32 v24, 0, v8, vcc
    v_add3_u32 v215, v25, v7, v24
    v_add_u32 v7, 6, v4
    v_cmp_lt_u32 vcc, 4, v7
    v_lshlrev_b32 v7, 5, v7
    s_nop 0
    v_cndmask_b32 v24, 0, v8, vcc
    v_add3_u32 v216, v25, v7, v24
    v_add_u32 v7, 8, v4
    v_cmp_lt_u32 vcc, 4, v7
    v_lshlrev_b32 v7, 5, v7
    s_nop 0
    v_cndmask_b32 v24, 0, v8, vcc
    v_add3_u32 v217, v25, v7, v24
    s_mul_i32 s29, s3, 20480
    v_lshlrev_b32 v218, 4, v9
    v_add_u32 v218, s29, v218
    v_add_u32 v219, 0x1000, v218
    v_lshlrev_b32 v21, 4, v2
    v_add_u32 v21, s54, v21
    v_add_u32 v1, 0x1000, v21
    s_lshr_b32 s29, s25, 2
    s_mul_i32 s29, s29, 348160
    s_add_u32 s29, s29, 0x1400000
    s_add_u32 s4, s10, 0x1400000
    s_addc_u32 s5, s11, 0
    s_mov_b32 s6, 0x2a8000
    s_mov_b32 s7, 0x00020000
    s_add_u32 s48, s10, s29
    s_addc_u32 s49, s11, 0
    s_mov_b32 s50, 0x55000
    s_mov_b32 s51, 0x00020000
    s_mov_b64 s[82:83], s[52:53]
    s_mov_b64 s[84:85], s[54:55]
    s_mov_b32 s52, s8
    s_mov_b32 s53, s9
    s_mov_b32 s54, 0x100
    s_mov_b32 s55, 0x00020000
    s_cmp_lg_u32 s28, 0
    s_cbranch_scc1 B_init_done
    v_mov_b32 v222, 0
    s_mov_b32 s59, 0
B_init:
    buffer_load_dword v223, v222, s[52:55], 0 offen sc1
    s_add_u32 s59, s59, 1
    s_waitcnt vmcnt(0)
    v_readfirstlane_b32 s58, v223
    s_cmp_lg_u32 s58, 0
    s_cbranch_scc1 B_init_done
    s_cmp_gt_u32 s59, 0x100000
    s_cbranch_scc1 B_init_done
    s_sleep 8
    s_branch B_init
B_init_done:
    s_mov_b64 s[52:53], s[82:83]
    s_mov_b64 s[54:55], s[84:85]
    s_cmp_eq_u32 s27, 15
    s_cbranch_scc1 B_start_done
    s_cmp_lg_u32 s28, 0
    s_cbranch_scc1 B_start_done
    s_add_u32 s98, s60, s57
    s_addc_u32 s99, s61, 0
    s_mov_b32 s59, 0
B_start:
    s_load_dword s58, s[98:99], 4 glc
    s_add_u32 s59, s59, 1
    s_waitcnt lgkmcnt(0)
    s_cmp_lg_u32 s58, 0
    s_cbranch_scc1 B_start_done
    s_cmp_gt_u32 s59, 200
    s_cbranch_scc1 B_start_done
    s_sleep 2
    s_branch B_start
B_start_done:
    s_barrier
    s_lshr_b32 s29, s25, 2
    s_add_u32 s55, s25, s29
    s_and_b32 s55, s55, 3
    s_mul_i32 s55, s55, 3
    s_add_u32 s57, s29, 96
    s_lshl_b32 s57, s57, 8
    s_add_u32 m0, s31, 0
    s_lshl_b32 s33, s38, 6
    buffer_load_dwordx4 v5, s[12:15], s33 offen lds
    s_add_u32 m0, s31, 1024
    s_add_u32 s33, s33, 20480
    buffer_load_dwordx4 v5, s[12:15], s33 offen lds
    s_add_u32 m0, s32, 0
    s_mul_i32 s34, s38, 98304
    buffer_load_dwordx4 v6, s[16:19], s34 offen lds
    s_add_u32 m0, s32, 960
    s_add_u32 s38, s38, 1
    buffer_load_dwordx4 v6, s[16:19], s34 offen offset:64 lds
    s_add_u32 m0, s32, 1920
    s_cmp_eq_u32 s38, 20
    s_cselect_b32 s38, 0, s38
    buffer_load_dwordx4 v6, s[16:19], s34 offen offset:128 lds
    s_add_u32 m0, s52, 0
    s_nop 0
    buffer_load_dwordx4 v208, s[44:47], s53 offen lds
    s_add_u32 m0, s52, 1024
    s_nop 0
    buffer_load_dwordx4 v209, s[44:47], s53 offen lds
    s_add_u32 m0, s52, 2048
    s_nop 0
    buffer_load_dwordx4 v210, s[44:47], s53 offen lds
    s_add_u32 m0, s52, 3072
    s_nop 0
    buffer_load_dwordx4 v211, s[44:47], s53 offen lds
    s_add_u32 m0, s52, 4096
    s_nop 0
    buffer_load_dwordx4 v212, s[44:47], s53 offen lds
    s_add_u32 m0, s31, 20480
    s_lshl_b32 s33, s38, 6
    buffer_load_dwordx4 v5, s[12:15], s33 offen lds
    s_add_u32 m0, s31, 21504
    s_add_u32 s33, s33, 20480
    buffer_load_dwordx4 v5, s[12:15], s33 offen lds
    s_add_u32 m0, s32, 20480
    s_mul_i32 s34, s38, 98304
    buffer_load_dwordx4 v6, s[16:19], s34 offen lds
    s_add_u32 m0, s32, 21440
    s_add_u32 s38, s38, 1
    buffer_load_dwordx4 v6, s[16:19], s34 offen offset:64 lds
    s_add_u32 m0, s32, 22400
    s_cmp_eq_u32 s38, 20
    s_cselect_b32 s38, 0, s38
    buffer_load_dwordx4 v6, s[16:19], s34 offen offset:128 lds
    s_add_u32 m0, s31, 40960
    s_lshl_b32 s33, s38, 6
    buffer_load_dwordx4 v5, s[12:15], s33 offen lds
    s_add_u32 m0, s31, 41984
    s_add_u32 s33, s33, 20480
    buffer_load_dwordx4 v5, s[12:15], s33 offen lds
    s_add_u32 m0, s32, 40960
    s_mul_i32 s34, s38, 98304
    buffer_load_dwordx4 v6, s[16:19], s34 offen lds
    s_add_u32 m0, s32, 41920
    s_add_u32 s38, s38, 1
    buffer_load_dwordx4 v6, s[16:19], s34 offen offset:64 lds
    s_add_u32 m0, s32, 42880
    s_cmp_eq_u32 s38, 20
    s_cselect_b32 s38, 0, s38
    buffer_load_dwordx4 v6, s[16:19], s34 offen offset:128 lds
    s_waitcnt vmcnt(10)
    ds_read_b64_tr_b16 v[188:189], v213 offset:0
    ds_read_b64_tr_b16 v[190:191], v213 offset:1280
    ds_read_b64_tr_b16 v[192:193], v214 offset:0
    ds_read_b64_tr_b16 v[194:195], v214 offset:1280
    ds_read_b64_tr_b16 v[196:197], v215 offset:0
    ds_read_b64_tr_b16 v[198:199], v215 offset:1280
    ds_read_b64_tr_b16 v[200:201], v216 offset:0
    ds_read_b64_tr_b16 v[202:203], v216 offset:1280
    ds_read_b64_tr_b16 v[204:205], v217 offset:0
    ds_read_b64_tr_b16 v[206:207], v217 offset:1280
    s_waitcnt vmcnt(5) lgkmcnt(0)
    s_barrier
    s_add_u32 m0, s31, 61440
    s_lshl_b32 s33, s38, 6
    buffer_load_dwordx4 v5, s[12:15], s33 offen lds
    s_add_u32 m0, s31, 62464
    s_add_u32 s33, s33, 20480
    buffer_load_dwordx4 v5, s[12:15], s33 offen lds
    s_add_u32 m0, s32, 61440
    s_mul_i32 s34, s38, 98304
    buffer_load_dwordx4 v6, s[16:19], s34 offen lds
    s_add_u32 m0, s32, 62400
    s_add_u32 s38, s38, 1
    buffer_load_dwordx4 v6, s[16:19], s34 offen offset:64 lds
    s_add_u32 m0, s32, 63360
    s_cmp_eq_u32 s38, 20
    s_cselect_b32 s38, 0, s38
    buffer_load_dwordx4 v6, s[16:19], s34 offen offset:128 lds
    ds_read_b128 v[32:35], v10 offset:0
    ds_read_b128 v[36:39], v10 offset:1024
    ds_read_b128 v[40:43], v10 offset:2048
    ds_read_b128 v[44:47], v10 offset:3072
    ds_read_b64_tr_b16 v[48:49], v11 offset:0
    ds_read_b64_tr_b16 v[50:51], v11 offset:256
    ds_read_b64_tr_b16 v[52:53], v11 offset:6144
    ds_read_b64_tr_b16 v[54:55], v11 offset:6400
    ds_read_b64_tr_b16 v[56:57], v12 offset:0
    ds_read_b64_tr_b16 v[58:59], v12 offset:256
    ds_read_b64_tr_b16 v[60:61], v12 offset:6144
    ds_read_b64_tr_b16 v[62:63], v12 offset:6400
    buffer_store_dwordx4 v[188:191], v218, s[4:7], 0 offen offset:0 sc1
    buffer_store_dwordx4 v[192:195], v218, s[4:7], 0 offen offset:1024 sc1
    buffer_store_dwordx4 v[196:199], v218, s[4:7], 0 offen offset:2048 sc1
    buffer_store_dwordx4 v[200:203], v218, s[4:7], 0 offen offset:3072 sc1
    buffer_store_dwordx4 v[204:207], v219, s[4:7], 0 offen offset:0 sc1
    s_waitcnt lgkmcnt(8)
    ds_read_b64_tr_b16 v[64:65], v13 offset:0
    ds_read_b64_tr_b16 v[66:67], v13 offset:256
    ds_read_b64_tr_b16 v[68:69], v13 offset:6144
    ds_read_b64_tr_b16 v[70:71], v13 offset:6400
    s_waitcnt lgkmcnt(0)
    v_mfma_f32_16x16x32_bf16 v[112:115], v[48:51], v[32:35], 0
    ds_read_b128 v[72:75], v10 offset:20480
    v_mfma_f32_16x16x32_bf16 v[116:119], v[48:51], v[36:39], 0
    ds_read_b128 v[76:79], v10 offset:21504
    v_mfma_f32_16x16x32_bf16 v[120:123], v[48:51], v[40:43], 0
    ds_read_b128 v[80:83], v10 offset:22528
    v_mfma_f32_16x16x32_bf16 v[124:127], v[48:51], v[44:47], 0
    ds_read_b128 v[84:87], v10 offset:23552
    v_mfma_f32_16x16x32_bf16 v[128:131], v[52:55], v[32:35], 0
    ds_read_b64_tr_b16 v[88:89], v11 offset:20480
    v_mfma_f32_16x16x32_bf16 v[132:135], v[52:55], v[36:39], 0
    ds_read_b64_tr_b16 v[90:91], v11 offset:20736
    v_mfma_f32_16x16x32_bf16 v[136:139], v[52:55], v[40:43], 0
    ds_read_b64_tr_b16 v[92:93], v11 offset:26624
    v_mfma_f32_16x16x32_bf16 v[140:143], v[52:55], v[44:47], 0
    ds_read_b64_tr_b16 v[94:95], v11 offset:26880
    v_mfma_f32_16x16x32_bf16 v[144:147], v[56:59], v[32:35], 0
    ds_read_b64_tr_b16 v[96:97], v12 offset:20480
    v_mfma_f32_16x16x32_bf16 v[148:151], v[56:59], v[36:39], 0
    ds_read_b64_tr_b16 v[98:99], v12 offset:20736
    v_mfma_f32_16x16x32_bf16 v[152:155], v[56:59], v[40:43], 0
    ds_read_b64_tr_b16 v[100:101], v12 offset:26624
    v_mfma_f32_16x16x32_bf16 v[156:159], v[56:59], v[44:47], 0
    ds_read_b64_tr_b16 v[102:103], v12 offset:26880
    v_mfma_f32_16x16x32_bf16 v[160:163], v[60:63], v[32:35], 0
    s_waitcnt lgkmcnt(8)
    ds_read_b64_tr_b16 v[104:105], v13 offset:20480
    v_mfma_f32_16x16x32_bf16 v[164:167], v[60:63], v[36:39], 0
    ds_read_b64_tr_b16 v[106:107], v13 offset:20736
    v_mfma_f32_16x16x32_bf16 v[168:171], v[60:63], v[40:43], 0
    ds_read_b64_tr_b16 v[108:109], v13 offset:26624
    v_mfma_f32_16x16x32_bf16 v[172:175], v[60:63], v[44:47], 0
    ds_read_b64_tr_b16 v[110:111], v13 offset:26880
    v_mfma_f32_16x16x32_bf16 v[176:179], v[64:67], v[32:35], 0
    v_mfma_f32_16x16x32_bf16 v[180:183], v[64:67], v[36:39], 0
    v_mfma_f32_16x16x32_bf16 v[184:187], v[64:67], v[40:43], 0
    v_mfma_f32_16x16x32_bf16 v[188:191], v[64:67], v[44:47], 0
    v_mfma_f32_16x16x32_bf16 v[192:195], v[68:71], v[32:35], 0
    v_mfma_f32_16x16x32_bf16 v[196:199], v[68:71], v[36:39], 0
    v_mfma_f32_16x16x32_bf16 v[200:203], v[68:71], v[40:43], 0
    v_mfma_f32_16x16x32_bf16 v[204:207], v[68:71], v[44:47], 0
    s_waitcnt vmcnt(0) lgkmcnt(0)
    s_barrier
    s_cmp_ge_u32 s3, 136
    s_cbranch_scc1 B_sigw
    s_cmp_lg_u32 s28, 0
    s_cbranch_scc1 B_sigw
    s_lshl_b32 s58, s96, 8
    s_add_u32 s100, s60, s58
    s_addc_u32 s101, s61, 0
    s_mov_b32 s95, 0x20000
    s_atomic_add s95, s[100:101], 0
    B_sigw:
    v_mfma_f32_16x16x32_bf16 v[112:115], v[88:91], v[72:75], v[112:115]
    ds_read_b128 v[32:35], v14 offset:0
    v_mfma_f32_16x16x32_bf16 v[116:119], v[88:91], v[76:79], v[116:119]
    ds_read_b128 v[36:39], v14 offset:1024
    s_add_u32 m0, s31, 0
    s_lshl_b32 s33, s38, 6
    buffer_load_dwordx4 v5, s[12:15], s33 offen lds
    v_mfma_f32_16x16x32_bf16 v[120:123], v[88:91], v[80:83], v[120:123]
    ds_read_b128 v[40:43], v14 offset:2048
    v_mfma_f32_16x16x32_bf16 v[124:127], v[88:91], v[84:87], v[124:127]
    ds_read_b128 v[44:47], v14 offset:3072
    s_add_u32 m0, s31, 1024
    s_add_u32 s33, s33, 20480
    buffer_load_dwordx4 v5, s[12:15], s33 offen lds
    v_mfma_f32_16x16x32_bf16 v[128:131], v[92:95], v[72:75], v[128:131]
    ds_read_b64_tr_b16 v[48:49], v15 offset:0
    v_mfma_f32_16x16x32_bf16 v[132:135], v[92:95], v[76:79], v[132:135]
    ds_read_b64_tr_b16 v[50:51], v15 offset:256
    s_add_u32 m0, s32, 0
    s_mul_i32 s34, s38, 98304
    buffer_load_dwordx4 v6, s[16:19], s34 offen lds
    v_mfma_f32_16x16x32_bf16 v[136:139], v[92:95], v[80:83], v[136:139]
    ds_read_b64_tr_b16 v[52:53], v15 offset:6144
    v_mfma_f32_16x16x32_bf16 v[140:143], v[92:95], v[84:87], v[140:143]
    ds_read_b64_tr_b16 v[54:55], v15 offset:6400
    s_add_u32 m0, s32, 960
    s_add_u32 s38, s38, 1
    buffer_load_dwordx4 v6, s[16:19], s34 offen offset:64 lds
    v_mfma_f32_16x16x32_bf16 v[144:147], v[96:99], v[72:75], v[144:147]
    ds_read_b64_tr_b16 v[56:57], v16 offset:0
    v_mfma_f32_16x16x32_bf16 v[148:151], v[96:99], v[76:79], v[148:151]
    ds_read_b64_tr_b16 v[58:59], v16 offset:256
    s_add_u32 m0, s32, 1920
    s_cmp_eq_u32 s38, 20
    s_cselect_b32 s38, 0, s38
    buffer_load_dwordx4 v6, s[16:19], s34 offen offset:128 lds
    v_mfma_f32_16x16x32_bf16 v[152:155], v[96:99], v[80:83], v[152:155]
    ds_read_b64_tr_b16 v[60:61], v16 offset:6144
    v_mfma_f32_16x16x32_bf16 v[156:159], v[96:99], v[84:87], v[156:159]
    ds_read_b64_tr_b16 v[62:63], v16 offset:6400
    s_add_u32 m0, s31, 20480
    s_lshl_b32 s33, s38, 6
    buffer_load_dwordx4 v5, s[12:15], s33 offen lds
    v_mfma_f32_16x16x32_bf16 v[160:163], v[100:103], v[72:75], v[160:163]
    s_waitcnt lgkmcnt(8)
    ds_read_b64_tr_b16 v[64:65], v17 offset:0
    v_mfma_f32_16x16x32_bf16 v[164:167], v[100:103], v[76:79], v[164:167]
    ds_read_b64_tr_b16 v[66:67], v17 offset:256
    s_add_u32 m0, s31, 21504
    s_add_u32 s33, s33, 20480
    buffer_load_dwordx4 v5, s[12:15], s33 offen lds
    v_mfma_f32_16x16x32_bf16 v[168:171], v[100:103], v[80:83], v[168:171]
    ds_read_b64_tr_b16 v[68:69], v17 offset:6144
    v_mfma_f32_16x16x32_bf16 v[172:175], v[100:103], v[84:87], v[172:175]
    ds_read_b64_tr_b16 v[70:71], v17 offset:6400
    s_add_u32 m0, s32, 20480
    s_mul_i32 s34, s38, 98304
    buffer_load_dwordx4 v6, s[16:19], s34 offen lds
    v_mfma_f32_16x16x32_bf16 v[176:179], v[104:107], v[72:75], v[176:179]
    v_mfma_f32_16x16x32_bf16 v[180:183], v[104:107], v[76:79], v[180:183]
    s_add_u32 m0, s32, 21440
    s_add_u32 s38, s38, 1
    buffer_load_dwordx4 v6, s[16:19], s34 offen offset:64 lds
    v_mfma_f32_16x16x32_bf16 v[184:187], v[104:107], v[80:83], v[184:187]
    v_mfma_f32_16x16x32_bf16 v[188:191], v[104:107], v[84:87], v[188:191]
    s_add_u32 m0, s32, 22400
    s_cmp_eq_u32 s38, 20
    s_cselect_b32 s38, 0, s38
    buffer_load_dwordx4 v6, s[16:19], s34 offen offset:128 lds
    v_mfma_f32_16x16x32_bf16 v[192:195], v[108:111], v[72:75], v[192:195]
    v_mfma_f32_16x16x32_bf16 v[196:199], v[108:111], v[76:79], v[196:199]
    v_mfma_f32_16x16x32_bf16 v[200:203], v[108:111], v[80:83], v[200:203]
    v_mfma_f32_16x16x32_bf16 v[204:207], v[108:111], v[84:87], v[204:207]
    s_waitcnt lgkmcnt(0)
    v_mfma_f32_16x16x32_bf16 v[112:115], v[48:51], v[32:35], v[112:115]
    ds_read_b128 v[72:75], v14 offset:20480
    v_mfma_f32_16x16x32_bf16 v[116:119], v[48:51], v[36:39], v[116:119]
    ds_read_b128 v[76:79], v14 offset:21504
    v_mfma_f32_16x16x32_bf16 v[120:123], v[48:51], v[40:43], v[120:123]
    ds_read_b128 v[80:83], v14 offset:22528
    v_mfma_f32_16x16x32_bf16 v[124:127], v[48:51], v[44:47], v[124:127]
    ds_read_b128 v[84:87], v14 offset:23552
    v_mfma_f32_16x16x32_bf16 v[128:131], v[52:55], v[32:35], v[128:131]
    ds_read_b64_tr_b16 v[88:89], v15 offset:20480
    v_mfma_f32_16x16x32_bf16 v[132:135], v[52:55], v[36:39], v[132:135]
    ds_read_b64_tr_b16 v[90:91], v15 offset:20736
    v_mfma_f32_16x16x32_bf16 v[136:139], v[52:55], v[40:43], v[136:139]
    ds_read_b64_tr_b16 v[92:93], v15 offset:26624
    v_mfma_f32_16x16x32_bf16 v[140:143], v[52:55], v[44:47], v[140:143]
    ds_read_b64_tr_b16 v[94:95], v15 offset:26880
    v_mfma_f32_16x16x32_bf16 v[144:147], v[56:59], v[32:35], v[144:147]
    ds_read_b64_tr_b16 v[96:97], v16 offset:20480
    v_mfma_f32_16x16x32_bf16 v[148:151], v[56:59], v[36:39], v[148:151]
    ds_read_b64_tr_b16 v[98:99], v16 offset:20736
    v_mfma_f32_16x16x32_bf16 v[152:155], v[56:59], v[40:43], v[152:155]
    ds_read_b64_tr_b16 v[100:101], v16 offset:26624
    v_mfma_f32_16x16x32_bf16 v[156:159], v[56:59], v[44:47], v[156:159]
    ds_read_b64_tr_b16 v[102:103], v16 offset:26880
    v_mfma_f32_16x16x32_bf16 v[160:163], v[60:63], v[32:35], v[160:163]
    s_waitcnt lgkmcnt(8)
    ds_read_b64_tr_b16 v[104:105], v17 offset:20480
    v_mfma_f32_16x16x32_bf16 v[164:167], v[60:63], v[36:39], v[164:167]
    ds_read_b64_tr_b16 v[106:107], v17 offset:20736
    v_mfma_f32_16x16x32_bf16 v[168:171], v[60:63], v[40:43], v[168:171]
    ds_read_b64_tr_b16 v[108:109], v17 offset:26624
    v_mfma_f32_16x16x32_bf16 v[172:175], v[60:63], v[44:47], v[172:175]
    ds_read_b64_tr_b16 v[110:111], v17 offset:26880
    v_mfma_f32_16x16x32_bf16 v[176:179], v[64:67], v[32:35], v[176:179]
    v_mfma_f32_16x16x32_bf16 v[180:183], v[64:67], v[36:39], v[180:183]
    v_mfma_f32_16x16x32_bf16 v[184:187], v[64:67], v[40:43], v[184:187]
    v_mfma_f32_16x16x32_bf16 v[188:191], v[64:67], v[44:47], v[188:191]
    v_mfma_f32_16x16x32_bf16 v[192:195], v[68:71], v[32:35], v[192:195]
    v_mfma_f32_16x16x32_bf16 v[196:199], v[68:71], v[36:39], v[196:199]
    v_mfma_f32_16x16x32_bf16 v[200:203], v[68:71], v[40:43], v[200:203]
    v_mfma_f32_16x16x32_bf16 v[204:207], v[68:71], v[44:47], v[204:207]
    s_waitcnt vmcnt(0) lgkmcnt(0)
    s_barrier
    v_mfma_f32_16x16x32_bf16 v[112:115], v[88:91], v[72:75], v[112:115]
    ds_read_b128 v[32:35], v10 offset:0
    v_mfma_f32_16x16x32_bf16 v[116:119], v[88:91], v[76:79], v[116:119]
    ds_read_b128 v[36:39], v10 offset:1024
    s_add_u32 m0, s31, 40960
    s_lshl_b32 s33, s38, 6
    buffer_load_dwordx4 v5, s[12:15], s33 offen lds
    v_mfma_f32_16x16x32_bf16 v[120:123], v[88:91], v[80:83], v[120:123]
    ds_read_b128 v[40:43], v10 offset:2048
    v_mfma_f32_16x16x32_bf16 v[124:127], v[88:91], v[84:87], v[124:127]
    ds_read_b128 v[44:47], v10 offset:3072
    s_add_u32 m0, s31, 41984
    s_add_u32 s33, s33, 20480
    buffer_load_dwordx4 v5, s[12:15], s33 offen lds
    v_mfma_f32_16x16x32_bf16 v[128:131], v[92:95], v[72:75], v[128:131]
    ds_read_b64_tr_b16 v[48:49], v11 offset:0
    v_mfma_f32_16x16x32_bf16 v[132:135], v[92:95], v[76:79], v[132:135]
    ds_read_b64_tr_b16 v[50:51], v11 offset:256
    s_add_u32 m0, s32, 40960
    s_mul_i32 s34, s38, 98304
    buffer_load_dwordx4 v6, s[16:19], s34 offen lds
    v_mfma_f32_16x16x32_bf16 v[136:139], v[92:95], v[80:83], v[136:139]
    ds_read_b64_tr_b16 v[52:53], v11 offset:6144
    v_mfma_f32_16x16x32_bf16 v[140:143], v[92:95], v[84:87], v[140:143]
    ds_read_b64_tr_b16 v[54:55], v11 offset:6400
    s_add_u32 m0, s32, 41920
    s_add_u32 s38, s38, 1
    buffer_load_dwordx4 v6, s[16:19], s34 offen offset:64 lds
    v_mfma_f32_16x16x32_bf16 v[144:147], v[96:99], v[72:75], v[144:147]
    ds_read_b64_tr_b16 v[56:57], v12 offset:0
    v_mfma_f32_16x16x32_bf16 v[148:151], v[96:99], v[76:79], v[148:151]
    ds_read_b64_tr_b16 v[58:59], v12 offset:256
    s_add_u32 m0, s32, 42880
    s_cmp_eq_u32 s38, 20
    s_cselect_b32 s38, 0, s38
    buffer_load_dwordx4 v6, s[16:19], s34 offen offset:128 lds
    v_mfma_f32_16x16x32_bf16 v[152:155], v[96:99], v[80:83], v[152:155]
    ds_read_b64_tr_b16 v[60:61], v12 offset:6144
    v_mfma_f32_16x16x32_bf16 v[156:159], v[96:99], v[84:87], v[156:159]
    ds_read_b64_tr_b16 v[62:63], v12 offset:6400
    s_add_u32 m0, s31, 61440
    s_lshl_b32 s33, s38, 6
    buffer_load_dwordx4 v5, s[12:15], s33 offen lds
    v_mfma_f32_16x16x32_bf16 v[160:163], v[100:103], v[72:75], v[160:163]
    s_waitcnt lgkmcnt(8)
    ds_read_b64_tr_b16 v[64:65], v13 offset:0
    v_mfma_f32_16x16x32_bf16 v[164:167], v[100:103], v[76:79], v[164:167]
    ds_read_b64_tr_b16 v[66:67], v13 offset:256
    s_add_u32 m0, s31, 62464
    s_add_u32 s33, s33, 20480
    buffer_load_dwordx4 v5, s[12:15], s33 offen lds
    v_mfma_f32_16x16x32_bf16 v[168:171], v[100:103], v[80:83], v[168:171]
    ds_read_b64_tr_b16 v[68:69], v13 offset:6144
    v_mfma_f32_16x16x32_bf16 v[172:175], v[100:103], v[84:87], v[172:175]
    ds_read_b64_tr_b16 v[70:71], v13 offset:6400
    s_add_u32 m0, s32, 61440
    s_mul_i32 s34, s38, 98304
    buffer_load_dwordx4 v6, s[16:19], s34 offen lds
    v_mfma_f32_16x16x32_bf16 v[176:179], v[104:107], v[72:75], v[176:179]
    v_mfma_f32_16x16x32_bf16 v[180:183], v[104:107], v[76:79], v[180:183]
    s_add_u32 m0, s32, 62400
    s_add_u32 s38, s38, 1
    buffer_load_dwordx4 v6, s[16:19], s34 offen offset:64 lds
    v_mfma_f32_16x16x32_bf16 v[184:187], v[104:107], v[80:83], v[184:187]
    v_mfma_f32_16x16x32_bf16 v[188:191], v[104:107], v[84:87], v[188:191]
    s_add_u32 m0, s32, 63360
    s_cmp_eq_u32 s38, 20
    s_cselect_b32 s38, 0, s38
    buffer_load_dwordx4 v6, s[16:19], s34 offen offset:128 lds
    v_mfma_f32_16x16x32_bf16 v[192:195], v[108:111], v[72:75], v[192:195]
    v_mfma_f32_16x16x32_bf16 v[196:199], v[108:111], v[76:79], v[196:199]
    v_mfma_f32_16x16x32_bf16 v[200:203], v[108:111], v[80:83], v[200:203]
    v_mfma_f32_16x16x32_bf16 v[204:207], v[108:111], v[84:87], v[204:207]
    s_waitcnt lgkmcnt(0)
    v_mfma_f32_16x16x32_bf16 v[112:115], v[48:51], v[32:35], v[112:115]
    ds_read_b128 v[72:75], v10 offset:20480
    v_mfma_f32_16x16x32_bf16 v[116:119], v[48:51], v[36:39], v[116:119]
    ds_read_b128 v[76:79], v10 offset:21504
    v_mfma_f32_16x16x32_bf16 v[120:123], v[48:51], v[40:43], v[120:123]
    ds_read_b128 v[80:83], v10 offset:22528
    v_mfma_f32_16x16x32_bf16 v[124:127], v[48:51], v[44:47], v[124:127]
    ds_read_b128 v[84:87], v10 offset:23552
    v_mfma_f32_16x16x32_bf16 v[128:131], v[52:55], v[32:35], v[128:131]
    ds_read_b64_tr_b16 v[88:89], v11 offset:20480
    v_mfma_f32_16x16x32_bf16 v[132:135], v[52:55], v[36:39], v[132:135]
    ds_read_b64_tr_b16 v[90:91], v11 offset:20736
    v_mfma_f32_16x16x32_bf16 v[136:139], v[52:55], v[40:43], v[136:139]
    ds_read_b64_tr_b16 v[92:93], v11 offset:26624
    v_mfma_f32_16x16x32_bf16 v[140:143], v[52:55], v[44:47], v[140:143]
    ds_read_b64_tr_b16 v[94:95], v11 offset:26880
    v_mfma_f32_16x16x32_bf16 v[144:147], v[56:59], v[32:35], v[144:147]
    ds_read_b64_tr_b16 v[96:97], v12 offset:20480
    v_mfma_f32_16x16x32_bf16 v[148:151], v[56:59], v[36:39], v[148:151]
    ds_read_b64_tr_b16 v[98:99], v12 offset:20736
    v_mfma_f32_16x16x32_bf16 v[152:155], v[56:59], v[40:43], v[152:155]
    ds_read_b64_tr_b16 v[100:101], v12 offset:26624
    v_mfma_f32_16x16x32_bf16 v[156:159], v[56:59], v[44:47], v[156:159]
    ds_read_b64_tr_b16 v[102:103], v12 offset:26880
    v_mfma_f32_16x16x32_bf16 v[160:163], v[60:63], v[32:35], v[160:163]
    s_waitcnt lgkmcnt(8)
    ds_read_b64_tr_b16 v[104:105], v13 offset:20480
    v_mfma_f32_16x16x32_bf16 v[164:167], v[60:63], v[36:39], v[164:167]
    ds_read_b64_tr_b16 v[106:107], v13 offset:20736
    v_mfma_f32_16x16x32_bf16 v[168:171], v[60:63], v[40:43], v[168:171]
    ds_read_b64_tr_b16 v[108:109], v13 offset:26624
    v_mfma_f32_16x16x32_bf16 v[172:175], v[60:63], v[44:47], v[172:175]
    ds_read_b64_tr_b16 v[110:111], v13 offset:26880
    v_mfma_f32_16x16x32_bf16 v[176:179], v[64:67], v[32:35], v[176:179]
    v_mfma_f32_16x16x32_bf16 v[180:183], v[64:67], v[36:39], v[180:183]
    v_mfma_f32_16x16x32_bf16 v[184:187], v[64:67], v[40:43], v[184:187]
    v_mfma_f32_16x16x32_bf16 v[188:191], v[64:67], v[44:47], v[188:191]
    v_mfma_f32_16x16x32_bf16 v[192:195], v[68:71], v[32:35], v[192:195]
    v_mfma_f32_16x16x32_bf16 v[196:199], v[68:71], v[36:39], v[196:199]
    v_mfma_f32_16x16x32_bf16 v[200:203], v[68:71], v[40:43], v[200:203]
    v_mfma_f32_16x16x32_bf16 v[204:207], v[68:71], v[44:47], v[204:207]
    s_waitcnt vmcnt(0) lgkmcnt(0)
    s_barrier
    v_mfma_f32_16x16x32_bf16 v[112:115], v[88:91], v[72:75], v[112:115]
    ds_read_b128 v[32:35], v14 offset:0
    v_mfma_f32_16x16x32_bf16 v[116:119], v[88:91], v[76:79], v[116:119]
    ds_read_b128 v[36:39], v14 offset:1024
    s_add_u32 m0, s31, 0
    s_lshl_b32 s33, s38, 6
    buffer_load_dwordx4 v5, s[12:15], s33 offen lds
    v_mfma_f32_16x16x32_bf16 v[120:123], v[88:91], v[80:83], v[120:123]
    ds_read_b128 v[40:43], v14 offset:2048
    v_mfma_f32_16x16x32_bf16 v[124:127], v[88:91], v[84:87], v[124:127]
    ds_read_b128 v[44:47], v14 offset:3072
    s_add_u32 m0, s31, 1024
    s_add_u32 s33, s33, 20480
    buffer_load_dwordx4 v5, s[12:15], s33 offen lds
    v_mfma_f32_16x16x32_bf16 v[128:131], v[92:95], v[72:75], v[128:131]
    ds_read_b64_tr_b16 v[48:49], v15 offset:0
    v_mfma_f32_16x16x32_bf16 v[132:135], v[92:95], v[76:79], v[132:135]
    ds_read_b64_tr_b16 v[50:51], v15 offset:256
    s_add_u32 m0, s32, 0
    s_mul_i32 s34, s38, 98304
    buffer_load_dwordx4 v6, s[16:19], s34 offen lds
    v_mfma_f32_16x16x32_bf16 v[136:139], v[92:95], v[80:83], v[136:139]
    ds_read_b64_tr_b16 v[52:53], v15 offset:6144
    v_mfma_f32_16x16x32_bf16 v[140:143], v[92:95], v[84:87], v[140:143]
    ds_read_b64_tr_b16 v[54:55], v15 offset:6400
    s_add_u32 m0, s32, 960
    s_add_u32 s38, s38, 1
    buffer_load_dwordx4 v6, s[16:19], s34 offen offset:64 lds
    v_mfma_f32_16x16x32_bf16 v[144:147], v[96:99], v[72:75], v[144:147]
    ds_read_b64_tr_b16 v[56:57], v16 offset:0
    v_mfma_f32_16x16x32_bf16 v[148:151], v[96:99], v[76:79], v[148:151]
    ds_read_b64_tr_b16 v[58:59], v16 offset:256
    s_add_u32 m0, s32, 1920
    s_cmp_eq_u32 s38, 20
    s_cselect_b32 s38, 0, s38
    buffer_load_dwordx4 v6, s[16:19], s34 offen offset:128 lds
    v_mfma_f32_16x16x32_bf16 v[152:155], v[96:99], v[80:83], v[152:155]
    ds_read_b64_tr_b16 v[60:61], v16 offset:6144
    v_mfma_f32_16x16x32_bf16 v[156:159], v[96:99], v[84:87], v[156:159]
    ds_read_b64_tr_b16 v[62:63], v16 offset:6400
    s_add_u32 m0, s31, 20480
    s_lshl_b32 s33, s38, 6
    buffer_load_dwordx4 v5, s[12:15], s33 offen lds
    v_mfma_f32_16x16x32_bf16 v[160:163], v[100:103], v[72:75], v[160:163]
    s_waitcnt lgkmcnt(8)
    ds_read_b64_tr_b16 v[64:65], v17 offset:0
    v_mfma_f32_16x16x32_bf16 v[164:167], v[100:103], v[76:79], v[164:167]
    ds_read_b64_tr_b16 v[66:67], v17 offset:256
    s_add_u32 m0, s31, 21504
    s_add_u32 s33, s33, 20480
    buffer_load_dwordx4 v5, s[12:15], s33 offen lds
    v_mfma_f32_16x16x32_bf16 v[168:171], v[100:103], v[80:83], v[168:171]
    ds_read_b64_tr_b16 v[68:69], v17 offset:6144
    v_mfma_f32_16x16x32_bf16 v[172:175], v[100:103], v[84:87], v[172:175]
    ds_read_b64_tr_b16 v[70:71], v17 offset:6400
    s_add_u32 m0, s32, 20480
    s_mul_i32 s34, s38, 98304
    buffer_load_dwordx4 v6, s[16:19], s34 offen lds
    v_mfma_f32_16x16x32_bf16 v[176:179], v[104:107], v[72:75], v[176:179]
    v_mfma_f32_16x16x32_bf16 v[180:183], v[104:107], v[76:79], v[180:183]
    s_add_u32 m0, s32, 21440
    s_add_u32 s38, s38, 1
    buffer_load_dwordx4 v6, s[16:19], s34 offen offset:64 lds
    v_mfma_f32_16x16x32_bf16 v[184:187], v[104:107], v[80:83], v[184:187]
    v_mfma_f32_16x16x32_bf16 v[188:191], v[104:107], v[84:87], v[188:191]
    s_add_u32 m0, s32, 22400
    s_cmp_eq_u32 s38, 20
    s_cselect_b32 s38, 0, s38
    buffer_load_dwordx4 v6, s[16:19], s34 offen offset:128 lds
    v_mfma_f32_16x16x32_bf16 v[192:195], v[108:111], v[72:75], v[192:195]
    v_mfma_f32_16x16x32_bf16 v[196:199], v[108:111], v[76:79], v[196:199]
    v_mfma_f32_16x16x32_bf16 v[200:203], v[108:111], v[80:83], v[200:203]
    v_mfma_f32_16x16x32_bf16 v[204:207], v[108:111], v[84:87], v[204:207]
    s_waitcnt lgkmcnt(0)
    v_mfma_f32_16x16x32_bf16 v[112:115], v[48:51], v[32:35], v[112:115]
    ds_read_b128 v[72:75], v14 offset:20480
    v_mfma_f32_16x16x32_bf16 v[116:119], v[48:51], v[36:39], v[116:119]
    ds_read_b128 v[76:79], v14 offset:21504
    v_mfma_f32_16x16x32_bf16 v[120:123], v[48:51], v[40:43], v[120:123]
    ds_read_b128 v[80:83], v14 offset:22528
    v_mfma_f32_16x16x32_bf16 v[124:127], v[48:51], v[44:47], v[124:127]
    ds_read_b128 v[84:87], v14 offset:23552
    v_mfma_f32_16x16x32_bf16 v[128:131], v[52:55], v[32:35], v[128:131]
    ds_read_b64_tr_b16 v[88:89], v15 offset:20480
    v_mfma_f32_16x16x32_bf16 v[132:135], v[52:55], v[36:39], v[132:135]
    ds_read_b64_tr_b16 v[90:91], v15 offset:20736
    v_mfma_f32_16x16x32_bf16 v[136:139], v[52:55], v[40:43], v[136:139]
    ds_read_b64_tr_b16 v[92:93], v15 offset:26624
    v_mfma_f32_16x16x32_bf16 v[140:143], v[52:55], v[44:47], v[140:143]
    ds_read_b64_tr_b16 v[94:95], v15 offset:26880
    v_mfma_f32_16x16x32_bf16 v[144:147], v[56:59], v[32:35], v[144:147]
    ds_read_b64_tr_b16 v[96:97], v16 offset:20480
    v_mfma_f32_16x16x32_bf16 v[148:151], v[56:59], v[36:39], v[148:151]
    ds_read_b64_tr_b16 v[98:99], v16 offset:20736
    v_mfma_f32_16x16x32_bf16 v[152:155], v[56:59], v[40:43], v[152:155]
    ds_read_b64_tr_b16 v[100:101], v16 offset:26624
    v_mfma_f32_16x16x32_bf16 v[156:159], v[56:59], v[44:47], v[156:159]
    ds_read_b64_tr_b16 v[102:103], v16 offset:26880
    v_mfma_f32_16x16x32_bf16 v[160:163], v[60:63], v[32:35], v[160:163]
    s_waitcnt lgkmcnt(8)
    ds_read_b64_tr_b16 v[104:105], v17 offset:20480
    v_mfma_f32_16x16x32_bf16 v[164:167], v[60:63], v[36:39], v[164:167]
    ds_read_b64_tr_b16 v[106:107], v17 offset:20736
    v_mfma_f32_16x16x32_bf16 v[168:171], v[60:63], v[40:43], v[168:171]
    ds_read_b64_tr_b16 v[108:109], v17 offset:26624
    v_mfma_f32_16x16x32_bf16 v[172:175], v[60:63], v[44:47], v[172:175]
    ds_read_b64_tr_b16 v[110:111], v17 offset:26880
    v_mfma_f32_16x16x32_bf16 v[176:179], v[64:67], v[32:35], v[176:179]
    v_mfma_f32_16x16x32_bf16 v[180:183], v[64:67], v[36:39], v[180:183]
    v_mfma_f32_16x16x32_bf16 v[184:187], v[64:67], v[40:43], v[184:187]
    v_mfma_f32_16x16x32_bf16 v[188:191], v[64:67], v[44:47], v[188:191]
    v_mfma_f32_16x16x32_bf16 v[192:195], v[68:71], v[32:35], v[192:195]
    v_mfma_f32_16x16x32_bf16 v[196:199], v[68:71], v[36:39], v[196:199]
    v_mfma_f32_16x16x32_bf16 v[200:203], v[68:71], v[40:43], v[200:203]
    v_mfma_f32_16x16x32_bf16 v[204:207], v[68:71], v[44:47], v[204:207]
    s_waitcnt vmcnt(0) lgkmcnt(0)
    s_barrier
    v_mfma_f32_16x16x32_bf16 v[112:115], v[88:91], v[72:75], v[112:115]
    ds_read_b128 v[32:35], v10 offset:0
    v_mfma_f32_16x16x32_bf16 v[116:119], v[88:91], v[76:79], v[116:119]
    ds_read_b128 v[36:39], v10 offset:1024
    s_add_u32 m0, s31, 40960
    s_lshl_b32 s33, s38, 6
    buffer_load_dwordx4 v5, s[12:15], s33 offen lds
    v_mfma_f32_16x16x32_bf16 v[120:123], v[88:91], v[80:83], v[120:123]
    ds_read_b128 v[40:43], v10 offset:2048
    v_mfma_f32_16x16x32_bf16 v[124:127], v[88:91], v[84:87], v[124:127]
    ds_read_b128 v[44:47], v10 offset:3072
    s_add_u32 m0, s31, 41984
    s_add_u32 s33, s33, 20480
    buffer_load_dwordx4 v5, s[12:15], s33 offen lds
    v_mfma_f32_16x16x32_bf16 v[128:131], v[92:95], v[72:75], v[128:131]
    ds_read_b64_tr_b16 v[48:49], v11 offset:0
    v_mfma_f32_16x16x32_bf16 v[132:135], v[92:95], v[76:79], v[132:135]
    ds_read_b64_tr_b16 v[50:51], v11 offset:256
    s_add_u32 m0, s32, 40960
    s_mul_i32 s34, s38, 98304
    buffer_load_dwordx4 v6, s[16:19], s34 offen lds
    v_mfma_f32_16x16x32_bf16 v[136:139], v[92:95], v[80:83], v[136:139]
    ds_read_b64_tr_b16 v[52:53], v11 offset:6144
    v_mfma_f32_16x16x32_bf16 v[140:143], v[92:95], v[84:87], v[140:143]
    ds_read_b64_tr_b16 v[54:55], v11 offset:6400
    s_add_u32 m0, s32, 41920
    s_add_u32 s38, s38, 1
    buffer_load_dwordx4 v6, s[16:19], s34 offen offset:64 lds
    v_mfma_f32_16x16x32_bf16 v[144:147], v[96:99], v[72:75], v[144:147]
    ds_read_b64_tr_b16 v[56:57], v12 offset:0
    v_mfma_f32_16x16x32_bf16 v[148:151], v[96:99], v[76:79], v[148:151]
    ds_read_b64_tr_b16 v[58:59], v12 offset:256
    s_add_u32 m0, s32, 42880
    s_cmp_eq_u32 s38, 20
    s_cselect_b32 s38, 0, s38
    buffer_load_dwordx4 v6, s[16:19], s34 offen offset:128 lds
    v_mfma_f32_16x16x32_bf16 v[152:155], v[96:99], v[80:83], v[152:155]
    ds_read_b64_tr_b16 v[60:61], v12 offset:6144
    v_mfma_f32_16x16x32_bf16 v[156:159], v[96:99], v[84:87], v[156:159]
    ds_read_b64_tr_b16 v[62:63], v12 offset:6400
    s_add_u32 m0, s31, 61440
    s_lshl_b32 s33, s38, 6
    buffer_load_dwordx4 v5, s[12:15], s33 offen lds
    v_mfma_f32_16x16x32_bf16 v[160:163], v[100:103], v[72:75], v[160:163]
    s_waitcnt lgkmcnt(8)
    ds_read_b64_tr_b16 v[64:65], v13 offset:0
    v_mfma_f32_16x16x32_bf16 v[164:167], v[100:103], v[76:79], v[164:167]
    ds_read_b64_tr_b16 v[66:67], v13 offset:256
    s_add_u32 m0, s31, 62464
    s_add_u32 s33, s33, 20480
    buffer_load_dwordx4 v5, s[12:15], s33 offen lds
    v_mfma_f32_16x16x32_bf16 v[168:171], v[100:103], v[80:83], v[168:171]
    ds_read_b64_tr_b16 v[68:69], v13 offset:6144
    v_mfma_f32_16x16x32_bf16 v[172:175], v[100:103], v[84:87], v[172:175]
    ds_read_b64_tr_b16 v[70:71], v13 offset:6400
    s_add_u32 m0, s32, 61440
    s_mul_i32 s34, s38, 98304
    buffer_load_dwordx4 v6, s[16:19], s34 offen lds
    v_mfma_f32_16x16x32_bf16 v[176:179], v[104:107], v[72:75], v[176:179]
    v_mfma_f32_16x16x32_bf16 v[180:183], v[104:107], v[76:79], v[180:183]
    s_add_u32 m0, s32, 62400
    s_add_u32 s38, s38, 1
    buffer_load_dwordx4 v6, s[16:19], s34 offen offset:64 lds
    v_mfma_f32_16x16x32_bf16 v[184:187], v[104:107], v[80:83], v[184:187]
    v_mfma_f32_16x16x32_bf16 v[188:191], v[104:107], v[84:87], v[188:191]
    s_add_u32 m0, s32, 63360
    s_cmp_eq_u32 s38, 20
    s_cselect_b32 s38, 0, s38
    buffer_load_dwordx4 v6, s[16:19], s34 offen offset:128 lds
    v_mfma_f32_16x16x32_bf16 v[192:195], v[108:111], v[72:75], v[192:195]
    v_mfma_f32_16x16x32_bf16 v[196:199], v[108:111], v[76:79], v[196:199]
    v_mfma_f32_16x16x32_bf16 v[200:203], v[108:111], v[80:83], v[200:203]
    v_mfma_f32_16x16x32_bf16 v[204:207], v[108:111], v[84:87], v[204:207]
    s_waitcnt lgkmcnt(0)
    v_mfma_f32_16x16x32_bf16 v[112:115], v[48:51], v[32:35], v[112:115]
    ds_read_b128 v[72:75], v10 offset:20480
    v_mfma_f32_16x16x32_bf16 v[116:119], v[48:51], v[36:39], v[116:119]
    ds_read_b128 v[76:79], v10 offset:21504
    v_mfma_f32_16x16x32_bf16 v[120:123], v[48:51], v[40:43], v[120:123]
    ds_read_b128 v[80:83], v10 offset:22528
    v_mfma_f32_16x16x32_bf16 v[124:127], v[48:51], v[44:47], v[124:127]
    ds_read_b128 v[84:87], v10 offset:23552
    v_mfma_f32_16x16x32_bf16 v[128:131], v[52:55], v[32:35], v[128:131]
    ds_read_b64_tr_b16 v[88:89], v11 offset:20480
    v_mfma_f32_16x16x32_bf16 v[132:135], v[52:55], v[36:39], v[132:135]
    ds_read_b64_tr_b16 v[90:91], v11 offset:20736
    v_mfma_f32_16x16x32_bf16 v[136:139], v[52:55], v[40:43], v[136:139]
    ds_read_b64_tr_b16 v[92:93], v11 offset:26624
    v_mfma_f32_16x16x32_bf16 v[140:143], v[52:55], v[44:47], v[140:143]
    ds_read_b64_tr_b16 v[94:95], v11 offset:26880
    v_mfma_f32_16x16x32_bf16 v[144:147], v[56:59], v[32:35], v[144:147]
    ds_read_b64_tr_b16 v[96:97], v12 offset:20480
    v_mfma_f32_16x16x32_bf16 v[148:151], v[56:59], v[36:39], v[148:151]
    ds_read_b64_tr_b16 v[98:99], v12 offset:20736
    v_mfma_f32_16x16x32_bf16 v[152:155], v[56:59], v[40:43], v[152:155]
    ds_read_b64_tr_b16 v[100:101], v12 offset:26624
    v_mfma_f32_16x16x32_bf16 v[156:159], v[56:59], v[44:47], v[156:159]
    ds_read_b64_tr_b16 v[102:103], v12 offset:26880
    v_mfma_f32_16x16x32_bf16 v[160:163], v[60:63], v[32:35], v[160:163]
    s_waitcnt lgkmcnt(8)
    ds_read_b64_tr_b16 v[104:105], v13 offset:20480
    v_mfma_f32_16x16x32_bf16 v[164:167], v[60:63], v[36:39], v[164:167]
    ds_read_b64_tr_b16 v[106:107], v13 offset:20736
    v_mfma_f32_16x16x32_bf16 v[168:171], v[60:63], v[40:43], v[168:171]
    ds_read_b64_tr_b16 v[108:109], v13 offset:26624
    v_mfma_f32_16x16x32_bf16 v[172:175], v[60:63], v[44:47], v[172:175]
    ds_read_b64_tr_b16 v[110:111], v13 offset:26880
    v_mfma_f32_16x16x32_bf16 v[176:179], v[64:67], v[32:35], v[176:179]
    v_mfma_f32_16x16x32_bf16 v[180:183], v[64:67], v[36:39], v[180:183]
    v_mfma_f32_16x16x32_bf16 v[184:187], v[64:67], v[40:43], v[184:187]
    v_mfma_f32_16x16x32_bf16 v[188:191], v[64:67], v[44:47], v[188:191]
    v_mfma_f32_16x16x32_bf16 v[192:195], v[68:71], v[32:35], v[192:195]
    v_mfma_f32_16x16x32_bf16 v[196:199], v[68:71], v[36:39], v[196:199]
    v_mfma_f32_16x16x32_bf16 v[200:203], v[68:71], v[40:43], v[200:203]
    v_mfma_f32_16x16x32_bf16 v[204:207], v[68:71], v[44:47], v[204:207]
    s_waitcnt vmcnt(0) lgkmcnt(0)
    s_barrier
    v_mfma_f32_16x16x32_bf16 v[112:115], v[88:91], v[72:75], v[112:115]
    ds_read_b128 v[32:35], v14 offset:0
    v_mfma_f32_16x16x32_bf16 v[116:119], v[88:91], v[76:79], v[116:119]
    ds_read_b128 v[36:39], v14 offset:1024
    s_add_u32 m0, s31, 0
    s_lshl_b32 s33, s38, 6
    buffer_load_dwordx4 v5, s[12:15], s33 offen lds
    v_mfma_f32_16x16x32_bf16 v[120:123], v[88:91], v[80:83], v[120:123]
    ds_read_b128 v[40:43], v14 offset:2048
    v_mfma_f32_16x16x32_bf16 v[124:127], v[88:91], v[84:87], v[124:127]
    ds_read_b128 v[44:47], v14 offset:3072
    s_add_u32 m0, s31, 1024
    s_add_u32 s33, s33, 20480
    buffer_load_dwordx4 v5, s[12:15], s33 offen lds
    v_mfma_f32_16x16x32_bf16 v[128:131], v[92:95], v[72:75], v[128:131]
    ds_read_b64_tr_b16 v[48:49], v15 offset:0
    v_mfma_f32_16x16x32_bf16 v[132:135], v[92:95], v[76:79], v[132:135]
    ds_read_b64_tr_b16 v[50:51], v15 offset:256
    s_add_u32 m0, s32, 0
    s_mul_i32 s34, s38, 98304
    buffer_load_dwordx4 v6, s[16:19], s34 offen lds
    v_mfma_f32_16x16x32_bf16 v[136:139], v[92:95], v[80:83], v[136:139]
    ds_read_b64_tr_b16 v[52:53], v15 offset:6144
    v_mfma_f32_16x16x32_bf16 v[140:143], v[92:95], v[84:87], v[140:143]
    ds_read_b64_tr_b16 v[54:55], v15 offset:6400
    s_add_u32 m0, s32, 960
    s_add_u32 s38, s38, 1
    buffer_load_dwordx4 v6, s[16:19], s34 offen offset:64 lds
    v_mfma_f32_16x16x32_bf16 v[144:147], v[96:99], v[72:75], v[144:147]
    ds_read_b64_tr_b16 v[56:57], v16 offset:0
    v_mfma_f32_16x16x32_bf16 v[148:151], v[96:99], v[76:79], v[148:151]
    ds_read_b64_tr_b16 v[58:59], v16 offset:256
    s_add_u32 m0, s32, 1920
    s_cmp_eq_u32 s38, 20
    s_cselect_b32 s38, 0, s38
    buffer_load_dwordx4 v6, s[16:19], s34 offen offset:128 lds
    v_mfma_f32_16x16x32_bf16 v[152:155], v[96:99], v[80:83], v[152:155]
    ds_read_b64_tr_b16 v[60:61], v16 offset:6144
    v_mfma_f32_16x16x32_bf16 v[156:159], v[96:99], v[84:87], v[156:159]
    ds_read_b64_tr_b16 v[62:63], v16 offset:6400
    s_add_u32 m0, s31, 20480
    s_lshl_b32 s33, s38, 6
    buffer_load_dwordx4 v5, s[12:15], s33 offen lds
    v_mfma_f32_16x16x32_bf16 v[160:163], v[100:103], v[72:75], v[160:163]
    s_waitcnt lgkmcnt(8)
    ds_read_b64_tr_b16 v[64:65], v17 offset:0
    v_mfma_f32_16x16x32_bf16 v[164:167], v[100:103], v[76:79], v[164:167]
    ds_read_b64_tr_b16 v[66:67], v17 offset:256
    s_add_u32 m0, s31, 21504
    s_add_u32 s33, s33, 20480
    buffer_load_dwordx4 v5, s[12:15], s33 offen lds
    v_mfma_f32_16x16x32_bf16 v[168:171], v[100:103], v[80:83], v[168:171]
    ds_read_b64_tr_b16 v[68:69], v17 offset:6144
    v_mfma_f32_16x16x32_bf16 v[172:175], v[100:103], v[84:87], v[172:175]
    ds_read_b64_tr_b16 v[70:71], v17 offset:6400
    s_add_u32 m0, s32, 20480
    s_mul_i32 s34, s38, 98304
    buffer_load_dwordx4 v6, s[16:19], s34 offen lds
    v_mfma_f32_16x16x32_bf16 v[176:179], v[104:107], v[72:75], v[176:179]
    v_mfma_f32_16x16x32_bf16 v[180:183], v[104:107], v[76:79], v[180:183]
    s_add_u32 m0, s32, 21440
    s_add_u32 s38, s38, 1
    buffer_load_dwordx4 v6, s[16:19], s34 offen offset:64 lds
    v_mfma_f32_16x16x32_bf16 v[184:187], v[104:107], v[80:83], v[184:187]
    v_mfma_f32_16x16x32_bf16 v[188:191], v[104:107], v[84:87], v[188:191]
    s_add_u32 m0, s32, 22400
    s_cmp_eq_u32 s38, 20
    s_cselect_b32 s38, 0, s38
    buffer_load_dwordx4 v6, s[16:19], s34 offen offset:128 lds
    v_mfma_f32_16x16x32_bf16 v[192:195], v[108:111], v[72:75], v[192:195]
    v_mfma_f32_16x16x32_bf16 v[196:199], v[108:111], v[76:79], v[196:199]
    v_mfma_f32_16x16x32_bf16 v[200:203], v[108:111], v[80:83], v[200:203]
    v_mfma_f32_16x16x32_bf16 v[204:207], v[108:111], v[84:87], v[204:207]
    s_waitcnt lgkmcnt(0)
    v_mfma_f32_16x16x32_bf16 v[112:115], v[48:51], v[32:35], v[112:115]
    ds_read_b128 v[72:75], v14 offset:20480
    v_mfma_f32_16x16x32_bf16 v[116:119], v[48:51], v[36:39], v[116:119]
    ds_read_b128 v[76:79], v14 offset:21504
    v_mfma_f32_16x16x32_bf16 v[120:123], v[48:51], v[40:43], v[120:123]
    ds_read_b128 v[80:83], v14 offset:22528
    v_mfma_f32_16x16x32_bf16 v[124:127], v[48:51], v[44:47], v[124:127]
    ds_read_b128 v[84:87], v14 offset:23552
    v_mfma_f32_16x16x32_bf16 v[128:131], v[52:55], v[32:35], v[128:131]
    ds_read_b64_tr_b16 v[88:89], v15 offset:20480
    v_mfma_f32_16x16x32_bf16 v[132:135], v[52:55], v[36:39], v[132:135]
    ds_read_b64_tr_b16 v[90:91], v15 offset:20736
    v_mfma_f32_16x16x32_bf16 v[136:139], v[52:55], v[40:43], v[136:139]
    ds_read_b64_tr_b16 v[92:93], v15 offset:26624
    v_mfma_f32_16x16x32_bf16 v[140:143], v[52:55], v[44:47], v[140:143]
    ds_read_b64_tr_b16 v[94:95], v15 offset:26880
    v_mfma_f32_16x16x32_bf16 v[144:147], v[56:59], v[32:35], v[144:147]
    ds_read_b64_tr_b16 v[96:97], v16 offset:20480
    v_mfma_f32_16x16x32_bf16 v[148:151], v[56:59], v[36:39], v[148:151]
    ds_read_b64_tr_b16 v[98:99], v16 offset:20736
    v_mfma_f32_16x16x32_bf16 v[152:155], v[56:59], v[40:43], v[152:155]
    ds_read_b64_tr_b16 v[100:101], v16 offset:26624
    v_mfma_f32_16x16x32_bf16 v[156:159], v[56:59], v[44:47], v[156:159]
    ds_read_b64_tr_b16 v[102:103], v16 offset:26880
    v_mfma_f32_16x16x32_bf16 v[160:163], v[60:63], v[32:35], v[160:163]
    s_waitcnt lgkmcnt(8)
    ds_read_b64_tr_b16 v[104:105], v17 offset:20480
    v_mfma_f32_16x16x32_bf16 v[164:167], v[60:63], v[36:39], v[164:167]
    ds_read_b64_tr_b16 v[106:107], v17 offset:20736
    v_mfma_f32_16x16x32_bf16 v[168:171], v[60:63], v[40:43], v[168:171]
    ds_read_b64_tr_b16 v[108:109], v17 offset:26624
    v_mfma_f32_16x16x32_bf16 v[172:175], v[60:63], v[44:47], v[172:175]
    ds_read_b64_tr_b16 v[110:111], v17 offset:26880
    v_mfma_f32_16x16x32_bf16 v[176:179], v[64:67], v[32:35], v[176:179]
    v_mfma_f32_16x16x32_bf16 v[180:183], v[64:67], v[36:39], v[180:183]
    v_mfma_f32_16x16x32_bf16 v[184:187], v[64:67], v[40:43], v[184:187]
    v_mfma_f32_16x16x32_bf16 v[188:191], v[64:67], v[44:47], v[188:191]
    v_mfma_f32_16x16x32_bf16 v[192:195], v[68:71], v[32:35], v[192:195]
    v_mfma_f32_16x16x32_bf16 v[196:199], v[68:71], v[36:39], v[196:199]
    v_mfma_f32_16x16x32_bf16 v[200:203], v[68:71], v[40:43], v[200:203]
    v_mfma_f32_16x16x32_bf16 v[204:207], v[68:71], v[44:47], v[204:207]
    s_waitcnt vmcnt(0) lgkmcnt(0)
    s_barrier
    v_mfma_f32_16x16x32_bf16 v[112:115], v[88:91], v[72:75], v[112:115]
    ds_read_b128 v[32:35], v10 offset:0
    v_mfma_f32_16x16x32_bf16 v[116:119], v[88:91], v[76:79], v[116:119]
    ds_read_b128 v[36:39], v10 offset:1024
    s_add_u32 m0, s31, 40960
    s_lshl_b32 s33, s38, 6
    buffer_load_dwordx4 v5, s[12:15], s33 offen lds
    v_mfma_f32_16x16x32_bf16 v[120:123], v[88:91], v[80:83], v[120:123]
    ds_read_b128 v[40:43], v10 offset:2048
    v_mfma_f32_16x16x32_bf16 v[124:127], v[88:91], v[84:87], v[124:127]
    ds_read_b128 v[44:47], v10 offset:3072
    s_add_u32 m0, s31, 41984
    s_add_u32 s33, s33, 20480
    buffer_load_dwordx4 v5, s[12:15], s33 offen lds
    v_mfma_f32_16x16x32_bf16 v[128:131], v[92:95], v[72:75], v[128:131]
    ds_read_b64_tr_b16 v[48:49], v11 offset:0
    v_mfma_f32_16x16x32_bf16 v[132:135], v[92:95], v[76:79], v[132:135]
    ds_read_b64_tr_b16 v[50:51], v11 offset:256
    s_add_u32 m0, s32, 40960
    s_mul_i32 s34, s38, 98304
    buffer_load_dwordx4 v6, s[16:19], s34 offen lds
    v_mfma_f32_16x16x32_bf16 v[136:139], v[92:95], v[80:83], v[136:139]
    ds_read_b64_tr_b16 v[52:53], v11 offset:6144
    v_mfma_f32_16x16x32_bf16 v[140:143], v[92:95], v[84:87], v[140:143]
    ds_read_b64_tr_b16 v[54:55], v11 offset:6400
    s_add_u32 m0, s32, 41920
    s_add_u32 s38, s38, 1
    buffer_load_dwordx4 v6, s[16:19], s34 offen offset:64 lds
    v_mfma_f32_16x16x32_bf16 v[144:147], v[96:99], v[72:75], v[144:147]
    ds_read_b64_tr_b16 v[56:57], v12 offset:0
    v_mfma_f32_16x16x32_bf16 v[148:151], v[96:99], v[76:79], v[148:151]
    ds_read_b64_tr_b16 v[58:59], v12 offset:256
    s_add_u32 m0, s32, 42880
    s_cmp_eq_u32 s38, 20
    s_cselect_b32 s38, 0, s38
    buffer_load_dwordx4 v6, s[16:19], s34 offen offset:128 lds
    v_mfma_f32_16x16x32_bf16 v[152:155], v[96:99], v[80:83], v[152:155]
    ds_read_b64_tr_b16 v[60:61], v12 offset:6144
    v_mfma_f32_16x16x32_bf16 v[156:159], v[96:99], v[84:87], v[156:159]
    ds_read_b64_tr_b16 v[62:63], v12 offset:6400
    s_add_u32 m0, s31, 61440
    s_lshl_b32 s33, s38, 6
    buffer_load_dwordx4 v5, s[12:15], s33 offen lds
    v_mfma_f32_16x16x32_bf16 v[160:163], v[100:103], v[72:75], v[160:163]
    s_waitcnt lgkmcnt(8)
    ds_read_b64_tr_b16 v[64:65], v13 offset:0
    v_mfma_f32_16x16x32_bf16 v[164:167], v[100:103], v[76:79], v[164:167]
    ds_read_b64_tr_b16 v[66:67], v13 offset:256
    s_add_u32 m0, s31, 62464
    s_add_u32 s33, s33, 20480
    buffer_load_dwordx4 v5, s[12:15], s33 offen lds
    v_mfma_f32_16x16x32_bf16 v[168:171], v[100:103], v[80:83], v[168:171]
    ds_read_b64_tr_b16 v[68:69], v13 offset:6144
    v_mfma_f32_16x16x32_bf16 v[172:175], v[100:103], v[84:87], v[172:175]
    ds_read_b64_tr_b16 v[70:71], v13 offset:6400
    s_add_u32 m0, s32, 61440
    s_mul_i32 s34, s38, 98304
    buffer_load_dwordx4 v6, s[16:19], s34 offen lds
    v_mfma_f32_16x16x32_bf16 v[176:179], v[104:107], v[72:75], v[176:179]
    v_mfma_f32_16x16x32_bf16 v[180:183], v[104:107], v[76:79], v[180:183]
    s_add_u32 m0, s32, 62400
    s_add_u32 s38, s38, 1
    buffer_load_dwordx4 v6, s[16:19], s34 offen offset:64 lds
    v_mfma_f32_16x16x32_bf16 v[184:187], v[104:107], v[80:83], v[184:187]
    v_mfma_f32_16x16x32_bf16 v[188:191], v[104:107], v[84:87], v[188:191]
    s_add_u32 m0, s32, 63360
    s_cmp_eq_u32 s38, 20
    s_cselect_b32 s38, 0, s38
    buffer_load_dwordx4 v6, s[16:19], s34 offen offset:128 lds
    v_mfma_f32_16x16x32_bf16 v[192:195], v[108:111], v[72:75], v[192:195]
    v_mfma_f32_16x16x32_bf16 v[196:199], v[108:111], v[76:79], v[196:199]
    v_mfma_f32_16x16x32_bf16 v[200:203], v[108:111], v[80:83], v[200:203]
    v_mfma_f32_16x16x32_bf16 v[204:207], v[108:111], v[84:87], v[204:207]
    s_waitcnt lgkmcnt(0)
    v_mfma_f32_16x16x32_bf16 v[112:115], v[48:51], v[32:35], v[112:115]
    ds_read_b128 v[72:75], v10 offset:20480
    v_mfma_f32_16x16x32_bf16 v[116:119], v[48:51], v[36:39], v[116:119]
    ds_read_b128 v[76:79], v10 offset:21504
    v_mfma_f32_16x16x32_bf16 v[120:123], v[48:51], v[40:43], v[120:123]
    ds_read_b128 v[80:83], v10 offset:22528
    v_mfma_f32_16x16x32_bf16 v[124:127], v[48:51], v[44:47], v[124:127]
    ds_read_b128 v[84:87], v10 offset:23552
    v_mfma_f32_16x16x32_bf16 v[128:131], v[52:55], v[32:35], v[128:131]
    ds_read_b64_tr_b16 v[88:89], v11 offset:20480
    v_mfma_f32_16x16x32_bf16 v[132:135], v[52:55], v[36:39], v[132:135]
    ds_read_b64_tr_b16 v[90:91], v11 offset:20736
    v_mfma_f32_16x16x32_bf16 v[136:139], v[52:55], v[40:43], v[136:139]
    ds_read_b64_tr_b16 v[92:93], v11 offset:26624
    v_mfma_f32_16x16x32_bf16 v[140:143], v[52:55], v[44:47], v[140:143]
    ds_read_b64_tr_b16 v[94:95], v11 offset:26880
    v_mfma_f32_16x16x32_bf16 v[144:147], v[56:59], v[32:35], v[144:147]
    ds_read_b64_tr_b16 v[96:97], v12 offset:20480
    v_mfma_f32_16x16x32_bf16 v[148:151], v[56:59], v[36:39], v[148:151]
    ds_read_b64_tr_b16 v[98:99], v12 offset:20736
    v_mfma_f32_16x16x32_bf16 v[152:155], v[56:59], v[40:43], v[152:155]
    ds_read_b64_tr_b16 v[100:101], v12 offset:26624
    v_mfma_f32_16x16x32_bf16 v[156:159], v[56:59], v[44:47], v[156:159]
    ds_read_b64_tr_b16 v[102:103], v12 offset:26880
    v_mfma_f32_16x16x32_bf16 v[160:163], v[60:63], v[32:35], v[160:163]
    s_waitcnt lgkmcnt(8)
    ds_read_b64_tr_b16 v[104:105], v13 offset:20480
    v_mfma_f32_16x16x32_bf16 v[164:167], v[60:63], v[36:39], v[164:167]
    ds_read_b64_tr_b16 v[106:107], v13 offset:20736
    v_mfma_f32_16x16x32_bf16 v[168:171], v[60:63], v[40:43], v[168:171]
    ds_read_b64_tr_b16 v[108:109], v13 offset:26624
    v_mfma_f32_16x16x32_bf16 v[172:175], v[60:63], v[44:47], v[172:175]
    ds_read_b64_tr_b16 v[110:111], v13 offset:26880
    v_mfma_f32_16x16x32_bf16 v[176:179], v[64:67], v[32:35], v[176:179]
    v_mfma_f32_16x16x32_bf16 v[180:183], v[64:67], v[36:39], v[180:183]
    v_mfma_f32_16x16x32_bf16 v[184:187], v[64:67], v[40:43], v[184:187]
    v_mfma_f32_16x16x32_bf16 v[188:191], v[64:67], v[44:47], v[188:191]
    v_mfma_f32_16x16x32_bf16 v[192:195], v[68:71], v[32:35], v[192:195]
    v_mfma_f32_16x16x32_bf16 v[196:199], v[68:71], v[36:39], v[196:199]
    v_mfma_f32_16x16x32_bf16 v[200:203], v[68:71], v[40:43], v[200:203]
    v_mfma_f32_16x16x32_bf16 v[204:207], v[68:71], v[44:47], v[204:207]
    s_waitcnt vmcnt(0) lgkmcnt(0)
    s_barrier
    v_mfma_f32_16x16x32_bf16 v[112:115], v[88:91], v[72:75], v[112:115]
    ds_read_b128 v[32:35], v14 offset:0
    v_mfma_f32_16x16x32_bf16 v[116:119], v[88:91], v[76:79], v[116:119]
    ds_read_b128 v[36:39], v14 offset:1024
    s_add_u32 m0, s31, 0
    s_lshl_b32 s33, s38, 6
    buffer_load_dwordx4 v5, s[12:15], s33 offen lds
    v_mfma_f32_16x16x32_bf16 v[120:123], v[88:91], v[80:83], v[120:123]
    ds_read_b128 v[40:43], v14 offset:2048
    v_mfma_f32_16x16x32_bf16 v[124:127], v[88:91], v[84:87], v[124:127]
    ds_read_b128 v[44:47], v14 offset:3072
    s_add_u32 m0, s31, 1024
    s_add_u32 s33, s33, 20480
    buffer_load_dwordx4 v5, s[12:15], s33 offen lds
    v_mfma_f32_16x16x32_bf16 v[128:131], v[92:95], v[72:75], v[128:131]
    ds_read_b64_tr_b16 v[48:49], v15 offset:0
    v_mfma_f32_16x16x32_bf16 v[132:135], v[92:95], v[76:79], v[132:135]
    ds_read_b64_tr_b16 v[50:51], v15 offset:256
    s_add_u32 m0, s32, 0
    s_mul_i32 s34, s38, 98304
    buffer_load_dwordx4 v6, s[16:19], s34 offen lds
    v_mfma_f32_16x16x32_bf16 v[136:139], v[92:95], v[80:83], v[136:139]
    ds_read_b64_tr_b16 v[52:53], v15 offset:6144
    v_mfma_f32_16x16x32_bf16 v[140:143], v[92:95], v[84:87], v[140:143]
    ds_read_b64_tr_b16 v[54:55], v15 offset:6400
    s_add_u32 m0, s32, 960
    s_add_u32 s38, s38, 1
    buffer_load_dwordx4 v6, s[16:19], s34 offen offset:64 lds
    v_mfma_f32_16x16x32_bf16 v[144:147], v[96:99], v[72:75], v[144:147]
    ds_read_b64_tr_b16 v[56:57], v16 offset:0
    v_mfma_f32_16x16x32_bf16 v[148:151], v[96:99], v[76:79], v[148:151]
    ds_read_b64_tr_b16 v[58:59], v16 offset:256
    s_add_u32 m0, s32, 1920
    s_cmp_eq_u32 s38, 20
    s_cselect_b32 s38, 0, s38
    buffer_load_dwordx4 v6, s[16:19], s34 offen offset:128 lds
    v_mfma_f32_16x16x32_bf16 v[152:155], v[96:99], v[80:83], v[152:155]
    ds_read_b64_tr_b16 v[60:61], v16 offset:6144
    v_mfma_f32_16x16x32_bf16 v[156:159], v[96:99], v[84:87], v[156:159]
    ds_read_b64_tr_b16 v[62:63], v16 offset:6400
    s_add_u32 m0, s31, 20480
    s_lshl_b32 s33, s38, 6
    buffer_load_dwordx4 v5, s[12:15], s33 offen lds
    v_mfma_f32_16x16x32_bf16 v[160:163], v[100:103], v[72:75], v[160:163]
    s_waitcnt lgkmcnt(8)
    ds_read_b64_tr_b16 v[64:65], v17 offset:0
    v_mfma_f32_16x16x32_bf16 v[164:167], v[100:103], v[76:79], v[164:167]
    ds_read_b64_tr_b16 v[66:67], v17 offset:256
    s_add_u32 m0, s31, 21504
    s_add_u32 s33, s33, 20480
    buffer_load_dwordx4 v5, s[12:15], s33 offen lds
    v_mfma_f32_16x16x32_bf16 v[168:171], v[100:103], v[80:83], v[168:171]
    ds_read_b64_tr_b16 v[68:69], v17 offset:6144
    v_mfma_f32_16x16x32_bf16 v[172:175], v[100:103], v[84:87], v[172:175]
    ds_read_b64_tr_b16 v[70:71], v17 offset:6400
    s_add_u32 m0, s32, 20480
    s_mul_i32 s34, s38, 98304
    buffer_load_dwordx4 v6, s[16:19], s34 offen lds
    v_mfma_f32_16x16x32_bf16 v[176:179], v[104:107], v[72:75], v[176:179]
    v_mfma_f32_16x16x32_bf16 v[180:183], v[104:107], v[76:79], v[180:183]
    s_add_u32 m0, s32, 21440
    s_add_u32 s38, s38, 1
    buffer_load_dwordx4 v6, s[16:19], s34 offen offset:64 lds
    v_mfma_f32_16x16x32_bf16 v[184:187], v[104:107], v[80:83], v[184:187]
    v_mfma_f32_16x16x32_bf16 v[188:191], v[104:107], v[84:87], v[188:191]
    s_add_u32 m0, s32, 22400
    s_cmp_eq_u32 s38, 20
    s_cselect_b32 s38, 0, s38
    buffer_load_dwordx4 v6, s[16:19], s34 offen offset:128 lds
    v_mfma_f32_16x16x32_bf16 v[192:195], v[108:111], v[72:75], v[192:195]
    v_mfma_f32_16x16x32_bf16 v[196:199], v[108:111], v[76:79], v[196:199]
    v_mfma_f32_16x16x32_bf16 v[200:203], v[108:111], v[80:83], v[200:203]
    v_mfma_f32_16x16x32_bf16 v[204:207], v[108:111], v[84:87], v[204:207]
    s_waitcnt lgkmcnt(0)
    v_mfma_f32_16x16x32_bf16 v[112:115], v[48:51], v[32:35], v[112:115]
    ds_read_b128 v[72:75], v14 offset:20480
    v_mfma_f32_16x16x32_bf16 v[116:119], v[48:51], v[36:39], v[116:119]
    ds_read_b128 v[76:79], v14 offset:21504
    v_mfma_f32_16x16x32_bf16 v[120:123], v[48:51], v[40:43], v[120:123]
    ds_read_b128 v[80:83], v14 offset:22528
    v_mfma_f32_16x16x32_bf16 v[124:127], v[48:51], v[44:47], v[124:127]
    ds_read_b128 v[84:87], v14 offset:23552
    v_mfma_f32_16x16x32_bf16 v[128:131], v[52:55], v[32:35], v[128:131]
    ds_read_b64_tr_b16 v[88:89], v15 offset:20480
    v_mfma_f32_16x16x32_bf16 v[132:135], v[52:55], v[36:39], v[132:135]
    ds_read_b64_tr_b16 v[90:91], v15 offset:20736
    v_mfma_f32_16x16x32_bf16 v[136:139], v[52:55], v[40:43], v[136:139]
    ds_read_b64_tr_b16 v[92:93], v15 offset:26624
    v_mfma_f32_16x16x32_bf16 v[140:143], v[52:55], v[44:47], v[140:143]
    ds_read_b64_tr_b16 v[94:95], v15 offset:26880
    v_mfma_f32_16x16x32_bf16 v[144:147], v[56:59], v[32:35], v[144:147]
    ds_read_b64_tr_b16 v[96:97], v16 offset:20480
    v_mfma_f32_16x16x32_bf16 v[148:151], v[56:59], v[36:39], v[148:151]
    ds_read_b64_tr_b16 v[98:99], v16 offset:20736
    v_mfma_f32_16x16x32_bf16 v[152:155], v[56:59], v[40:43], v[152:155]
    ds_read_b64_tr_b16 v[100:101], v16 offset:26624
    v_mfma_f32_16x16x32_bf16 v[156:159], v[56:59], v[44:47], v[156:159]
    ds_read_b64_tr_b16 v[102:103], v16 offset:26880
    v_mfma_f32_16x16x32_bf16 v[160:163], v[60:63], v[32:35], v[160:163]
    s_waitcnt lgkmcnt(8)
    ds_read_b64_tr_b16 v[104:105], v17 offset:20480
    v_mfma_f32_16x16x32_bf16 v[164:167], v[60:63], v[36:39], v[164:167]
    ds_read_b64_tr_b16 v[106:107], v17 offset:20736
    v_mfma_f32_16x16x32_bf16 v[168:171], v[60:63], v[40:43], v[168:171]
    ds_read_b64_tr_b16 v[108:109], v17 offset:26624
    v_mfma_f32_16x16x32_bf16 v[172:175], v[60:63], v[44:47], v[172:175]
    ds_read_b64_tr_b16 v[110:111], v17 offset:26880
    v_mfma_f32_16x16x32_bf16 v[176:179], v[64:67], v[32:35], v[176:179]
    v_mfma_f32_16x16x32_bf16 v[180:183], v[64:67], v[36:39], v[180:183]
    v_mfma_f32_16x16x32_bf16 v[184:187], v[64:67], v[40:43], v[184:187]
    v_mfma_f32_16x16x32_bf16 v[188:191], v[64:67], v[44:47], v[188:191]
    v_mfma_f32_16x16x32_bf16 v[192:195], v[68:71], v[32:35], v[192:195]
    v_mfma_f32_16x16x32_bf16 v[196:199], v[68:71], v[36:39], v[196:199]
    v_mfma_f32_16x16x32_bf16 v[200:203], v[68:71], v[40:43], v[200:203]
    v_mfma_f32_16x16x32_bf16 v[204:207], v[68:71], v[44:47], v[204:207]
    s_waitcnt vmcnt(0) lgkmcnt(0)
    s_barrier
    v_mfma_f32_16x16x32_bf16 v[112:115], v[88:91], v[72:75], v[112:115]
    ds_read_b128 v[32:35], v10 offset:0
    v_mfma_f32_16x16x32_bf16 v[116:119], v[88:91], v[76:79], v[116:119]
    ds_read_b128 v[36:39], v10 offset:1024
    s_add_u32 m0, s31, 40960
    s_lshl_b32 s33, s38, 6
    buffer_load_dwordx4 v5, s[12:15], s33 offen lds
    v_mfma_f32_16x16x32_bf16 v[120:123], v[88:91], v[80:83], v[120:123]
    ds_read_b128 v[40:43], v10 offset:2048
    v_mfma_f32_16x16x32_bf16 v[124:127], v[88:91], v[84:87], v[124:127]
    ds_read_b128 v[44:47], v10 offset:3072
    s_add_u32 m0, s31, 41984
    s_add_u32 s33, s33, 20480
    buffer_load_dwordx4 v5, s[12:15], s33 offen lds
    v_mfma_f32_16x16x32_bf16 v[128:131], v[92:95], v[72:75], v[128:131]
    ds_read_b64_tr_b16 v[48:49], v11 offset:0
    v_mfma_f32_16x16x32_bf16 v[132:135], v[92:95], v[76:79], v[132:135]
    ds_read_b64_tr_b16 v[50:51], v11 offset:256
    s_add_u32 m0, s32, 40960
    s_mul_i32 s34, s38, 98304
    buffer_load_dwordx4 v6, s[16:19], s34 offen lds
    v_mfma_f32_16x16x32_bf16 v[136:139], v[92:95], v[80:83], v[136:139]
    ds_read_b64_tr_b16 v[52:53], v11 offset:6144
    v_mfma_f32_16x16x32_bf16 v[140:143], v[92:95], v[84:87], v[140:143]
    ds_read_b64_tr_b16 v[54:55], v11 offset:6400
    s_add_u32 m0, s32, 41920
    s_add_u32 s38, s38, 1
    buffer_load_dwordx4 v6, s[16:19], s34 offen offset:64 lds
    v_mfma_f32_16x16x32_bf16 v[144:147], v[96:99], v[72:75], v[144:147]
    ds_read_b64_tr_b16 v[56:57], v12 offset:0
    v_mfma_f32_16x16x32_bf16 v[148:151], v[96:99], v[76:79], v[148:151]
    ds_read_b64_tr_b16 v[58:59], v12 offset:256
    s_add_u32 m0, s32, 42880
    s_cmp_eq_u32 s38, 20
    s_cselect_b32 s38, 0, s38
    buffer_load_dwordx4 v6, s[16:19], s34 offen offset:128 lds
    v_mfma_f32_16x16x32_bf16 v[152:155], v[96:99], v[80:83], v[152:155]
    ds_read_b64_tr_b16 v[60:61], v12 offset:6144
    v_mfma_f32_16x16x32_bf16 v[156:159], v[96:99], v[84:87], v[156:159]
    ds_read_b64_tr_b16 v[62:63], v12 offset:6400
    s_add_u32 m0, s31, 61440
    s_lshl_b32 s33, s38, 6
    buffer_load_dwordx4 v5, s[12:15], s33 offen lds
    v_mfma_f32_16x16x32_bf16 v[160:163], v[100:103], v[72:75], v[160:163]
    s_waitcnt lgkmcnt(8)
    ds_read_b64_tr_b16 v[64:65], v13 offset:0
    v_mfma_f32_16x16x32_bf16 v[164:167], v[100:103], v[76:79], v[164:167]
    ds_read_b64_tr_b16 v[66:67], v13 offset:256
    s_add_u32 m0, s31, 62464
    s_add_u32 s33, s33, 20480
    buffer_load_dwordx4 v5, s[12:15], s33 offen lds
    v_mfma_f32_16x16x32_bf16 v[168:171], v[100:103], v[80:83], v[168:171]
    ds_read_b64_tr_b16 v[68:69], v13 offset:6144
    v_mfma_f32_16x16x32_bf16 v[172:175], v[100:103], v[84:87], v[172:175]
    ds_read_b64_tr_b16 v[70:71], v13 offset:6400
    s_add_u32 m0, s32, 61440
    s_mul_i32 s34, s38, 98304
    buffer_load_dwordx4 v6, s[16:19], s34 offen lds
    v_mfma_f32_16x16x32_bf16 v[176:179], v[104:107], v[72:75], v[176:179]
    v_mfma_f32_16x16x32_bf16 v[180:183], v[104:107], v[76:79], v[180:183]
    s_add_u32 m0, s32, 62400
    s_add_u32 s38, s38, 1
    buffer_load_dwordx4 v6, s[16:19], s34 offen offset:64 lds
    v_mfma_f32_16x16x32_bf16 v[184:187], v[104:107], v[80:83], v[184:187]
    v_mfma_f32_16x16x32_bf16 v[188:191], v[104:107], v[84:87], v[188:191]
    s_add_u32 m0, s32, 63360
    s_cmp_eq_u32 s38, 20
    s_cselect_b32 s38, 0, s38
    buffer_load_dwordx4 v6, s[16:19], s34 offen offset:128 lds
    v_mfma_f32_16x16x32_bf16 v[192:195], v[108:111], v[72:75], v[192:195]
    v_mfma_f32_16x16x32_bf16 v[196:199], v[108:111], v[76:79], v[196:199]
    buffer_load_dword v22, off, s[60:63], s57 sc1
    v_mfma_f32_16x16x32_bf16 v[200:203], v[108:111], v[80:83], v[200:203]
    v_mfma_f32_16x16x32_bf16 v[204:207], v[108:111], v[84:87], v[204:207]
    s_waitcnt lgkmcnt(0)
    v_mfma_f32_16x16x32_bf16 v[112:115], v[48:51], v[32:35], v[112:115]
    ds_read_b128 v[72:75], v10 offset:20480
    v_mfma_f32_16x16x32_bf16 v[116:119], v[48:51], v[36:39], v[116:119]
    ds_read_b128 v[76:79], v10 offset:21504
    v_mfma_f32_16x16x32_bf16 v[120:123], v[48:51], v[40:43], v[120:123]
    ds_read_b128 v[80:83], v10 offset:22528
    v_mfma_f32_16x16x32_bf16 v[124:127], v[48:51], v[44:47], v[124:127]
    ds_read_b128 v[84:87], v10 offset:23552
    v_mfma_f32_16x16x32_bf16 v[128:131], v[52:55], v[32:35], v[128:131]
    ds_read_b64_tr_b16 v[88:89], v11 offset:20480
    v_mfma_f32_16x16x32_bf16 v[132:135], v[52:55], v[36:39], v[132:135]
    ds_read_b64_tr_b16 v[90:91], v11 offset:20736
    v_mfma_f32_16x16x32_bf16 v[136:139], v[52:55], v[40:43], v[136:139]
    ds_read_b64_tr_b16 v[92:93], v11 offset:26624
    v_mfma_f32_16x16x32_bf16 v[140:143], v[52:55], v[44:47], v[140:143]
    ds_read_b64_tr_b16 v[94:95], v11 offset:26880
    v_mfma_f32_16x16x32_bf16 v[144:147], v[56:59], v[32:35], v[144:147]
    ds_read_b64_tr_b16 v[96:97], v12 offset:20480
    v_mfma_f32_16x16x32_bf16 v[148:151], v[56:59], v[36:39], v[148:151]
    ds_read_b64_tr_b16 v[98:99], v12 offset:20736
    v_mfma_f32_16x16x32_bf16 v[152:155], v[56:59], v[40:43], v[152:155]
    ds_read_b64_tr_b16 v[100:101], v12 offset:26624
    v_mfma_f32_16x16x32_bf16 v[156:159], v[56:59], v[44:47], v[156:159]
    ds_read_b64_tr_b16 v[102:103], v12 offset:26880
    v_mfma_f32_16x16x32_bf16 v[160:163], v[60:63], v[32:35], v[160:163]
    s_waitcnt lgkmcnt(8)
    ds_read_b64_tr_b16 v[104:105], v13 offset:20480
    v_mfma_f32_16x16x32_bf16 v[164:167], v[60:63], v[36:39], v[164:167]
    ds_read_b64_tr_b16 v[106:107], v13 offset:20736
    v_mfma_f32_16x16x32_bf16 v[168:171], v[60:63], v[40:43], v[168:171]
    ds_read_b64_tr_b16 v[108:109], v13 offset:26624
    v_mfma_f32_16x16x32_bf16 v[172:175], v[60:63], v[44:47], v[172:175]
    ds_read_b64_tr_b16 v[110:111], v13 offset:26880
    v_mfma_f32_16x16x32_bf16 v[176:179], v[64:67], v[32:35], v[176:179]
    v_mfma_f32_16x16x32_bf16 v[180:183], v[64:67], v[36:39], v[180:183]
    v_mfma_f32_16x16x32_bf16 v[184:187], v[64:67], v[40:43], v[184:187]
    v_mfma_f32_16x16x32_bf16 v[188:191], v[64:67], v[44:47], v[188:191]
    v_mfma_f32_16x16x32_bf16 v[192:195], v[68:71], v[32:35], v[192:195]
    v_mfma_f32_16x16x32_bf16 v[196:199], v[68:71], v[36:39], v[196:199]
    v_mfma_f32_16x16x32_bf16 v[200:203], v[68:71], v[40:43], v[200:203]
    v_mfma_f32_16x16x32_bf16 v[204:207], v[68:71], v[44:47], v[204:207]
    s_waitcnt vmcnt(0) lgkmcnt(0)
    v_readfirstlane_b32 s58, v22
    s_cmp_ge_u32 s58, 2228224
    s_cbranch_scc1 B_pollw_done
    s_cmp_lg_u32 s28, 0
    s_cbranch_scc1 B_pollw_done
    s_add_u32 s98, s60, s57
    s_addc_u32 s99, s61, 0
    s_mov_b32 s59, 0
B_pollw:
    s_load_dword s58, s[98:99], 0 glc
    s_add_u32 s59, s59, 1
    s_waitcnt lgkmcnt(0)
    s_cmp_ge_u32 s58, 2228224
    s_cbranch_scc1 B_pollw_done
    s_cmp_gt_u32 s59, 1048576
    s_cbranch_scc1 B_pollw_done
    s_sleep 4
    s_branch B_pollw
B_pollw_done:
    s_barrier
    v_mfma_f32_16x16x32_bf16 v[112:115], v[88:91], v[72:75], v[112:115]
    ds_read_b128 v[32:35], v14 offset:0
    v_mfma_f32_16x16x32_bf16 v[116:119], v[88:91], v[76:79], v[116:119]
    ds_read_b128 v[36:39], v14 offset:1024
    s_add_u32 m0, s54, 0
    s_mul_i32 s56, s55, 20480
    buffer_load_dwordx4 v21, s[48:51], s56 offen sc1 lds
    v_mfma_f32_16x16x32_bf16 v[120:123], v[88:91], v[80:83], v[120:123]
    ds_read_b128 v[40:43], v14 offset:2048
    v_mfma_f32_16x16x32_bf16 v[124:127], v[88:91], v[84:87], v[124:127]
    ds_read_b128 v[44:47], v14 offset:3072
    buffer_load_dwordx4 v21, s[48:51], s56 offen offset:1024 sc1 lds
    v_mfma_f32_16x16x32_bf16 v[128:131], v[92:95], v[72:75], v[128:131]
    ds_read_b64_tr_b16 v[48:49], v15 offset:0
    v_mfma_f32_16x16x32_bf16 v[132:135], v[92:95], v[76:79], v[132:135]
    ds_read_b64_tr_b16 v[50:51], v15 offset:256
    buffer_load_dwordx4 v21, s[48:51], s56 offen offset:2048 sc1 lds
    v_mfma_f32_16x16x32_bf16 v[136:139], v[92:95], v[80:83], v[136:139]
    ds_read_b64_tr_b16 v[52:53], v15 offset:6144
    v_mfma_f32_16x16x32_bf16 v[140:143], v[92:95], v[84:87], v[140:143]
    ds_read_b64_tr_b16 v[54:55], v15 offset:6400
    buffer_load_dwordx4 v21, s[48:51], s56 offen offset:3072 sc1 lds
    v_mfma_f32_16x16x32_bf16 v[144:147], v[96:99], v[72:75], v[144:147]
    ds_read_b64_tr_b16 v[56:57], v16 offset:0
    v_mfma_f32_16x16x32_bf16 v[148:151], v[96:99], v[76:79], v[148:151]
    ds_read_b64_tr_b16 v[58:59], v16 offset:256
    s_add_u32 m0, s54, 4096
    s_add_u32 s55, s55, 1
    s_cmp_eq_u32 s55, 12
    s_cselect_b32 s55, 0, s55
    buffer_load_dwordx4 v1, s[48:51], s56 offen sc1 lds
    v_mfma_f32_16x16x32_bf16 v[152:155], v[96:99], v[80:83], v[152:155]
    ds_read_b64_tr_b16 v[60:61], v16 offset:6144
    v_mfma_f32_16x16x32_bf16 v[156:159], v[96:99], v[84:87], v[156:159]
    ds_read_b64_tr_b16 v[62:63], v16 offset:6400
    s_add_u32 m0, s54, 20480
    s_mul_i32 s56, s55, 20480
    buffer_load_dwordx4 v21, s[48:51], s56 offen sc1 lds
    v_mfma_f32_16x16x32_bf16 v[160:163], v[100:103], v[72:75], v[160:163]
    s_waitcnt lgkmcnt(8)
    ds_read_b64_tr_b16 v[64:65], v17 offset:0
    v_mfma_f32_16x16x32_bf16 v[164:167], v[100:103], v[76:79], v[164:167]
    ds_read_b64_tr_b16 v[66:67], v17 offset:256
    buffer_load_dwordx4 v21, s[48:51], s56 offen offset:1024 sc1 lds
    v_mfma_f32_16x16x32_bf16 v[168:171], v[100:103], v[80:83], v[168:171]
    ds_read_b64_tr_b16 v[68:69], v17 offset:6144
    v_mfma_f32_16x16x32_bf16 v[172:175], v[100:103], v[84:87], v[172:175]
    ds_read_b64_tr_b16 v[70:71], v17 offset:6400
    buffer_load_dwordx4 v21, s[48:51], s56 offen offset:2048 sc1 lds
    v_mfma_f32_16x16x32_bf16 v[176:179], v[104:107], v[72:75], v[176:179]
    v_mfma_f32_16x16x32_bf16 v[180:183], v[104:107], v[76:79], v[180:183]
    buffer_load_dwordx4 v21, s[48:51], s56 offen offset:3072 sc1 lds
    v_mfma_f32_16x16x32_bf16 v[184:187], v[104:107], v[80:83], v[184:187]
    v_mfma_f32_16x16x32_bf16 v[188:191], v[104:107], v[84:87], v[188:191]
    s_add_u32 m0, s54, 24576
    s_add_u32 s55, s55, 1
    s_cmp_eq_u32 s55, 12
    s_cselect_b32 s55, 0, s55
    buffer_load_dwordx4 v1, s[48:51], s56 offen sc1 lds
    v_mfma_f32_16x16x32_bf16 v[192:195], v[108:111], v[72:75], v[192:195]
    v_mfma_f32_16x16x32_bf16 v[196:199], v[108:111], v[76:79], v[196:199]
    v_mfma_f32_16x16x32_bf16 v[200:203], v[108:111], v[80:83], v[200:203]
    v_mfma_f32_16x16x32_bf16 v[204:207], v[108:111], v[84:87], v[204:207]
    s_waitcnt lgkmcnt(0)
    v_mfma_f32_16x16x32_bf16 v[112:115], v[48:51], v[32:35], v[112:115]
    ds_read_b128 v[72:75], v14 offset:20480
    v_mfma_f32_16x16x32_bf16 v[116:119], v[48:51], v[36:39], v[116:119]
    ds_read_b128 v[76:79], v14 offset:21504
    v_mfma_f32_16x16x32_bf16 v[120:123], v[48:51], v[40:43], v[120:123]
    ds_read_b128 v[80:83], v14 offset:22528
    v_mfma_f32_16x16x32_bf16 v[124:127], v[48:51], v[44:47], v[124:127]
    ds_read_b128 v[84:87], v14 offset:23552
    v_mfma_f32_16x16x32_bf16 v[128:131], v[52:55], v[32:35], v[128:131]
    ds_read_b64_tr_b16 v[88:89], v15 offset:20480
    v_mfma_f32_16x16x32_bf16 v[132:135], v[52:55], v[36:39], v[132:135]
    ds_read_b64_tr_b16 v[90:91], v15 offset:20736
    v_mfma_f32_16x16x32_bf16 v[136:139], v[52:55], v[40:43], v[136:139]
    ds_read_b64_tr_b16 v[92:93], v15 offset:26624
    v_mfma_f32_16x16x32_bf16 v[140:143], v[52:55], v[44:47], v[140:143]
    ds_read_b64_tr_b16 v[94:95], v15 offset:26880
    v_mfma_f32_16x16x32_bf16 v[144:147], v[56:59], v[32:35], v[144:147]
    ds_read_b64_tr_b16 v[96:97], v16 offset:20480
    v_mfma_f32_16x16x32_bf16 v[148:151], v[56:59], v[36:39], v[148:151]
    ds_read_b64_tr_b16 v[98:99], v16 offset:20736
    v_mfma_f32_16x16x32_bf16 v[152:155], v[56:59], v[40:43], v[152:155]
    ds_read_b64_tr_b16 v[100:101], v16 offset:26624
    v_mfma_f32_16x16x32_bf16 v[156:159], v[56:59], v[44:47], v[156:159]
    ds_read_b64_tr_b16 v[102:103], v16 offset:26880
    v_mfma_f32_16x16x32_bf16 v[160:163], v[60:63], v[32:35], v[160:163]
    s_waitcnt lgkmcnt(8)
    ds_read_b64_tr_b16 v[104:105], v17 offset:20480
    v_mfma_f32_16x16x32_bf16 v[164:167], v[60:63], v[36:39], v[164:167]
    ds_read_b64_tr_b16 v[106:107], v17 offset:20736
    v_mfma_f32_16x16x32_bf16 v[168:171], v[60:63], v[40:43], v[168:171]
    ds_read_b64_tr_b16 v[108:109], v17 offset:26624
    v_mfma_f32_16x16x32_bf16 v[172:175], v[60:63], v[44:47], v[172:175]
    ds_read_b64_tr_b16 v[110:111], v17 offset:26880
    v_mfma_f32_16x16x32_bf16 v[176:179], v[64:67], v[32:35], v[176:179]
    v_mfma_f32_16x16x32_bf16 v[180:183], v[64:67], v[36:39], v[180:183]
    v_mfma_f32_16x16x32_bf16 v[184:187], v[64:67], v[40:43], v[184:187]
    v_mfma_f32_16x16x32_bf16 v[188:191], v[64:67], v[44:47], v[188:191]
    v_mfma_f32_16x16x32_bf16 v[192:195], v[68:71], v[32:35], v[192:195]
    v_mfma_f32_16x16x32_bf16 v[196:199], v[68:71], v[36:39], v[196:199]
    v_mfma_f32_16x16x32_bf16 v[200:203], v[68:71], v[40:43], v[200:203]
    v_mfma_f32_16x16x32_bf16 v[204:207], v[68:71], v[44:47], v[204:207]
    s_waitcnt lgkmcnt(0)
    v_mfma_f32_16x16x32_bf16 v[112:115], v[88:91], v[72:75], v[112:115]
    v_mfma_f32_16x16x32_bf16 v[116:119], v[88:91], v[76:79], v[116:119]
    v_mfma_f32_16x16x32_bf16 v[120:123], v[88:91], v[80:83], v[120:123]
    v_mfma_f32_16x16x32_bf16 v[124:127], v[88:91], v[84:87], v[124:127]
    v_mfma_f32_16x16x32_bf16 v[128:131], v[92:95], v[72:75], v[128:131]
    v_mfma_f32_16x16x32_bf16 v[132:135], v[92:95], v[76:79], v[132:135]
    v_mfma_f32_16x16x32_bf16 v[136:139], v[92:95], v[80:83], v[136:139]
    v_mfma_f32_16x16x32_bf16 v[140:143], v[92:95], v[84:87], v[140:143]
    v_mfma_f32_16x16x32_bf16 v[144:147], v[96:99], v[72:75], v[144:147]
    v_mfma_f32_16x16x32_bf16 v[148:151], v[96:99], v[76:79], v[148:151]
    v_mfma_f32_16x16x32_bf16 v[152:155], v[96:99], v[80:83], v[152:155]
    v_mfma_f32_16x16x32_bf16 v[156:159], v[96:99], v[84:87], v[156:159]
    v_mfma_f32_16x16x32_bf16 v[160:163], v[100:103], v[72:75], v[160:163]
    v_mfma_f32_16x16x32_bf16 v[164:167], v[100:103], v[76:79], v[164:167]
    v_mfma_f32_16x16x32_bf16 v[168:171], v[100:103], v[80:83], v[168:171]
    v_mfma_f32_16x16x32_bf16 v[172:175], v[100:103], v[84:87], v[172:175]
    v_mfma_f32_16x16x32_bf16 v[176:179], v[104:107], v[72:75], v[176:179]
    v_mfma_f32_16x16x32_bf16 v[180:183], v[104:107], v[76:79], v[180:183]
    v_mfma_f32_16x16x32_bf16 v[184:187], v[104:107], v[80:83], v[184:187]
    v_mfma_f32_16x16x32_bf16 v[188:191], v[104:107], v[84:87], v[188:191]
    v_mfma_f32_16x16x32_bf16 v[192:195], v[108:111], v[72:75], v[192:195]
    v_mfma_f32_16x16x32_bf16 v[196:199], v[108:111], v[76:79], v[196:199]
    v_mfma_f32_16x16x32_bf16 v[200:203], v[108:111], v[80:83], v[200:203]
    v_mfma_f32_16x16x32_bf16 v[204:207], v[108:111], v[84:87], v[204:207]
    s_setprio 3
    s_mov_b32 s44, 0xbfb8aa3b
    s_mov_b32 s45, 0xbfb8aa3b
    s_load_dwordx2 s[8:9], s[0:1], 64
    s_nop 3
    v_pk_mul_f32 v[32:33], v[112:113], s[44:45]
    v_pk_mul_f32 v[34:35], v[114:115], s[44:45]
    v_pk_mul_f32 v[36:37], v[144:145], s[44:45]
    v_pk_mul_f32 v[38:39], v[146:147], s[44:45]
    v_exp_f32 v32, v32
    v_exp_f32 v33, v33
    v_exp_f32 v34, v34
    v_exp_f32 v35, v35
    v_exp_f32 v36, v36
    v_exp_f32 v37, v37
    v_exp_f32 v38, v38
    v_exp_f32 v39, v39
    v_pk_mul_f32 v[112:113], v[112:113], v[128:129]
    v_pk_mul_f32 v[114:115], v[114:115], v[130:131]
    v_pk_mul_f32 v[144:145], v[144:145], v[160:161]
    v_pk_mul_f32 v[146:147], v[146:147], v[162:163]
    v_pk_add_f32 v[32:33], v[32:33], 1.0 op_sel_hi:[1,0]
    v_pk_add_f32 v[34:35], v[34:35], 1.0 op_sel_hi:[1,0]
    v_pk_add_f32 v[36:37], v[36:37], 1.0 op_sel_hi:[1,0]
    v_pk_add_f32 v[38:39], v[38:39], 1.0 op_sel_hi:[1,0]
    v_rcp_f32 v32, v32
    v_rcp_f32 v33, v33
    v_rcp_f32 v34, v34
    v_rcp_f32 v35, v35
    v_rcp_f32 v36, v36
    v_rcp_f32 v37, v37
    v_rcp_f32 v38, v38
    v_rcp_f32 v39, v39
    s_nop 0
    v_pk_mul_f32 v[112:113], v[112:113], v[32:33]
    v_pk_mul_f32 v[114:115], v[114:115], v[34:35]
    v_pk_mul_f32 v[144:145], v[144:145], v[36:37]
    v_pk_mul_f32 v[146:147], v[146:147], v[38:39]
    v_cvt_pk_bf16_f32 v40, v112, v113
    v_cvt_pk_bf16_f32 v41, v114, v115
    v_cvt_pk_bf16_f32 v42, v144, v145
    v_cvt_pk_bf16_f32 v43, v146, v147
    buffer_store_dwordx4 v[40:43], v20, s[40:43], 0 offen offset:0 sc1
    v_pk_mul_f32 v[44:45], v[116:117], s[44:45]
    v_pk_mul_f32 v[46:47], v[118:119], s[44:45]
    v_pk_mul_f32 v[48:49], v[148:149], s[44:45]
    v_pk_mul_f32 v[50:51], v[150:151], s[44:45]
    v_exp_f32 v44, v44
    v_exp_f32 v45, v45
    v_exp_f32 v46, v46
    v_exp_f32 v47, v47
    v_exp_f32 v48, v48
    v_exp_f32 v49, v49
    v_exp_f32 v50, v50
    v_exp_f32 v51, v51
    v_pk_mul_f32 v[116:117], v[116:117], v[132:133]
    v_pk_mul_f32 v[118:119], v[118:119], v[134:135]
    v_pk_mul_f32 v[148:149], v[148:149], v[164:165]
    v_pk_mul_f32 v[150:151], v[150:151], v[166:167]
    v_pk_add_f32 v[44:45], v[44:45], 1.0 op_sel_hi:[1,0]
    v_pk_add_f32 v[46:47], v[46:47], 1.0 op_sel_hi:[1,0]
    v_pk_add_f32 v[48:49], v[48:49], 1.0 op_sel_hi:[1,0]
    v_pk_add_f32 v[50:51], v[50:51], 1.0 op_sel_hi:[1,0]
    v_rcp_f32 v44, v44
    v_rcp_f32 v45, v45
    v_rcp_f32 v46, v46
    v_rcp_f32 v47, v47
    v_rcp_f32 v48, v48
    v_rcp_f32 v49, v49
    v_rcp_f32 v50, v50
    v_rcp_f32 v51, v51
    s_nop 0
    v_pk_mul_f32 v[116:117], v[116:117], v[44:45]
    v_pk_mul_f32 v[118:119], v[118:119], v[46:47]
    v_pk_mul_f32 v[148:149], v[148:149], v[48:49]
    v_pk_mul_f32 v[150:151], v[150:151], v[50:51]
    v_cvt_pk_bf16_f32 v52, v116, v117
    v_cvt_pk_bf16_f32 v53, v118, v119
    v_cvt_pk_bf16_f32 v54, v148, v149
    v_cvt_pk_bf16_f32 v55, v150, v151
    buffer_store_dwordx4 v[52:55], v20, s[40:43], 0 offen offset:256 sc1
    v_pk_mul_f32 v[56:57], v[120:121], s[44:45]
    v_pk_mul_f32 v[58:59], v[122:123], s[44:45]
    v_pk_mul_f32 v[60:61], v[152:153], s[44:45]
    v_pk_mul_f32 v[62:63], v[154:155], s[44:45]
    v_exp_f32 v56, v56
    v_exp_f32 v57, v57
    v_exp_f32 v58, v58
    v_exp_f32 v59, v59
    v_exp_f32 v60, v60
    v_exp_f32 v61, v61
    v_exp_f32 v62, v62
    v_exp_f32 v63, v63
    v_pk_mul_f32 v[120:121], v[120:121], v[136:137]
    v_pk_mul_f32 v[122:123], v[122:123], v[138:139]
    v_pk_mul_f32 v[152:153], v[152:153], v[168:169]
    v_pk_mul_f32 v[154:155], v[154:155], v[170:171]
    v_pk_add_f32 v[56:57], v[56:57], 1.0 op_sel_hi:[1,0]
    v_pk_add_f32 v[58:59], v[58:59], 1.0 op_sel_hi:[1,0]
    v_pk_add_f32 v[60:61], v[60:61], 1.0 op_sel_hi:[1,0]
    v_pk_add_f32 v[62:63], v[62:63], 1.0 op_sel_hi:[1,0]
    v_rcp_f32 v56, v56
    v_rcp_f32 v57, v57
    v_rcp_f32 v58, v58
    v_rcp_f32 v59, v59
    v_rcp_f32 v60, v60
    v_rcp_f32 v61, v61
    v_rcp_f32 v62, v62
    v_rcp_f32 v63, v63
    s_nop 0
    v_pk_mul_f32 v[120:121], v[120:121], v[56:57]
    v_pk_mul_f32 v[122:123], v[122:123], v[58:59]
    v_pk_mul_f32 v[152:153], v[152:153], v[60:61]
    v_pk_mul_f32 v[154:155], v[154:155], v[62:63]
    v_cvt_pk_bf16_f32 v64, v120, v121
    v_cvt_pk_bf16_f32 v65, v122, v123
    v_cvt_pk_bf16_f32 v66, v152, v153
    v_cvt_pk_bf16_f32 v67, v154, v155
    buffer_store_dwordx4 v[64:67], v20, s[40:43], s37 offen offset:0 sc1
    v_pk_mul_f32 v[68:69], v[124:125], s[44:45]
    v_pk_mul_f32 v[70:71], v[126:127], s[44:45]
    v_pk_mul_f32 v[72:73], v[156:157], s[44:45]
    v_pk_mul_f32 v[74:75], v[158:159], s[44:45]
    v_exp_f32 v68, v68
    v_exp_f32 v69, v69
    v_exp_f32 v70, v70
    v_exp_f32 v71, v71
    v_exp_f32 v72, v72
    v_exp_f32 v73, v73
    v_exp_f32 v74, v74
    v_exp_f32 v75, v75
    v_pk_mul_f32 v[124:125], v[124:125], v[140:141]
    v_pk_mul_f32 v[126:127], v[126:127], v[142:143]
    v_pk_mul_f32 v[156:157], v[156:157], v[172:173]
    v_pk_mul_f32 v[158:159], v[158:159], v[174:175]
    v_pk_add_f32 v[68:69], v[68:69], 1.0 op_sel_hi:[1,0]
    v_pk_add_f32 v[70:71], v[70:71], 1.0 op_sel_hi:[1,0]
    v_pk_add_f32 v[72:73], v[72:73], 1.0 op_sel_hi:[1,0]
    v_pk_add_f32 v[74:75], v[74:75], 1.0 op_sel_hi:[1,0]
    v_rcp_f32 v68, v68
    v_rcp_f32 v69, v69
    v_rcp_f32 v70, v70
    v_rcp_f32 v71, v71
    v_rcp_f32 v72, v72
    v_rcp_f32 v73, v73
    v_rcp_f32 v74, v74
    v_rcp_f32 v75, v75
    s_nop 0
    v_pk_mul_f32 v[124:125], v[124:125], v[68:69]
    v_pk_mul_f32 v[126:127], v[126:127], v[70:71]
    v_pk_mul_f32 v[156:157], v[156:157], v[72:73]
    v_pk_mul_f32 v[158:159], v[158:159], v[74:75]
    v_cvt_pk_bf16_f32 v76, v124, v125
    v_cvt_pk_bf16_f32 v77, v126, v127
    v_cvt_pk_bf16_f32 v78, v156, v157
    v_cvt_pk_bf16_f32 v79, v158, v159
    buffer_store_dwordx4 v[76:79], v20, s[40:43], s37 offen offset:256 sc1
    v_pk_mul_f32 v[80:81], v[176:177], s[44:45]
    v_pk_mul_f32 v[82:83], v[178:179], s[44:45]
    v_pk_mul_f32 v[84:85], v[180:181], s[44:45]
    v_pk_mul_f32 v[86:87], v[182:183], s[44:45]
    v_exp_f32 v80, v80
    v_exp_f32 v81, v81
    v_exp_f32 v82, v82
    v_exp_f32 v83, v83
    v_exp_f32 v84, v84
    v_exp_f32 v85, v85
    v_exp_f32 v86, v86
    v_exp_f32 v87, v87
    v_pk_mul_f32 v[176:177], v[176:177], v[192:193]
    v_pk_mul_f32 v[178:179], v[178:179], v[194:195]
    v_pk_mul_f32 v[180:181], v[180:181], v[196:197]
    v_pk_mul_f32 v[182:183], v[182:183], v[198:199]
    v_pk_add_f32 v[80:81], v[80:81], 1.0 op_sel_hi:[1,0]
    v_pk_add_f32 v[82:83], v[82:83], 1.0 op_sel_hi:[1,0]
    v_pk_add_f32 v[84:85], v[84:85], 1.0 op_sel_hi:[1,0]
    v_pk_add_f32 v[86:87], v[86:87], 1.0 op_sel_hi:[1,0]
    v_rcp_f32 v80, v80
    v_rcp_f32 v81, v81
    v_rcp_f32 v82, v82
    v_rcp_f32 v83, v83
    v_rcp_f32 v84, v84
    v_rcp_f32 v85, v85
    v_rcp_f32 v86, v86
    v_rcp_f32 v87, v87
    s_nop 0
    v_pk_mul_f32 v[176:177], v[176:177], v[80:81]
    v_pk_mul_f32 v[178:179], v[178:179], v[82:83]
    v_pk_mul_f32 v[180:181], v[180:181], v[84:85]
    v_pk_mul_f32 v[182:183], v[182:183], v[86:87]
    v_cvt_pk_bf16_f32 v88, v176, v177
    v_cvt_pk_bf16_f32 v89, v178, v179
    v_cvt_pk_bf16_f32 v90, v180, v181
    v_cvt_pk_bf16_f32 v91, v182, v183
    buffer_store_dwordx2 v[88:89], v19, s[40:43], 0 offen sc1
    buffer_store_dwordx2 v[90:91], v19, s[40:43], 0 offen offset:256 sc1
    v_pk_mul_f32 v[92:93], v[184:185], s[44:45]
    v_pk_mul_f32 v[94:95], v[186:187], s[44:45]
    v_pk_mul_f32 v[96:97], v[188:189], s[44:45]
    v_pk_mul_f32 v[98:99], v[190:191], s[44:45]
    v_exp_f32 v92, v92
    v_exp_f32 v93, v93
    v_exp_f32 v94, v94
    v_exp_f32 v95, v95
    v_exp_f32 v96, v96
    v_exp_f32 v97, v97
    v_exp_f32 v98, v98
    v_exp_f32 v99, v99
    v_pk_mul_f32 v[184:185], v[184:185], v[200:201]
    v_pk_mul_f32 v[186:187], v[186:187], v[202:203]
    v_pk_mul_f32 v[188:189], v[188:189], v[204:205]
    v_pk_mul_f32 v[190:191], v[190:191], v[206:207]
    v_pk_add_f32 v[92:93], v[92:93], 1.0 op_sel_hi:[1,0]
    v_pk_add_f32 v[94:95], v[94:95], 1.0 op_sel_hi:[1,0]
    v_pk_add_f32 v[96:97], v[96:97], 1.0 op_sel_hi:[1,0]
    v_pk_add_f32 v[98:99], v[98:99], 1.0 op_sel_hi:[1,0]
    v_rcp_f32 v92, v92
    v_rcp_f32 v93, v93
    v_rcp_f32 v94, v94
    v_rcp_f32 v95, v95
    v_rcp_f32 v96, v96
    v_rcp_f32 v97, v97
    v_rcp_f32 v98, v98
    v_rcp_f32 v99, v99
    s_nop 0
    v_pk_mul_f32 v[184:185], v[184:185], v[92:93]
    v_pk_mul_f32 v[186:187], v[186:187], v[94:95]
    v_pk_mul_f32 v[188:189], v[188:189], v[96:97]
    v_pk_mul_f32 v[190:191], v[190:191], v[98:99]
    v_cvt_pk_bf16_f32 v100, v184, v185
    v_cvt_pk_bf16_f32 v101, v186, v187
    v_cvt_pk_bf16_f32 v102, v188, v189
    v_cvt_pk_bf16_f32 v103, v190, v191
    buffer_store_dwordx2 v[100:101], v19, s[40:43], s37 offen sc1
    buffer_store_dwordx2 v[102:103], v19, s[40:43], s37 offen offset:256 sc1
    s_lshl_b32 s26, s24, 2
    s_and_b32 s27, s25, 3
    s_add_u32 s26, s26, s27
    s_lshr_b32 s27, s25, 2
    s_add_u32 s57, s26, 32
    s_lshl_b32 s57, s57, 8
    s_mul_i32 s29, s27, 160
    v_lshlrev_b32 v9, 4, v2
    s_add_u32 s39, s25, s27
    s_and_b32 s39, s39, 3
    s_mul_i32 s39, s39, 3
    s_lshr_b32 s53, s27, 2
    s_add_u32 s53, s53, s27
    s_lshl_b32 s30, s26, 1
    s_add_u32 s30, s30, s35
    s_mul_i32 s32, s30, 96
    s_lshl_b32 s33, s36, 2
    s_add_u32 s32, s32, s33
    s_lshl_b32 s32, s32, 10
    v_add_u32 v25, s32, v18
    v_lshrrev_b32 v7, 1, v23
    v_mul_u32_u24 v7, 2560, v7
    v_and_b32 v8, 1, v23
    v_lshl_add_u32 v7, v8, 8, v7
    v_lshl_add_u32 v26, v3, 4, v7
    v_add_u32 v27, 40960, v26
    s_mul_i32 s32, s36, 10240
    v_add_u32 v28, s32, v26
    v_add_u32 v29, s32, v27
    s_mul_i32 s32, s36, 5120
    v_add_u32 v26, s32, v26
    v_add_u32 v27, s32, v27
    v_mov_b32 v4, v23
    s_lshl_b32 s32, s26, 6
    s_lshl_b32 s33, s35, 5
    s_add_u32 s32, s32, s33
    v_add_u32 v24, s32, v3
    v_lshlrev_b32 v22, 2, v24
    s_lshl_b32 s33, s36, 4
    v_add_u32 v24, s33, v24
    s_add_u32 s20, s10, 0xa00000
    s_addc_u32 s21, s11, 0
    s_mov_b32 s22, 0x2000
    s_mov_b32 s23, 0x00020000
    s_setprio 0
    s_waitcnt vmcnt(0)
    s_barrier
    s_cmp_lg_u32 s28, 0
    s_cbranch_scc1 B_sigh
    s_lshl_b32 s58, s97, 8
    s_add_u32 s100, s60, s58
    s_addc_u32 s101, s61, 0
    s_mov_b32 s95, 0x20000
    s_atomic_add s95, s[100:101], 0
    s_atomic_add s95, s[100:101], 256
    B_sigh:
    s_add_u32 m0, s54, 40960
    s_mul_i32 s56, s55, 20480
    buffer_load_dwordx4 v21, s[48:51], s56 offen sc1 lds
    buffer_load_dwordx4 v21, s[48:51], s56 offen offset:1024 sc1 lds
    buffer_load_dwordx4 v21, s[48:51], s56 offen offset:2048 sc1 lds
    buffer_load_dwordx4 v21, s[48:51], s56 offen offset:3072 sc1 lds
    s_add_u32 m0, s54, 45056
    s_add_u32 s55, s55, 1
    s_cmp_eq_u32 s55, 12
    s_cselect_b32 s55, 0, s55
    buffer_load_dwordx4 v1, s[48:51], s56 offen sc1 lds
    s_add_u32 m0, s54, 61440
    s_mul_i32 s56, s55, 20480
    buffer_load_dwordx4 v21, s[48:51], s56 offen sc1 lds
    buffer_load_dwordx4 v21, s[48:51], s56 offen offset:1024 sc1 lds
    buffer_load_dwordx4 v21, s[48:51], s56 offen offset:2048 sc1 lds
    buffer_load_dwordx4 v21, s[48:51], s56 offen offset:3072 sc1 lds
    s_add_u32 m0, s54, 65536
    s_add_u32 s55, s55, 1
    s_cmp_eq_u32 s55, 12
    s_cselect_b32 s55, 0, s55
    buffer_load_dwordx4 v1, s[48:51], s56 offen sc1 lds
    s_cmp_lg_u32 s28, 0
    s_cbranch_scc1 B_pollh_done
    s_add_u32 s98, s60, s57
    s_addc_u32 s99, s61, 0
    s_mov_b32 s59, 0
B_pollh:
    s_load_dword s58, s[98:99], 0 glc
    s_add_u32 s59, s59, 1
    s_waitcnt lgkmcnt(0)
    s_cmp_ge_u32 s58, 2228224
    s_cbranch_scc1 B_pollh_done
    s_cmp_gt_u32 s59, 1048576
    s_cbranch_scc1 B_pollh_done
    s_sleep 2
    s_branch B_pollh
B_pollh_done:
    s_barrier
    s_lshl_b32 s33, s39, 13
    buffer_load_dwordx4 v[32:35], v25, s[40:43], s33 offen offset:0 sc1
    s_add_u32 s39, s39, 1
    buffer_load_dwordx4 v[36:39], v25, s[40:43], s33 offen offset:256 sc1
    s_cmp_eq_u32 s39, 12
    s_cselect_b32 s39, 0, s39
    buffer_load_dwordx4 v[40:43], v25, s[40:43], s33 offen offset:2048 sc1
    buffer_load_dwordx4 v[44:47], v25, s[40:43], s33 offen offset:2304 sc1
    s_lshl_b32 s33, s39, 13
    buffer_load_dwordx4 v[48:51], v25, s[40:43], s33 offen offset:0 sc1
    s_add_u32 s39, s39, 1
    buffer_load_dwordx4 v[52:55], v25, s[40:43], s33 offen offset:256 sc1
    s_cmp_eq_u32 s39, 12
    s_cselect_b32 s39, 0, s39
    buffer_load_dwordx4 v[56:59], v25, s[40:43], s33 offen offset:2048 sc1
    buffer_load_dwordx4 v[60:63], v25, s[40:43], s33 offen offset:2304 sc1
    s_lshl_b32 s33, s39, 13
    buffer_load_dwordx4 v[64:67], v25, s[40:43], s33 offen offset:0 sc1
    s_add_u32 s39, s39, 1
    buffer_load_dwordx4 v[68:71], v25, s[40:43], s33 offen offset:256 sc1
    s_cmp_eq_u32 s39, 12
    s_cselect_b32 s39, 0, s39
    buffer_load_dwordx4 v[72:75], v25, s[40:43], s33 offen offset:2048 sc1
    buffer_load_dwordx4 v[76:79], v25, s[40:43], s33 offen offset:2304 sc1
    s_lshl_b32 s33, s39, 13
    buffer_load_dwordx4 v[80:83], v25, s[40:43], s33 offen offset:0 sc1
    s_add_u32 s39, s39, 1
    buffer_load_dwordx4 v[84:87], v25, s[40:43], s33 offen offset:256 sc1
    s_cmp_eq_u32 s39, 12
    s_cselect_b32 s39, 0, s39
    buffer_load_dwordx4 v[88:91], v25, s[40:43], s33 offen offset:2048 sc1
    buffer_load_dwordx4 v[92:95], v25, s[40:43], s33 offen offset:2304 sc1
    buffer_load_dword v10, v22, s[20:23], 0 offen sc1
    buffer_load_dword v11, v22, s[20:23], 0 offen offset:64 sc1
    ds_read_b128 v[192:195], v28 offset:0
    ds_read_b128 v[196:199], v28 offset:512
    ds_read_b128 v[200:203], v28 offset:1024
    ds_read_b128 v[204:207], v28 offset:1536
    ds_read_b128 v[208:211], v28 offset:2048
    s_waitcnt vmcnt(14) lgkmcnt(0)
    v_mfma_f32_16x16x32_bf16 v[112:115], v[192:195], v[32:35], 0
    ds_read_b128 v[212:215], v28 offset:5120
    v_mfma_f32_16x16x32_bf16 v[132:135], v[192:195], v[36:39], 0
    ds_read_b128 v[216:219], v28 offset:5632
    v_mfma_f32_16x16x32_bf16 v[116:119], v[196:199], v[32:35], 0
    ds_read_b128 v[220:223], v28 offset:6144
    v_mfma_f32_16x16x32_bf16 v[136:139], v[196:199], v[36:39], 0
    ds_read_b128 v[224:227], v28 offset:6656
    v_mfma_f32_16x16x32_bf16 v[120:123], v[200:203], v[32:35], 0
    ds_read_b128 v[228:231], v28 offset:7168
    v_mfma_f32_16x16x32_bf16 v[140:143], v[200:203], v[36:39], 0
    v_mfma_f32_16x16x32_bf16 v[124:127], v[204:207], v[32:35], 0
    v_mfma_f32_16x16x32_bf16 v[144:147], v[204:207], v[36:39], 0
    v_mfma_f32_16x16x32_bf16 v[128:131], v[208:211], v[32:35], 0
    v_mfma_f32_16x16x32_bf16 v[148:151], v[208:211], v[36:39], 0
    s_waitcnt lgkmcnt(0)
    v_mfma_f32_16x16x32_bf16 v[112:115], v[212:215], v[40:43], v[112:115]
    ds_read_b128 v[232:235], v28 offset:20480
    v_mfma_f32_16x16x32_bf16 v[132:135], v[212:215], v[44:47], v[132:135]
    ds_read_b128 v[236:239], v28 offset:20992
    v_mfma_f32_16x16x32_bf16 v[116:119], v[216:219], v[40:43], v[116:119]
    ds_read_b128 v[240:243], v28 offset:21504
    v_mfma_f32_16x16x32_bf16 v[136:139], v[216:219], v[44:47], v[136:139]
    ds_read_b128 v[244:247], v28 offset:22016
    v_mfma_f32_16x16x32_bf16 v[120:123], v[220:223], v[40:43], v[120:123]
    ds_read_b128 v[248:251], v28 offset:22528
    v_mfma_f32_16x16x32_bf16 v[140:143], v[220:223], v[44:47], v[140:143]
    v_mfma_f32_16x16x32_bf16 v[124:127], v[224:227], v[40:43], v[124:127]
    v_mfma_f32_16x16x32_bf16 v[144:147], v[224:227], v[44:47], v[144:147]
    v_mfma_f32_16x16x32_bf16 v[128:131], v[228:231], v[40:43], v[128:131]
    v_mfma_f32_16x16x32_bf16 v[148:151], v[228:231], v[44:47], v[148:151]
    s_waitcnt vmcnt(10) lgkmcnt(0)
    v_mfma_f32_16x16x32_bf16 v[112:115], v[232:235], v[48:51], v[112:115]
    ds_read_b128 v[192:195], v28 offset:25600
    v_mfma_f32_16x16x32_bf16 v[132:135], v[232:235], v[52:55], v[132:135]
    ds_read_b128 v[196:199], v28 offset:26112
    s_lshl_b32 s33, s39, 13
    buffer_load_dwordx4 v[32:35], v25, s[40:43], s33 offen offset:0 sc1
    v_mfma_f32_16x16x32_bf16 v[116:119], v[236:239], v[48:51], v[116:119]
    ds_read_b128 v[200:203], v28 offset:26624
    v_mfma_f32_16x16x32_bf16 v[136:139], v[236:239], v[52:55], v[136:139]
    ds_read_b128 v[204:207], v28 offset:27136
    s_add_u32 s39, s39, 1
    buffer_load_dwordx4 v[36:39], v25, s[40:43], s33 offen offset:256 sc1
    v_mfma_f32_16x16x32_bf16 v[120:123], v[240:243], v[48:51], v[120:123]
    ds_read_b128 v[208:211], v28 offset:27648
    v_mfma_f32_16x16x32_bf16 v[140:143], v[240:243], v[52:55], v[140:143]
    s_cmp_eq_u32 s39, 12
    s_cselect_b32 s39, 0, s39
    buffer_load_dwordx4 v[40:43], v25, s[40:43], s33 offen offset:2048 sc1
    v_mfma_f32_16x16x32_bf16 v[124:127], v[244:247], v[48:51], v[124:127]
    v_mfma_f32_16x16x32_bf16 v[144:147], v[244:247], v[52:55], v[144:147]
    buffer_load_dwordx4 v[44:47], v25, s[40:43], s33 offen offset:2304 sc1
    v_mfma_f32_16x16x32_bf16 v[128:131], v[248:251], v[48:51], v[128:131]
    v_mfma_f32_16x16x32_bf16 v[148:151], v[248:251], v[52:55], v[148:151]
    s_waitcnt vmcnt(18) lgkmcnt(0)
    s_barrier
    v_mfma_f32_16x16x32_bf16 v[112:115], v[192:195], v[56:59], v[112:115]
    ds_read_b128 v[212:215], v29 offset:0
    v_mfma_f32_16x16x32_bf16 v[132:135], v[192:195], v[60:63], v[132:135]
    ds_read_b128 v[216:219], v29 offset:512
    s_add_u32 m0, s54, 0
    s_mul_i32 s56, s55, 20480
    buffer_load_dwordx4 v21, s[48:51], s56 offen sc1 lds
    v_mfma_f32_16x16x32_bf16 v[116:119], v[196:199], v[56:59], v[116:119]
    ds_read_b128 v[220:223], v29 offset:1024
    v_mfma_f32_16x16x32_bf16 v[136:139], v[196:199], v[60:63], v[136:139]
    ds_read_b128 v[224:227], v29 offset:1536
    buffer_load_dwordx4 v21, s[48:51], s56 offen offset:1024 sc1 lds
    v_mfma_f32_16x16x32_bf16 v[120:123], v[200:203], v[56:59], v[120:123]
    ds_read_b128 v[228:231], v29 offset:2048
    v_mfma_f32_16x16x32_bf16 v[140:143], v[200:203], v[60:63], v[140:143]
    buffer_load_dwordx4 v21, s[48:51], s56 offen offset:2048 sc1 lds
    v_mfma_f32_16x16x32_bf16 v[124:127], v[204:207], v[56:59], v[124:127]
    v_mfma_f32_16x16x32_bf16 v[144:147], v[204:207], v[60:63], v[144:147]
    buffer_load_dwordx4 v21, s[48:51], s56 offen offset:3072 sc1 lds
    v_mfma_f32_16x16x32_bf16 v[128:131], v[208:211], v[56:59], v[128:131]
    v_mfma_f32_16x16x32_bf16 v[148:151], v[208:211], v[60:63], v[148:151]
    s_add_u32 m0, s54, 4096
    s_add_u32 s55, s55, 1
    s_cmp_eq_u32 s55, 12
    s_cselect_b32 s55, 0, s55
    buffer_load_dwordx4 v1, s[48:51], s56 offen sc1 lds
    s_waitcnt vmcnt(15) lgkmcnt(0)
    v_mfma_f32_16x16x32_bf16 v[112:115], v[212:215], v[64:67], v[112:115]
    ds_read_b128 v[232:235], v29 offset:5120
    v_mfma_f32_16x16x32_bf16 v[132:135], v[212:215], v[68:71], v[132:135]
    ds_read_b128 v[236:239], v29 offset:5632
    s_add_u32 m0, s54, 20480
    s_mul_i32 s56, s55, 20480
    buffer_load_dwordx4 v21, s[48:51], s56 offen sc1 lds
    v_mfma_f32_16x16x32_bf16 v[116:119], v[216:219], v[64:67], v[116:119]
    ds_read_b128 v[240:243], v29 offset:6144
    v_mfma_f32_16x16x32_bf16 v[136:139], v[216:219], v[68:71], v[136:139]
    ds_read_b128 v[244:247], v29 offset:6656
    buffer_load_dwordx4 v21, s[48:51], s56 offen offset:1024 sc1 lds
    v_mfma_f32_16x16x32_bf16 v[120:123], v[220:223], v[64:67], v[120:123]
    ds_read_b128 v[248:251], v29 offset:7168
    v_mfma_f32_16x16x32_bf16 v[140:143], v[220:223], v[68:71], v[140:143]
    buffer_load_dwordx4 v21, s[48:51], s56 offen offset:2048 sc1 lds
    v_mfma_f32_16x16x32_bf16 v[124:127], v[224:227], v[64:67], v[124:127]
    v_mfma_f32_16x16x32_bf16 v[144:147], v[224:227], v[68:71], v[144:147]
    buffer_load_dwordx4 v21, s[48:51], s56 offen offset:3072 sc1 lds
    v_mfma_f32_16x16x32_bf16 v[128:131], v[228:231], v[64:67], v[128:131]
    v_mfma_f32_16x16x32_bf16 v[148:151], v[228:231], v[68:71], v[148:151]
    s_add_u32 m0, s54, 24576
    s_add_u32 s55, s55, 1
    s_cmp_eq_u32 s55, 12
    s_cselect_b32 s55, 0, s55
    buffer_load_dwordx4 v1, s[48:51], s56 offen sc1 lds
    s_waitcnt lgkmcnt(0)
    v_mfma_f32_16x16x32_bf16 v[112:115], v[232:235], v[72:75], v[112:115]
    ds_read_b128 v[192:195], v29 offset:20480
    v_mfma_f32_16x16x32_bf16 v[132:135], v[232:235], v[76:79], v[132:135]
    ds_read_b128 v[196:199], v29 offset:20992
    s_lshl_b32 s33, s39, 13
    buffer_load_dwordx4 v[48:51], v25, s[40:43], s33 offen offset:0 sc1
    v_mfma_f32_16x16x32_bf16 v[116:119], v[236:239], v[72:75], v[116:119]
    ds_read_b128 v[200:203], v29 offset:21504
    v_mfma_f32_16x16x32_bf16 v[136:139], v[236:239], v[76:79], v[136:139]
    ds_read_b128 v[204:207], v29 offset:22016
    s_add_u32 s39, s39, 1
    buffer_load_dwordx4 v[52:55], v25, s[40:43], s33 offen offset:256 sc1
    v_mfma_f32_16x16x32_bf16 v[120:123], v[240:243], v[72:75], v[120:123]
    ds_read_b128 v[208:211], v29 offset:22528
    v_mfma_f32_16x16x32_bf16 v[140:143], v[240:243], v[76:79], v[140:143]
    s_cmp_eq_u32 s39, 12
    s_cselect_b32 s39, 0, s39
    buffer_load_dwordx4 v[56:59], v25, s[40:43], s33 offen offset:2048 sc1
    v_mfma_f32_16x16x32_bf16 v[124:127], v[244:247], v[72:75], v[124:127]
    v_mfma_f32_16x16x32_bf16 v[144:147], v[244:247], v[76:79], v[144:147]
    buffer_load_dwordx4 v[60:63], v25, s[40:43], s33 offen offset:2304 sc1
    v_mfma_f32_16x16x32_bf16 v[128:131], v[248:251], v[72:75], v[128:131]
    v_mfma_f32_16x16x32_bf16 v[148:151], v[248:251], v[76:79], v[148:151]
    s_waitcnt vmcnt(20) lgkmcnt(0)
    v_mfma_f32_16x16x32_bf16 v[112:115], v[192:195], v[80:83], v[112:115]
    ds_read_b128 v[212:215], v29 offset:25600
    v_mfma_f32_16x16x32_bf16 v[132:135], v[192:195], v[84:87], v[132:135]
    ds_read_b128 v[216:219], v29 offset:26112
    s_lshl_b32 s33, s39, 13
    buffer_load_dwordx4 v[64:67], v25, s[40:43], s33 offen offset:0 sc1
    v_mfma_f32_16x16x32_bf16 v[116:119], v[196:199], v[80:83], v[116:119]
    ds_read_b128 v[220:223], v29 offset:26624
    v_mfma_f32_16x16x32_bf16 v[136:139], v[196:199], v[84:87], v[136:139]
    ds_read_b128 v[224:227], v29 offset:27136
    s_add_u32 s39, s39, 1
    buffer_load_dwordx4 v[68:71], v25, s[40:43], s33 offen offset:256 sc1
    v_mfma_f32_16x16x32_bf16 v[120:123], v[200:203], v[80:83], v[120:123]
    ds_read_b128 v[228:231], v29 offset:27648
    v_mfma_f32_16x16x32_bf16 v[140:143], v[200:203], v[84:87], v[140:143]
    s_cmp_eq_u32 s39, 12
    s_cselect_b32 s39, 0, s39
    buffer_load_dwordx4 v[72:75], v25, s[40:43], s33 offen offset:2048 sc1
    v_mfma_f32_16x16x32_bf16 v[124:127], v[204:207], v[80:83], v[124:127]
    v_mfma_f32_16x16x32_bf16 v[144:147], v[204:207], v[84:87], v[144:147]
    buffer_load_dwordx4 v[76:79], v25, s[40:43], s33 offen offset:2304 sc1
    v_mfma_f32_16x16x32_bf16 v[128:131], v[208:211], v[80:83], v[128:131]
    v_mfma_f32_16x16x32_bf16 v[148:151], v[208:211], v[84:87], v[148:151]
    s_waitcnt vmcnt(8) lgkmcnt(0)
    s_barrier
    v_mfma_f32_16x16x32_bf16 v[112:115], v[212:215], v[88:91], v[112:115]
    ds_read_b128 v[232:235], v28 offset:0
    v_mfma_f32_16x16x32_bf16 v[132:135], v[212:215], v[92:95], v[132:135]
    ds_read_b128 v[236:239], v28 offset:512
    s_add_u32 m0, s54, 40960
    s_mul_i32 s56, s55, 20480
    buffer_load_dwordx4 v21, s[48:51], s56 offen sc1 lds
    v_mfma_f32_16x16x32_bf16 v[116:119], v[216:219], v[88:91], v[116:119]
    ds_read_b128 v[240:243], v28 offset:1024
    v_mfma_f32_16x16x32_bf16 v[136:139], v[216:219], v[92:95], v[136:139]
    ds_read_b128 v[244:247], v28 offset:1536
    buffer_load_dwordx4 v21, s[48:51], s56 offen offset:1024 sc1 lds
    v_mfma_f32_16x16x32_bf16 v[120:123], v[220:223], v[88:91], v[120:123]
    ds_read_b128 v[248:251], v28 offset:2048
    v_mfma_f32_16x16x32_bf16 v[140:143], v[220:223], v[92:95], v[140:143]
    buffer_load_dwordx4 v21, s[48:51], s56 offen offset:2048 sc1 lds
    v_mfma_f32_16x16x32_bf16 v[124:127], v[224:227], v[88:91], v[124:127]
    v_mfma_f32_16x16x32_bf16 v[144:147], v[224:227], v[92:95], v[144:147]
    buffer_load_dwordx4 v21, s[48:51], s56 offen offset:3072 sc1 lds
    v_mfma_f32_16x16x32_bf16 v[128:131], v[228:231], v[88:91], v[128:131]
    v_mfma_f32_16x16x32_bf16 v[148:151], v[228:231], v[92:95], v[148:151]
    s_add_u32 m0, s54, 45056
    s_add_u32 s55, s55, 1
    s_cmp_eq_u32 s55, 12
    s_cselect_b32 s55, 0, s55
    buffer_load_dwordx4 v1, s[48:51], s56 offen sc1 lds
    s_waitcnt vmcnt(23) lgkmcnt(0)
    v_mfma_f32_16x16x32_bf16 v[112:115], v[232:235], v[32:35], v[112:115]
    ds_read_b128 v[192:195], v28 offset:5120
    v_mfma_f32_16x16x32_bf16 v[132:135], v[232:235], v[36:39], v[132:135]
    ds_read_b128 v[196:199], v28 offset:5632
    s_add_u32 m0, s54, 61440
    s_mul_i32 s56, s55, 20480
    buffer_load_dwordx4 v21, s[48:51], s56 offen sc1 lds
    v_mfma_f32_16x16x32_bf16 v[116:119], v[236:239], v[32:35], v[116:119]
    ds_read_b128 v[200:203], v28 offset:6144
    v_mfma_f32_16x16x32_bf16 v[136:139], v[236:239], v[36:39], v[136:139]
    ds_read_b128 v[204:207], v28 offset:6656
    buffer_load_dwordx4 v21, s[48:51], s56 offen offset:1024 sc1 lds
    v_mfma_f32_16x16x32_bf16 v[120:123], v[240:243], v[32:35], v[120:123]
    ds_read_b128 v[208:211], v28 offset:7168
    v_mfma_f32_16x16x32_bf16 v[140:143], v[240:243], v[36:39], v[140:143]
    buffer_load_dwordx4 v21, s[48:51], s56 offen offset:2048 sc1 lds
    v_mfma_f32_16x16x32_bf16 v[124:127], v[244:247], v[32:35], v[124:127]
    v_mfma_f32_16x16x32_bf16 v[144:147], v[244:247], v[36:39], v[144:147]
    buffer_load_dwordx4 v21, s[48:51], s56 offen offset:3072 sc1 lds
    v_mfma_f32_16x16x32_bf16 v[128:131], v[248:251], v[32:35], v[128:131]
    v_mfma_f32_16x16x32_bf16 v[148:151], v[248:251], v[36:39], v[148:151]
    s_add_u32 m0, s54, 65536
    s_add_u32 s55, s55, 1
    s_cmp_eq_u32 s55, 12
    s_cselect_b32 s55, 0, s55
    buffer_load_dwordx4 v1, s[48:51], s56 offen sc1 lds
    s_waitcnt lgkmcnt(0)
    v_mfma_f32_16x16x32_bf16 v[112:115], v[192:195], v[40:43], v[112:115]
    ds_read_b128 v[212:215], v28 offset:20480
    v_mfma_f32_16x16x32_bf16 v[132:135], v[192:195], v[44:47], v[132:135]
    ds_read_b128 v[216:219], v28 offset:20992
    s_lshl_b32 s33, s39, 13
    buffer_load_dwordx4 v[80:83], v25, s[40:43], s33 offen offset:0 sc1
    v_mfma_f32_16x16x32_bf16 v[116:119], v[196:199], v[40:43], v[116:119]
    ds_read_b128 v[220:223], v28 offset:21504
    v_mfma_f32_16x16x32_bf16 v[136:139], v[196:199], v[44:47], v[136:139]
    ds_read_b128 v[224:227], v28 offset:22016
    s_add_u32 s39, s39, 1
    buffer_load_dwordx4 v[84:87], v25, s[40:43], s33 offen offset:256 sc1
    v_mfma_f32_16x16x32_bf16 v[120:123], v[200:203], v[40:43], v[120:123]
    ds_read_b128 v[228:231], v28 offset:22528
    v_mfma_f32_16x16x32_bf16 v[140:143], v[200:203], v[44:47], v[140:143]
    s_cmp_eq_u32 s39, 12
    s_cselect_b32 s39, 0, s39
    buffer_load_dwordx4 v[88:91], v25, s[40:43], s33 offen offset:2048 sc1
    v_mfma_f32_16x16x32_bf16 v[124:127], v[204:207], v[40:43], v[124:127]
    v_mfma_f32_16x16x32_bf16 v[144:147], v[204:207], v[44:47], v[144:147]
    buffer_load_dwordx4 v[92:95], v25, s[40:43], s33 offen offset:2304 sc1
    v_mfma_f32_16x16x32_bf16 v[128:131], v[208:211], v[40:43], v[128:131]
    v_mfma_f32_16x16x32_bf16 v[148:151], v[208:211], v[44:47], v[148:151]
    s_waitcnt vmcnt(18) lgkmcnt(0)
    v_mfma_f32_16x16x32_bf16 v[112:115], v[212:215], v[48:51], v[112:115]
    ds_read_b128 v[232:235], v28 offset:25600
    v_mfma_f32_16x16x32_bf16 v[132:135], v[212:215], v[52:55], v[132:135]
    ds_read_b128 v[236:239], v28 offset:26112
    s_lshl_b32 s33, s39, 13
    buffer_load_dwordx4 v[32:35], v25, s[40:43], s33 offen offset:0 sc1
    v_mfma_f32_16x16x32_bf16 v[116:119], v[216:219], v[48:51], v[116:119]
    ds_read_b128 v[240:243], v28 offset:26624
    v_mfma_f32_16x16x32_bf16 v[136:139], v[216:219], v[52:55], v[136:139]
    ds_read_b128 v[244:247], v28 offset:27136
    s_add_u32 s39, s39, 1
    buffer_load_dwordx4 v[36:39], v25, s[40:43], s33 offen offset:256 sc1
    v_mfma_f32_16x16x32_bf16 v[120:123], v[220:223], v[48:51], v[120:123]
    ds_read_b128 v[248:251], v28 offset:27648
    v_mfma_f32_16x16x32_bf16 v[140:143], v[220:223], v[52:55], v[140:143]
    s_cmp_eq_u32 s39, 12
    s_cselect_b32 s39, 0, s39
    buffer_load_dwordx4 v[40:43], v25, s[40:43], s33 offen offset:2048 sc1
    v_mfma_f32_16x16x32_bf16 v[124:127], v[224:227], v[48:51], v[124:127]
    v_mfma_f32_16x16x32_bf16 v[144:147], v[224:227], v[52:55], v[144:147]
    buffer_load_dwordx4 v[44:47], v25, s[40:43], s33 offen offset:2304 sc1
    v_mfma_f32_16x16x32_bf16 v[128:131], v[228:231], v[48:51], v[128:131]
    v_mfma_f32_16x16x32_bf16 v[148:151], v[228:231], v[52:55], v[148:151]
    s_waitcnt vmcnt(8) lgkmcnt(0)
    s_barrier
    v_mfma_f32_16x16x32_bf16 v[112:115], v[232:235], v[56:59], v[112:115]
    ds_read_b128 v[192:195], v29 offset:0
    v_mfma_f32_16x16x32_bf16 v[132:135], v[232:235], v[60:63], v[132:135]
    ds_read_b128 v[196:199], v29 offset:512
    s_add_u32 m0, s54, 0
    s_mul_i32 s56, s55, 20480
    buffer_load_dwordx4 v21, s[48:51], s56 offen sc1 lds
    v_mfma_f32_16x16x32_bf16 v[116:119], v[236:239], v[56:59], v[116:119]
    ds_read_b128 v[200:203], v29 offset:1024
    v_mfma_f32_16x16x32_bf16 v[136:139], v[236:239], v[60:63], v[136:139]
    ds_read_b128 v[204:207], v29 offset:1536
    buffer_load_dwordx4 v21, s[48:51], s56 offen offset:1024 sc1 lds
    v_mfma_f32_16x16x32_bf16 v[120:123], v[240:243], v[56:59], v[120:123]
    ds_read_b128 v[208:211], v29 offset:2048
    v_mfma_f32_16x16x32_bf16 v[140:143], v[240:243], v[60:63], v[140:143]
    buffer_load_dwordx4 v21, s[48:51], s56 offen offset:2048 sc1 lds
    v_mfma_f32_16x16x32_bf16 v[124:127], v[244:247], v[56:59], v[124:127]
    v_mfma_f32_16x16x32_bf16 v[144:147], v[244:247], v[60:63], v[144:147]
    buffer_load_dwordx4 v21, s[48:51], s56 offen offset:3072 sc1 lds
    v_mfma_f32_16x16x32_bf16 v[128:131], v[248:251], v[56:59], v[128:131]
    v_mfma_f32_16x16x32_bf16 v[148:151], v[248:251], v[60:63], v[148:151]
    s_add_u32 m0, s54, 4096
    s_add_u32 s55, s55, 1
    s_cmp_eq_u32 s55, 12
    s_cselect_b32 s55, 0, s55
    buffer_load_dwordx4 v1, s[48:51], s56 offen sc1 lds
    s_waitcnt vmcnt(23) lgkmcnt(0)
    v_mfma_f32_16x16x32_bf16 v[112:115], v[192:195], v[64:67], v[112:115]
    ds_read_b128 v[212:215], v29 offset:5120
    v_mfma_f32_16x16x32_bf16 v[132:135], v[192:195], v[68:71], v[132:135]
    ds_read_b128 v[216:219], v29 offset:5632
    s_add_u32 m0, s54, 20480
    s_mul_i32 s56, s55, 20480
    buffer_load_dwordx4 v21, s[48:51], s56 offen sc1 lds
    v_mfma_f32_16x16x32_bf16 v[116:119], v[196:199], v[64:67], v[116:119]
    ds_read_b128 v[220:223], v29 offset:6144
    v_mfma_f32_16x16x32_bf16 v[136:139], v[196:199], v[68:71], v[136:139]
    ds_read_b128 v[224:227], v29 offset:6656
    buffer_load_dwordx4 v21, s[48:51], s56 offen offset:1024 sc1 lds
    v_mfma_f32_16x16x32_bf16 v[120:123], v[200:203], v[64:67], v[120:123]
    ds_read_b128 v[228:231], v29 offset:7168
    v_mfma_f32_16x16x32_bf16 v[140:143], v[200:203], v[68:71], v[140:143]
    buffer_load_dwordx4 v21, s[48:51], s56 offen offset:2048 sc1 lds
    v_mfma_f32_16x16x32_bf16 v[124:127], v[204:207], v[64:67], v[124:127]
    v_mfma_f32_16x16x32_bf16 v[144:147], v[204:207], v[68:71], v[144:147]
    buffer_load_dwordx4 v21, s[48:51], s56 offen offset:3072 sc1 lds
    v_mfma_f32_16x16x32_bf16 v[128:131], v[208:211], v[64:67], v[128:131]
    v_mfma_f32_16x16x32_bf16 v[148:151], v[208:211], v[68:71], v[148:151]
    s_add_u32 m0, s54, 24576
    s_add_u32 s55, s55, 1
    s_cmp_eq_u32 s55, 12
    s_cselect_b32 s55, 0, s55
    buffer_load_dwordx4 v1, s[48:51], s56 offen sc1 lds
    s_waitcnt lgkmcnt(0)
    v_mfma_f32_16x16x32_bf16 v[112:115], v[212:215], v[72:75], v[112:115]
    ds_read_b128 v[232:235], v29 offset:20480
    v_mfma_f32_16x16x32_bf16 v[132:135], v[212:215], v[76:79], v[132:135]
    ds_read_b128 v[236:239], v29 offset:20992
    s_lshl_b32 s33, s39, 13
    buffer_load_dwordx4 v[48:51], v25, s[40:43], s33 offen offset:0 sc1
    v_mfma_f32_16x16x32_bf16 v[116:119], v[216:219], v[72:75], v[116:119]
    ds_read_b128 v[240:243], v29 offset:21504
    v_mfma_f32_16x16x32_bf16 v[136:139], v[216:219], v[76:79], v[136:139]
    ds_read_b128 v[244:247], v29 offset:22016
    s_add_u32 s39, s39, 1
    buffer_load_dwordx4 v[52:55], v25, s[40:43], s33 offen offset:256 sc1
    v_mfma_f32_16x16x32_bf16 v[120:123], v[220:223], v[72:75], v[120:123]
    ds_read_b128 v[248:251], v29 offset:22528
    v_mfma_f32_16x16x32_bf16 v[140:143], v[220:223], v[76:79], v[140:143]
    s_cmp_eq_u32 s39, 12
    s_cselect_b32 s39, 0, s39
    buffer_load_dwordx4 v[56:59], v25, s[40:43], s33 offen offset:2048 sc1
    v_mfma_f32_16x16x32_bf16 v[124:127], v[224:227], v[72:75], v[124:127]
    v_mfma_f32_16x16x32_bf16 v[144:147], v[224:227], v[76:79], v[144:147]
    buffer_load_dwordx4 v[60:63], v25, s[40:43], s33 offen offset:2304 sc1
    v_mfma_f32_16x16x32_bf16 v[128:131], v[228:231], v[72:75], v[128:131]
    v_mfma_f32_16x16x32_bf16 v[148:151], v[228:231], v[76:79], v[148:151]
    s_waitcnt vmcnt(18) lgkmcnt(0)
    v_mfma_f32_16x16x32_bf16 v[112:115], v[232:235], v[80:83], v[112:115]
    ds_read_b128 v[192:195], v29 offset:25600
    v_mfma_f32_16x16x32_bf16 v[132:135], v[232:235], v[84:87], v[132:135]
    ds_read_b128 v[196:199], v29 offset:26112
    s_lshl_b32 s33, s39, 13
    buffer_load_dwordx4 v[64:67], v25, s[40:43], s33 offen offset:0 sc1
    v_mfma_f32_16x16x32_bf16 v[116:119], v[236:239], v[80:83], v[116:119]
    ds_read_b128 v[200:203], v29 offset:26624
    v_mfma_f32_16x16x32_bf16 v[136:139], v[236:239], v[84:87], v[136:139]
    ds_read_b128 v[204:207], v29 offset:27136
    s_add_u32 s39, s39, 1
    buffer_load_dwordx4 v[68:71], v25, s[40:43], s33 offen offset:256 sc1
    v_mfma_f32_16x16x32_bf16 v[120:123], v[240:243], v[80:83], v[120:123]
    ds_read_b128 v[208:211], v29 offset:27648
    v_mfma_f32_16x16x32_bf16 v[140:143], v[240:243], v[84:87], v[140:143]
    s_cmp_eq_u32 s39, 12
    s_cselect_b32 s39, 0, s39
    buffer_load_dwordx4 v[72:75], v25, s[40:43], s33 offen offset:2048 sc1
    v_mfma_f32_16x16x32_bf16 v[124:127], v[244:247], v[80:83], v[124:127]
    v_mfma_f32_16x16x32_bf16 v[144:147], v[244:247], v[84:87], v[144:147]
    buffer_load_dwordx4 v[76:79], v25, s[40:43], s33 offen offset:2304 sc1
    v_mfma_f32_16x16x32_bf16 v[128:131], v[248:251], v[80:83], v[128:131]
    v_mfma_f32_16x16x32_bf16 v[148:151], v[248:251], v[84:87], v[148:151]
    s_waitcnt vmcnt(8) lgkmcnt(0)
    s_barrier
    v_mfma_f32_16x16x32_bf16 v[112:115], v[192:195], v[88:91], v[112:115]
    ds_read_b128 v[212:215], v28 offset:0
    v_mfma_f32_16x16x32_bf16 v[132:135], v[192:195], v[92:95], v[132:135]
    ds_read_b128 v[216:219], v28 offset:512
    s_add_u32 m0, s54, 40960
    s_mul_i32 s56, s55, 20480
    buffer_load_dwordx4 v21, s[48:51], s56 offen sc1 lds
    v_mfma_f32_16x16x32_bf16 v[116:119], v[196:199], v[88:91], v[116:119]
    ds_read_b128 v[220:223], v28 offset:1024
    v_mfma_f32_16x16x32_bf16 v[136:139], v[196:199], v[92:95], v[136:139]
    ds_read_b128 v[224:227], v28 offset:1536
    buffer_load_dwordx4 v21, s[48:51], s56 offen offset:1024 sc1 lds
    v_mfma_f32_16x16x32_bf16 v[120:123], v[200:203], v[88:91], v[120:123]
    ds_read_b128 v[228:231], v28 offset:2048
    v_mfma_f32_16x16x32_bf16 v[140:143], v[200:203], v[92:95], v[140:143]
    buffer_load_dwordx4 v21, s[48:51], s56 offen offset:2048 sc1 lds
    v_mfma_f32_16x16x32_bf16 v[124:127], v[204:207], v[88:91], v[124:127]
    v_mfma_f32_16x16x32_bf16 v[144:147], v[204:207], v[92:95], v[144:147]
    buffer_load_dwordx4 v21, s[48:51], s56 offen offset:3072 sc1 lds
    v_mfma_f32_16x16x32_bf16 v[128:131], v[208:211], v[88:91], v[128:131]
    v_mfma_f32_16x16x32_bf16 v[148:151], v[208:211], v[92:95], v[148:151]
    s_add_u32 m0, s54, 45056
    s_add_u32 s55, s55, 1
    s_cmp_eq_u32 s55, 12
    s_cselect_b32 s55, 0, s55
    buffer_load_dwordx4 v1, s[48:51], s56 offen sc1 lds
    s_waitcnt vmcnt(23) lgkmcnt(0)
    v_mfma_f32_16x16x32_bf16 v[112:115], v[212:215], v[32:35], v[112:115]
    ds_read_b128 v[232:235], v28 offset:5120
    v_mfma_f32_16x16x32_bf16 v[132:135], v[212:215], v[36:39], v[132:135]
    ds_read_b128 v[236:239], v28 offset:5632
    s_add_u32 m0, s54, 61440
    s_mul_i32 s56, s55, 20480
    buffer_load_dwordx4 v21, s[48:51], s56 offen sc1 lds
    v_mfma_f32_16x16x32_bf16 v[116:119], v[216:219], v[32:35], v[116:119]
    ds_read_b128 v[240:243], v28 offset:6144
    v_mfma_f32_16x16x32_bf16 v[136:139], v[216:219], v[36:39], v[136:139]
    ds_read_b128 v[244:247], v28 offset:6656
    buffer_load_dwordx4 v21, s[48:51], s56 offen offset:1024 sc1 lds
    v_mfma_f32_16x16x32_bf16 v[120:123], v[220:223], v[32:35], v[120:123]
    ds_read_b128 v[248:251], v28 offset:7168
    v_mfma_f32_16x16x32_bf16 v[140:143], v[220:223], v[36:39], v[140:143]
    buffer_load_dwordx4 v21, s[48:51], s56 offen offset:2048 sc1 lds
    v_mfma_f32_16x16x32_bf16 v[124:127], v[224:227], v[32:35], v[124:127]
    v_mfma_f32_16x16x32_bf16 v[144:147], v[224:227], v[36:39], v[144:147]
    buffer_load_dwordx4 v21, s[48:51], s56 offen offset:3072 sc1 lds
    v_mfma_f32_16x16x32_bf16 v[128:131], v[228:231], v[32:35], v[128:131]
    v_mfma_f32_16x16x32_bf16 v[148:151], v[228:231], v[36:39], v[148:151]
    s_add_u32 m0, s54, 65536
    s_add_u32 s55, s55, 1
    s_cmp_eq_u32 s55, 12
    s_cselect_b32 s55, 0, s55
    buffer_load_dwordx4 v1, s[48:51], s56 offen sc1 lds
    s_waitcnt lgkmcnt(0)
    v_mfma_f32_16x16x32_bf16 v[112:115], v[232:235], v[40:43], v[112:115]
    ds_read_b128 v[192:195], v28 offset:20480
    v_mfma_f32_16x16x32_bf16 v[132:135], v[232:235], v[44:47], v[132:135]
    ds_read_b128 v[196:199], v28 offset:20992
    s_lshl_b32 s33, s39, 13
    buffer_load_dwordx4 v[80:83], v25, s[40:43], s33 offen offset:0 sc1
    v_mfma_f32_16x16x32_bf16 v[116:119], v[236:239], v[40:43], v[116:119]
    ds_read_b128 v[200:203], v28 offset:21504
    v_mfma_f32_16x16x32_bf16 v[136:139], v[236:239], v[44:47], v[136:139]
    ds_read_b128 v[204:207], v28 offset:22016
    s_add_u32 s39, s39, 1
    buffer_load_dwordx4 v[84:87], v25, s[40:43], s33 offen offset:256 sc1
    v_mfma_f32_16x16x32_bf16 v[120:123], v[240:243], v[40:43], v[120:123]
    ds_read_b128 v[208:211], v28 offset:22528
    v_mfma_f32_16x16x32_bf16 v[140:143], v[240:243], v[44:47], v[140:143]
    s_cmp_eq_u32 s39, 12
    s_cselect_b32 s39, 0, s39
    buffer_load_dwordx4 v[88:91], v25, s[40:43], s33 offen offset:2048 sc1
    v_mfma_f32_16x16x32_bf16 v[124:127], v[244:247], v[40:43], v[124:127]
    v_mfma_f32_16x16x32_bf16 v[144:147], v[244:247], v[44:47], v[144:147]
    buffer_load_dwordx4 v[92:95], v25, s[40:43], s33 offen offset:2304 sc1
    v_mfma_f32_16x16x32_bf16 v[128:131], v[248:251], v[40:43], v[128:131]
    v_mfma_f32_16x16x32_bf16 v[148:151], v[248:251], v[44:47], v[148:151]
    s_and_b32 s32, s25, 3
    s_mul_i32 s32, s32, 15360
    s_add_u32 s32, s32, 286720
    s_mul_i32 s34, s28, 1280
    s_sub_u32 s32, s32, s34
    buffer_load_dwordx4 v[252:255], v21, s[48:51], s32 offen offset:0 sc1
    s_waitcnt vmcnt(19) lgkmcnt(0)
    v_mfma_f32_16x16x32_bf16 v[112:115], v[192:195], v[48:51], v[112:115]
    ds_read_b128 v[212:215], v28 offset:25600
    v_mfma_f32_16x16x32_bf16 v[132:135], v[192:195], v[52:55], v[132:135]
    ds_read_b128 v[216:219], v28 offset:26112
    buffer_load_dwordx4 v[252:255], v21, s[48:51], s32 offen offset:1024 sc1
    v_mfma_f32_16x16x32_bf16 v[116:119], v[196:199], v[48:51], v[116:119]
    ds_read_b128 v[220:223], v28 offset:26624
    v_mfma_f32_16x16x32_bf16 v[136:139], v[196:199], v[52:55], v[136:139]
    ds_read_b128 v[224:227], v28 offset:27136
    buffer_load_dwordx4 v[252:255], v21, s[48:51], s32 offen offset:2048 sc1
    v_mfma_f32_16x16x32_bf16 v[120:123], v[200:203], v[48:51], v[120:123]
    ds_read_b128 v[228:231], v28 offset:27648
    v_mfma_f32_16x16x32_bf16 v[140:143], v[200:203], v[52:55], v[140:143]
    buffer_load_dwordx4 v[252:255], v21, s[48:51], s32 offen offset:3072 sc1
    v_mfma_f32_16x16x32_bf16 v[124:127], v[204:207], v[48:51], v[124:127]
    v_mfma_f32_16x16x32_bf16 v[144:147], v[204:207], v[52:55], v[144:147]
    v_mfma_f32_16x16x32_bf16 v[128:131], v[208:211], v[48:51], v[128:131]
    v_mfma_f32_16x16x32_bf16 v[148:151], v[208:211], v[52:55], v[148:151]
    s_waitcnt vmcnt(8) lgkmcnt(0)
    s_barrier
    v_mfma_f32_16x16x32_bf16 v[112:115], v[212:215], v[56:59], v[112:115]
    ds_read_b128 v[232:235], v29 offset:0
    v_mfma_f32_16x16x32_bf16 v[132:135], v[212:215], v[60:63], v[132:135]
    ds_read_b128 v[236:239], v29 offset:512
    s_add_u32 m0, s54, 0
    s_mov_b32 s56, 245760
    buffer_load_dwordx4 v21, s[48:51], s56 offen sc1 lds
    v_mfma_f32_16x16x32_bf16 v[116:119], v[216:219], v[56:59], v[116:119]
    ds_read_b128 v[240:243], v29 offset:1024
    v_mfma_f32_16x16x32_bf16 v[136:139], v[216:219], v[60:63], v[136:139]
    ds_read_b128 v[244:247], v29 offset:1536
    buffer_load_dwordx4 v21, s[48:51], s56 offen offset:1024 sc1 lds
    v_mfma_f32_16x16x32_bf16 v[120:123], v[220:223], v[56:59], v[120:123]
    ds_read_b128 v[248:251], v29 offset:2048
    v_mfma_f32_16x16x32_bf16 v[140:143], v[220:223], v[60:63], v[140:143]
    buffer_load_dwordx4 v21, s[48:51], s56 offen offset:2048 sc1 lds
    v_mfma_f32_16x16x32_bf16 v[124:127], v[224:227], v[56:59], v[124:127]
    v_mfma_f32_16x16x32_bf16 v[144:147], v[224:227], v[60:63], v[144:147]
    buffer_load_dwordx4 v21, s[48:51], s56 offen offset:3072 sc1 lds
    v_mfma_f32_16x16x32_bf16 v[128:131], v[228:231], v[56:59], v[128:131]
    v_mfma_f32_16x16x32_bf16 v[148:151], v[228:231], v[60:63], v[148:151]
    s_add_u32 m0, s54, 4096
    s_nop 0
    buffer_load_dwordx4 v1, s[48:51], s56 offen sc1 lds
    s_waitcnt vmcnt(23) lgkmcnt(0)
    v_mfma_f32_16x16x32_bf16 v[112:115], v[232:235], v[64:67], v[112:115]
    ds_read_b128 v[192:195], v29 offset:5120
    v_mfma_f32_16x16x32_bf16 v[132:135], v[232:235], v[68:71], v[132:135]
    ds_read_b128 v[196:199], v29 offset:5632
    s_add_u32 m0, s54, 20480
    s_mov_b32 s56, 266240
    buffer_load_dwordx4 v21, s[48:51], s56 offen sc1 lds
    v_mfma_f32_16x16x32_bf16 v[116:119], v[236:239], v[64:67], v[116:119]
    ds_read_b128 v[200:203], v29 offset:6144
    v_mfma_f32_16x16x32_bf16 v[136:139], v[236:239], v[68:71], v[136:139]
    ds_read_b128 v[204:207], v29 offset:6656
    buffer_load_dwordx4 v21, s[48:51], s56 offen offset:1024 sc1 lds
    v_mfma_f32_16x16x32_bf16 v[120:123], v[240:243], v[64:67], v[120:123]
    ds_read_b128 v[208:211], v29 offset:7168
    v_mfma_f32_16x16x32_bf16 v[140:143], v[240:243], v[68:71], v[140:143]
    buffer_load_dwordx4 v21, s[48:51], s56 offen offset:2048 sc1 lds
    v_mfma_f32_16x16x32_bf16 v[124:127], v[244:247], v[64:67], v[124:127]
    v_mfma_f32_16x16x32_bf16 v[144:147], v[244:247], v[68:71], v[144:147]
    buffer_load_dwordx4 v21, s[48:51], s56 offen offset:3072 sc1 lds
    v_mfma_f32_16x16x32_bf16 v[128:131], v[248:251], v[64:67], v[128:131]
    v_mfma_f32_16x16x32_bf16 v[148:151], v[248:251], v[68:71], v[148:151]
    s_add_u32 m0, s54, 24576
    s_nop 0
    buffer_load_dwordx4 v1, s[48:51], s56 offen sc1 lds
    s_waitcnt lgkmcnt(0)
    v_mfma_f32_16x16x32_bf16 v[112:115], v[192:195], v[72:75], v[112:115]
    ds_read_b128 v[212:215], v29 offset:20480
    v_mfma_f32_16x16x32_bf16 v[132:135], v[192:195], v[76:79], v[132:135]
    ds_read_b128 v[216:219], v29 offset:20992
    v_mfma_f32_16x16x32_bf16 v[116:119], v[196:199], v[72:75], v[116:119]
    ds_read_b128 v[220:223], v29 offset:21504
    v_mfma_f32_16x16x32_bf16 v[136:139], v[196:199], v[76:79], v[136:139]
    ds_read_b128 v[224:227], v29 offset:22016
    v_mfma_f32_16x16x32_bf16 v[120:123], v[200:203], v[72:75], v[120:123]
    ds_read_b128 v[228:231], v29 offset:22528
    v_mfma_f32_16x16x32_bf16 v[140:143], v[200:203], v[76:79], v[140:143]
    v_mfma_f32_16x16x32_bf16 v[124:127], v[204:207], v[72:75], v[124:127]
    v_mfma_f32_16x16x32_bf16 v[144:147], v[204:207], v[76:79], v[144:147]
    v_mfma_f32_16x16x32_bf16 v[128:131], v[208:211], v[72:75], v[128:131]
    v_mfma_f32_16x16x32_bf16 v[148:151], v[208:211], v[76:79], v[148:151]
    s_waitcnt vmcnt(14) lgkmcnt(0)
    v_mfma_f32_16x16x32_bf16 v[112:115], v[212:215], v[80:83], v[112:115]
    ds_read_b128 v[232:235], v29 offset:25600
    v_mfma_f32_16x16x32_bf16 v[132:135], v[212:215], v[84:87], v[132:135]
    ds_read_b128 v[236:239], v29 offset:26112
    v_mfma_f32_16x16x32_bf16 v[116:119], v[216:219], v[80:83], v[116:119]
    ds_read_b128 v[240:243], v29 offset:26624
    v_mfma_f32_16x16x32_bf16 v[136:139], v[216:219], v[84:87], v[136:139]
    ds_read_b128 v[244:247], v29 offset:27136
    v_mfma_f32_16x16x32_bf16 v[120:123], v[220:223], v[80:83], v[120:123]
    ds_read_b128 v[248:251], v29 offset:27648
    v_mfma_f32_16x16x32_bf16 v[140:143], v[220:223], v[84:87], v[140:143]
    v_mfma_f32_16x16x32_bf16 v[124:127], v[224:227], v[80:83], v[124:127]
    v_mfma_f32_16x16x32_bf16 v[144:147], v[224:227], v[84:87], v[144:147]
    v_mfma_f32_16x16x32_bf16 v[128:131], v[228:231], v[80:83], v[128:131]
    v_mfma_f32_16x16x32_bf16 v[148:151], v[228:231], v[84:87], v[148:151]
    s_waitcnt vmcnt(0) lgkmcnt(0)
    s_barrier
    s_sub_u32 s57, s57, 0x2000
    s_add_u32 s100, s60, s57
    s_addc_u32 s101, s61, 0
    s_load_dword s52, s[100:101], 0x4000 glc
    s_load_dword s34, s[100:101], 0 glc
    v_mfma_f32_16x16x32_bf16 v[112:115], v[232:235], v[88:91], v[112:115]
    ds_read_b128 v[192:195], v26 offset:0
    s_add_u32 m0, s54, 40960
    s_mov_b32 s56, 286720
    buffer_load_dwordx4 v21, s[48:51], s56 offen sc1 lds
    v_mfma_f32_16x16x32_bf16 v[132:135], v[232:235], v[92:95], v[132:135]
    ds_read_b128 v[196:199], v26 offset:512
    buffer_load_dwordx4 v21, s[48:51], s56 offen offset:1024 sc1 lds
    v_mfma_f32_16x16x32_bf16 v[116:119], v[236:239], v[88:91], v[116:119]
    ds_read_b128 v[200:203], v26 offset:1024
    buffer_load_dwordx4 v21, s[48:51], s56 offen offset:2048 sc1 lds
    v_mfma_f32_16x16x32_bf16 v[136:139], v[236:239], v[92:95], v[136:139]
    ds_read_b128 v[204:207], v26 offset:1536
    buffer_load_dwordx4 v21, s[48:51], s56 offen offset:3072 sc1 lds
    v_mfma_f32_16x16x32_bf16 v[120:123], v[240:243], v[88:91], v[120:123]
    ds_read_b128 v[208:211], v26 offset:2048
    s_add_u32 m0, s54, 45056
    s_nop 0
    buffer_load_dwordx4 v1, s[48:51], s56 offen sc1 lds
    v_mfma_f32_16x16x32_bf16 v[140:143], v[240:243], v[92:95], v[140:143]
    ds_read_b128 v[212:215], v26 offset:10240
    s_add_u32 m0, s54, 61440
    s_mov_b32 s56, 307200
    buffer_load_dwordx4 v21, s[48:51], s56 offen sc1 lds
    v_mfma_f32_16x16x32_bf16 v[124:127], v[244:247], v[88:91], v[124:127]
    ds_read_b128 v[216:219], v26 offset:10752
    buffer_load_dwordx4 v21, s[48:51], s56 offen offset:1024 sc1 lds
    v_mfma_f32_16x16x32_bf16 v[144:147], v[244:247], v[92:95], v[144:147]
    ds_read_b128 v[220:223], v26 offset:11264
    buffer_load_dwordx4 v21, s[48:51], s56 offen offset:2048 sc1 lds
    v_mfma_f32_16x16x32_bf16 v[128:131], v[248:251], v[88:91], v[128:131]
    ds_read_b128 v[224:227], v26 offset:11776
    buffer_load_dwordx4 v21, s[48:51], s56 offen offset:3072 sc1 lds
    v_mfma_f32_16x16x32_bf16 v[148:151], v[248:251], v[92:95], v[148:151]
    ds_read_b128 v[228:231], v26 offset:12288
    s_add_u32 m0, s54, 65536
    s_nop 0
    buffer_load_dwordx4 v1, s[48:51], s56 offen sc1 lds
    s_setprio 3
    s_lshl_b32 s30, s26, 1
    s_add_u32 s30, s30, s35
    s_mul_i32 s32, s30, 40960
    v_add_u32 v25, s32, v18
    s_add_u32 s53, s53, s36
    s_cmp_ge_u32 s53, 10
    s_cselect_b32 s32, 10, 0
    s_sub_u32 s53, s53, s32
    s_add_u32 s12, s10, 0x1100000
    s_addc_u32 s13, s11, 0
    s_mov_b32 s14, 0x280000
    s_mov_b32 s15, 0x00020000
    s_waitcnt lgkmcnt(0)
    s_barrier
    s_add_u32 m0, s54, 0
    s_mov_b32 s56, 327680
    buffer_load_dwordx4 v21, s[48:51], s56 offen sc1 lds
    buffer_load_dwordx4 v21, s[48:51], s56 offen offset:1024 sc1 lds
    buffer_load_dwordx4 v21, s[48:51], s56 offen offset:2048 sc1 lds
    buffer_load_dwordx4 v21, s[48:51], s56 offen offset:3072 sc1 lds
    s_add_u32 m0, s54, 4096
    s_nop 0
    buffer_load_dwordx4 v1, s[48:51], s56 offen sc1 lds
    s_cmp_ge_u32 s52, 2097152
    s_cbranch_scc1 B_early
    v_sub_f32 v12, 1.0, v10
    v_sub_f32 v13, 1.0, v11
    s_mul_i32 s32, s28, 5120
    s_add_u32 s32, s32, 20480
    v_add_u32 v30, s32, v9
    s_xor_b32 s32, s28, 2
    s_mul_i32 s32, s32, 5120
    s_add_u32 s32, s32, 20480
    v_add_u32 v31, s32, v9
    v_mul_u32_u24 v28, 1280, v24
    v_lshl_add_u32 v28, v4, 3, v28
    v_add_u32 v28, s29, v28
    v_mul_f32 v112, v112, v12
    v_mul_f32 v113, v113, v12
    v_mul_f32 v114, v114, v12
    v_mul_f32 v115, v115, v12
    v_mul_f32 v116, v116, v12
    v_mul_f32 v117, v117, v12
    v_mul_f32 v118, v118, v12
    v_mul_f32 v119, v119, v12
    v_mul_f32 v120, v120, v12
    v_mul_f32 v121, v121, v12
    v_mul_f32 v122, v122, v12
    v_mul_f32 v123, v123, v12
    v_mul_f32 v124, v124, v12
    v_mul_f32 v125, v125, v12
    v_mul_f32 v126, v126, v12
    v_mul_f32 v127, v127, v12
    v_mul_f32 v128, v128, v12
    v_mul_f32 v129, v129, v12
    v_mul_f32 v130, v130, v12
    v_mul_f32 v131, v131, v12
    v_mul_f32 v132, v132, v13
    v_mul_f32 v133, v133, v13
    v_mul_f32 v134, v134, v13
    v_mul_f32 v135, v135, v13
    v_mul_f32 v136, v136, v13
    v_mul_f32 v137, v137, v13
    v_mul_f32 v138, v138, v13
    v_mul_f32 v139, v139, v13
    v_mul_f32 v140, v140, v13
    v_mul_f32 v141, v141, v13
    v_mul_f32 v142, v142, v13
    v_mul_f32 v143, v143, v13
    v_mul_f32 v144, v144, v13
    v_mul_f32 v145, v145, v13
    v_mul_f32 v146, v146, v13
    v_mul_f32 v147, v147, v13
    v_mul_f32 v148, v148, v13
    v_mul_f32 v149, v149, v13
    v_mul_f32 v150, v150, v13
    v_mul_f32 v151, v151, v13
    s_mov_b32 s40, s8
    s_mov_b32 s41, s9
    s_mov_b32 s42, 0x280000
    s_mov_b32 s43, 0x00020000
    s_setprio 0
    s_cmp_lg_u32 s28, 0
    s_cbranch_scc1 B_polle_done
    s_add_u32 s98, s60, s57
    s_addc_u32 s99, s61, 0
    s_mov_b32 s59, 0
B_polle:
    s_load_dword s58, s[98:99], 16384 glc
    s_add_u32 s59, s59, 1
    s_waitcnt lgkmcnt(0)
    s_cmp_ge_u32 s58, 2097152
    s_cbranch_scc1 B_polle_done
    s_cmp_gt_u32 s59, 1048576
    s_cbranch_scc1 B_polle_done
    s_sleep 2
    s_branch B_polle
B_polle_done:
    s_barrier
    s_load_dword s34, s[100:101], 0 glc
    s_lshl_b32 s33, s53, 11
    s_add_u32 s53, s53, 2
    s_cmp_ge_u32 s53, 10
    s_cselect_b32 s32, 10, 0
    buffer_load_dwordx4 v[32:35], v25, s[12:15], s33 offen sc1
    s_sub_u32 s53, s53, s32
    buffer_load_dwordx4 v[36:39], v25, s[12:15], s33 offen offset:256 sc1
    s_lshl_b32 s33, s53, 11
    s_add_u32 s53, s53, 2
    s_cmp_ge_u32 s53, 10
    s_cselect_b32 s32, 10, 0
    buffer_load_dwordx4 v[40:43], v25, s[12:15], s33 offen sc1
    s_sub_u32 s53, s53, s32
    buffer_load_dwordx4 v[44:47], v25, s[12:15], s33 offen offset:256 sc1
    s_lshl_b32 s33, s53, 11
    s_add_u32 s53, s53, 2
    s_cmp_ge_u32 s53, 10
    s_cselect_b32 s32, 10, 0
    buffer_load_dwordx4 v[48:51], v25, s[12:15], s33 offen sc1
    s_sub_u32 s53, s53, s32
    buffer_load_dwordx4 v[52:55], v25, s[12:15], s33 offen offset:256 sc1
    s_lshl_b32 s33, s53, 11
    s_add_u32 s53, s53, 2
    s_cmp_ge_u32 s53, 10
    s_cselect_b32 s32, 10, 0
    buffer_load_dwordx4 v[56:59], v25, s[12:15], s33 offen sc1
    s_sub_u32 s53, s53, s32
    buffer_load_dwordx4 v[60:63], v25, s[12:15], s33 offen offset:256 sc1
    s_lshl_b32 s33, s53, 11
    s_add_u32 s53, s53, 2
    s_cmp_ge_u32 s53, 10
    s_cselect_b32 s32, 10, 0
    buffer_load_dwordx4 v[64:67], v25, s[12:15], s33 offen sc1
    s_sub_u32 s53, s53, s32
    buffer_load_dwordx4 v[68:71], v25, s[12:15], s33 offen offset:256 sc1
    s_waitcnt lgkmcnt(0)
    s_cmp_ge_u32 s34, 2097152
    s_cbranch_scc0 B_slow
    s_lshl_b32 s33, s53, 11
    s_add_u32 s33, s33, 20480
    s_add_u32 s53, s53, 2
    s_cmp_ge_u32 s53, 10
    s_cselect_b32 s32, 10, 0
    buffer_load_dwordx4 v[72:75], v25, s[12:15], s33 offen sc1
    s_sub_u32 s53, s53, s32
    buffer_load_dwordx4 v[76:79], v25, s[12:15], s33 offen offset:256 sc1
    s_lshl_b32 s33, s53, 11
    s_add_u32 s33, s33, 20480
    s_add_u32 s53, s53, 2
    s_cmp_ge_u32 s53, 10
    s_cselect_b32 s32, 10, 0
    buffer_load_dwordx4 v[80:83], v25, s[12:15], s33 offen sc1
    s_sub_u32 s53, s53, s32
    buffer_load_dwordx4 v[84:87], v25, s[12:15], s33 offen offset:256 sc1
    s_lshl_b32 s33, s53, 11
    s_add_u32 s33, s33, 20480
    s_add_u32 s53, s53, 2
    s_cmp_ge_u32 s53, 10
    s_cselect_b32 s32, 10, 0
    buffer_load_dwordx4 v[88:91], v25, s[12:15], s33 offen sc1
    s_sub_u32 s53, s53, s32
    buffer_load_dwordx4 v[92:95], v25, s[12:15], s33 offen offset:256 sc1
    s_lshl_b32 s33, s53, 11
    s_add_u32 s33, s33, 20480
    s_add_u32 s53, s53, 2
    s_cmp_ge_u32 s53, 10
    s_cselect_b32 s32, 10, 0
    buffer_load_dwordx4 v[96:99], v25, s[12:15], s33 offen sc1
    s_sub_u32 s53, s53, s32
    buffer_load_dwordx4 v[100:103], v25, s[12:15], s33 offen offset:256 sc1
    s_lshl_b32 s33, s53, 11
    s_add_u32 s33, s33, 20480
    s_add_u32 s53, s53, 2
    s_cmp_ge_u32 s53, 10
    s_cselect_b32 s32, 10, 0
    buffer_load_dwordx4 v[104:107], v25, s[12:15], s33 offen sc1
    s_sub_u32 s53, s53, s32
    buffer_load_dwordx4 v[108:111], v25, s[12:15], s33 offen offset:256 sc1
    s_branch B_both
B_early:
    s_lshl_b32 s33, s53, 11
    s_add_u32 s53, s53, 2
    s_cmp_ge_u32 s53, 10
    s_cselect_b32 s32, 10, 0
    buffer_load_dwordx4 v[32:35], v25, s[12:15], s33 offen sc1
    s_sub_u32 s53, s53, s32
    buffer_load_dwordx4 v[36:39], v25, s[12:15], s33 offen offset:256 sc1
    s_lshl_b32 s33, s53, 11
    s_add_u32 s53, s53, 2
    s_cmp_ge_u32 s53, 10
    s_cselect_b32 s32, 10, 0
    buffer_load_dwordx4 v[40:43], v25, s[12:15], s33 offen sc1
    s_sub_u32 s53, s53, s32
    buffer_load_dwordx4 v[44:47], v25, s[12:15], s33 offen offset:256 sc1
    s_lshl_b32 s33, s53, 11
    s_add_u32 s53, s53, 2
    s_cmp_ge_u32 s53, 10
    s_cselect_b32 s32, 10, 0
    buffer_load_dwordx4 v[48:51], v25, s[12:15], s33 offen sc1
    s_sub_u32 s53, s53, s32
    buffer_load_dwordx4 v[52:55], v25, s[12:15], s33 offen offset:256 sc1
    s_lshl_b32 s33, s53, 11
    s_add_u32 s53, s53, 2
    s_cmp_ge_u32 s53, 10
    s_cselect_b32 s32, 10, 0
    buffer_load_dwordx4 v[56:59], v25, s[12:15], s33 offen sc1
    s_sub_u32 s53, s53, s32
    buffer_load_dwordx4 v[60:63], v25, s[12:15], s33 offen offset:256 sc1
    s_lshl_b32 s33, s53, 11
    s_add_u32 s53, s53, 2
    s_cmp_ge_u32 s53, 10
    s_cselect_b32 s32, 10, 0
    buffer_load_dwordx4 v[64:67], v25, s[12:15], s33 offen sc1
    s_sub_u32 s53, s53, s32
    buffer_load_dwordx4 v[68:71], v25, s[12:15], s33 offen offset:256 sc1
    s_cmp_ge_u32 s34, 2097152
    s_cbranch_scc1 B_early2
    s_load_dword s34, s[100:101], 0 glc
    v_sub_f32 v12, 1.0, v10
    v_sub_f32 v13, 1.0, v11
    s_mul_i32 s32, s28, 5120
    s_add_u32 s32, s32, 20480
    v_add_u32 v30, s32, v9
    s_xor_b32 s32, s28, 2
    s_mul_i32 s32, s32, 5120
    s_add_u32 s32, s32, 20480
    v_add_u32 v31, s32, v9
    v_mul_u32_u24 v28, 1280, v24
    v_lshl_add_u32 v28, v4, 3, v28
    v_add_u32 v28, s29, v28
    v_mul_f32 v112, v112, v12
    v_mul_f32 v113, v113, v12
    v_mul_f32 v114, v114, v12
    v_mul_f32 v115, v115, v12
    v_mul_f32 v116, v116, v12
    v_mul_f32 v117, v117, v12
    v_mul_f32 v118, v118, v12
    v_mul_f32 v119, v119, v12
    v_mul_f32 v120, v120, v12
    v_mul_f32 v121, v121, v12
    v_mul_f32 v122, v122, v12
    v_mul_f32 v123, v123, v12
    v_mul_f32 v124, v124, v12
    v_mul_f32 v125, v125, v12
    v_mul_f32 v126, v126, v12
    v_mul_f32 v127, v127, v12
    v_mul_f32 v128, v128, v12
    v_mul_f32 v129, v129, v12
    v_mul_f32 v130, v130, v12
    v_mul_f32 v131, v131, v12
    v_mul_f32 v132, v132, v13
    v_mul_f32 v133, v133, v13
    v_mul_f32 v134, v134, v13
    v_mul_f32 v135, v135, v13
    v_mul_f32 v136, v136, v13
    v_mul_f32 v137, v137, v13
    v_mul_f32 v138, v138, v13
    v_mul_f32 v139, v139, v13
    v_mul_f32 v140, v140, v13
    v_mul_f32 v141, v141, v13
    v_mul_f32 v142, v142, v13
    v_mul_f32 v143, v143, v13
    v_mul_f32 v144, v144, v13
    v_mul_f32 v145, v145, v13
    v_mul_f32 v146, v146, v13
    v_mul_f32 v147, v147, v13
    v_mul_f32 v148, v148, v13
    v_mul_f32 v149, v149, v13
    v_mul_f32 v150, v150, v13
    v_mul_f32 v151, v151, v13
    s_mov_b32 s40, s8
    s_mov_b32 s41, s9
    s_mov_b32 s42, 0x280000
    s_mov_b32 s43, 0x00020000
    s_barrier
    s_waitcnt lgkmcnt(0)
    s_cmp_ge_u32 s34, 2097152
    s_cbranch_scc0 B_slow
    s_lshl_b32 s33, s53, 11
    s_add_u32 s33, s33, 20480
    s_add_u32 s53, s53, 2
    s_cmp_ge_u32 s53, 10
    s_cselect_b32 s32, 10, 0
    buffer_load_dwordx4 v[72:75], v25, s[12:15], s33 offen sc1
    s_sub_u32 s53, s53, s32
    buffer_load_dwordx4 v[76:79], v25, s[12:15], s33 offen offset:256 sc1
    s_lshl_b32 s33, s53, 11
    s_add_u32 s33, s33, 20480
    s_add_u32 s53, s53, 2
    s_cmp_ge_u32 s53, 10
    s_cselect_b32 s32, 10, 0
    buffer_load_dwordx4 v[80:83], v25, s[12:15], s33 offen sc1
    s_sub_u32 s53, s53, s32
    buffer_load_dwordx4 v[84:87], v25, s[12:15], s33 offen offset:256 sc1
    s_lshl_b32 s33, s53, 11
    s_add_u32 s33, s33, 20480
    s_add_u32 s53, s53, 2
    s_cmp_ge_u32 s53, 10
    s_cselect_b32 s32, 10, 0
    buffer_load_dwordx4 v[88:91], v25, s[12:15], s33 offen sc1
    s_sub_u32 s53, s53, s32
    buffer_load_dwordx4 v[92:95], v25, s[12:15], s33 offen offset:256 sc1
    s_lshl_b32 s33, s53, 11
    s_add_u32 s33, s33, 20480
    s_add_u32 s53, s53, 2
    s_cmp_ge_u32 s53, 10
    s_cselect_b32 s32, 10, 0
    buffer_load_dwordx4 v[96:99], v25, s[12:15], s33 offen sc1
    s_sub_u32 s53, s53, s32
    buffer_load_dwordx4 v[100:103], v25, s[12:15], s33 offen offset:256 sc1
    s_lshl_b32 s33, s53, 11
    s_add_u32 s33, s33, 20480
    s_add_u32 s53, s53, 2
    s_cmp_ge_u32 s53, 10
    s_cselect_b32 s32, 10, 0
    buffer_load_dwordx4 v[104:107], v25, s[12:15], s33 offen sc1
    s_sub_u32 s53, s53, s32
    buffer_load_dwordx4 v[108:111], v25, s[12:15], s33 offen offset:256 sc1
    s_branch B_both
B_early2:
    s_lshl_b32 s33, s53, 11
    s_add_u32 s33, s33, 20480
    s_add_u32 s53, s53, 2
    s_cmp_ge_u32 s53, 10
    s_cselect_b32 s32, 10, 0
    buffer_load_dwordx4 v[72:75], v25, s[12:15], s33 offen sc1
    s_sub_u32 s53, s53, s32
    buffer_load_dwordx4 v[76:79], v25, s[12:15], s33 offen offset:256 sc1
    s_lshl_b32 s33, s53, 11
    s_add_u32 s33, s33, 20480
    s_add_u32 s53, s53, 2
    s_cmp_ge_u32 s53, 10
    s_cselect_b32 s32, 10, 0
    buffer_load_dwordx4 v[80:83], v25, s[12:15], s33 offen sc1
    s_sub_u32 s53, s53, s32
    buffer_load_dwordx4 v[84:87], v25, s[12:15], s33 offen offset:256 sc1
    s_lshl_b32 s33, s53, 11
    s_add_u32 s33, s33, 20480
    s_add_u32 s53, s53, 2
    s_cmp_ge_u32 s53, 10
    s_cselect_b32 s32, 10, 0
    buffer_load_dwordx4 v[88:91], v25, s[12:15], s33 offen sc1
    s_sub_u32 s53, s53, s32
    buffer_load_dwordx4 v[92:95], v25, s[12:15], s33 offen offset:256 sc1
    s_lshl_b32 s33, s53, 11
    s_add_u32 s33, s33, 20480
    s_add_u32 s53, s53, 2
    s_cmp_ge_u32 s53, 10
    s_cselect_b32 s32, 10, 0
    buffer_load_dwordx4 v[96:99], v25, s[12:15], s33 offen sc1
    s_sub_u32 s53, s53, s32
    buffer_load_dwordx4 v[100:103], v25, s[12:15], s33 offen offset:256 sc1
    s_lshl_b32 s33, s53, 11
    s_add_u32 s33, s33, 20480
    s_add_u32 s53, s53, 2
    s_cmp_ge_u32 s53, 10
    s_cselect_b32 s32, 10, 0
    buffer_load_dwordx4 v[104:107], v25, s[12:15], s33 offen sc1
    s_sub_u32 s53, s53, s32
    buffer_load_dwordx4 v[108:111], v25, s[12:15], s33 offen offset:256 sc1
    v_sub_f32 v12, 1.0, v10
    v_sub_f32 v13, 1.0, v11
    s_mul_i32 s32, s28, 5120
    s_add_u32 s32, s32, 20480
    v_add_u32 v30, s32, v9
    s_xor_b32 s32, s28, 2
    s_mul_i32 s32, s32, 5120
    s_add_u32 s32, s32, 20480
    v_add_u32 v31, s32, v9
    v_mul_u32_u24 v28, 1280, v24
    v_lshl_add_u32 v28, v4, 3, v28
    v_add_u32 v28, s29, v28
    v_mul_f32 v112, v112, v12
    v_mul_f32 v113, v113, v12
    v_mul_f32 v114, v114, v12
    v_mul_f32 v115, v115, v12
    v_mul_f32 v116, v116, v12
    v_mul_f32 v117, v117, v12
    v_mul_f32 v118, v118, v12
    v_mul_f32 v119, v119, v12
    v_mul_f32 v120, v120, v12
    v_mul_f32 v121, v121, v12
    v_mul_f32 v122, v122, v12
    v_mul_f32 v123, v123, v12
    v_mul_f32 v124, v124, v12
    v_mul_f32 v125, v125, v12
    v_mul_f32 v126, v126, v12
    v_mul_f32 v127, v127, v12
    v_mul_f32 v128, v128, v12
    v_mul_f32 v129, v129, v12
    v_mul_f32 v130, v130, v12
    v_mul_f32 v131, v131, v12
    v_mul_f32 v132, v132, v13
    v_mul_f32 v133, v133, v13
    v_mul_f32 v134, v134, v13
    v_mul_f32 v135, v135, v13
    v_mul_f32 v136, v136, v13
    v_mul_f32 v137, v137, v13
    v_mul_f32 v138, v138, v13
    v_mul_f32 v139, v139, v13
    v_mul_f32 v140, v140, v13
    v_mul_f32 v141, v141, v13
    v_mul_f32 v142, v142, v13
    v_mul_f32 v143, v143, v13
    v_mul_f32 v144, v144, v13
    v_mul_f32 v145, v145, v13
    v_mul_f32 v146, v146, v13
    v_mul_f32 v147, v147, v13
    v_mul_f32 v148, v148, v13
    v_mul_f32 v149, v149, v13
    v_mul_f32 v150, v150, v13
    v_mul_f32 v151, v151, v13
    s_mov_b32 s40, s8
    s_mov_b32 s41, s9
    s_mov_b32 s42, 0x280000
    s_mov_b32 s43, 0x00020000
    s_barrier
B_both:
    s_waitcnt vmcnt(18) lgkmcnt(5)
    v_mfma_f32_16x16x32_bf16 v[152:155], v[192:195], v[32:35], 0
    ds_read_b128 v[232:235], v26 offset:20480
    v_mfma_f32_16x16x32_bf16 v[172:175], v[192:195], v[36:39], 0
    ds_read_b128 v[236:239], v26 offset:20992
    v_mfma_f32_16x16x32_bf16 v[156:159], v[196:199], v[32:35], 0
    ds_read_b128 v[240:243], v26 offset:21504
    v_mfma_f32_16x16x32_bf16 v[176:179], v[196:199], v[36:39], 0
    ds_read_b128 v[244:247], v26 offset:22016
    v_mfma_f32_16x16x32_bf16 v[160:163], v[200:203], v[32:35], 0
    ds_read_b128 v[248:251], v26 offset:22528
    v_mfma_f32_16x16x32_bf16 v[180:183], v[200:203], v[36:39], 0
    v_mfma_f32_16x16x32_bf16 v[164:167], v[204:207], v[32:35], 0
    v_mfma_f32_16x16x32_bf16 v[184:187], v[204:207], v[36:39], 0
    v_mfma_f32_16x16x32_bf16 v[168:171], v[208:211], v[32:35], 0
    v_mfma_f32_16x16x32_bf16 v[188:191], v[208:211], v[36:39], 0
    s_waitcnt vmcnt(16) lgkmcnt(5)
    v_mfma_f32_16x16x32_bf16 v[152:155], v[212:215], v[40:43], v[152:155]
    ds_read_b128 v[192:195], v26 offset:30720
    v_mfma_f32_16x16x32_bf16 v[172:175], v[212:215], v[44:47], v[172:175]
    ds_read_b128 v[196:199], v26 offset:31232
    v_mfma_f32_16x16x32_bf16 v[156:159], v[216:219], v[40:43], v[156:159]
    ds_read_b128 v[200:203], v26 offset:31744
    v_mfma_f32_16x16x32_bf16 v[176:179], v[216:219], v[44:47], v[176:179]
    ds_read_b128 v[204:207], v26 offset:32256
    v_mfma_f32_16x16x32_bf16 v[160:163], v[220:223], v[40:43], v[160:163]
    ds_read_b128 v[208:211], v26 offset:32768
    v_mfma_f32_16x16x32_bf16 v[180:183], v[220:223], v[44:47], v[180:183]
    v_mfma_f32_16x16x32_bf16 v[164:167], v[224:227], v[40:43], v[164:167]
    v_mfma_f32_16x16x32_bf16 v[184:187], v[224:227], v[44:47], v[184:187]
    v_mfma_f32_16x16x32_bf16 v[168:171], v[228:231], v[40:43], v[168:171]
    v_mfma_f32_16x16x32_bf16 v[188:191], v[228:231], v[44:47], v[188:191]
    s_waitcnt vmcnt(14) lgkmcnt(5)
    s_barrier
    v_mfma_f32_16x16x32_bf16 v[152:155], v[232:235], v[48:51], v[152:155]
    ds_read_b128 v[212:215], v27 offset:0
    v_mfma_f32_16x16x32_bf16 v[172:175], v[232:235], v[52:55], v[172:175]
    ds_read_b128 v[216:219], v27 offset:512
    v_mfma_f32_16x16x32_bf16 v[156:159], v[236:239], v[48:51], v[156:159]
    ds_read_b128 v[220:223], v27 offset:1024
    v_mfma_f32_16x16x32_bf16 v[176:179], v[236:239], v[52:55], v[176:179]
    ds_read_b128 v[224:227], v27 offset:1536
    v_mfma_f32_16x16x32_bf16 v[160:163], v[240:243], v[48:51], v[160:163]
    ds_read_b128 v[228:231], v27 offset:2048
    v_mfma_f32_16x16x32_bf16 v[180:183], v[240:243], v[52:55], v[180:183]
    v_mfma_f32_16x16x32_bf16 v[164:167], v[244:247], v[48:51], v[164:167]
    v_mfma_f32_16x16x32_bf16 v[184:187], v[244:247], v[52:55], v[184:187]
    v_mfma_f32_16x16x32_bf16 v[168:171], v[248:251], v[48:51], v[168:171]
    v_mfma_f32_16x16x32_bf16 v[188:191], v[248:251], v[52:55], v[188:191]
    s_waitcnt vmcnt(12) lgkmcnt(5)
    v_mfma_f32_16x16x32_bf16 v[152:155], v[192:195], v[56:59], v[152:155]
    ds_read_b128 v[232:235], v27 offset:10240
    v_mfma_f32_16x16x32_bf16 v[172:175], v[192:195], v[60:63], v[172:175]
    ds_read_b128 v[236:239], v27 offset:10752
    v_mfma_f32_16x16x32_bf16 v[156:159], v[196:199], v[56:59], v[156:159]
    ds_read_b128 v[240:243], v27 offset:11264
    v_mfma_f32_16x16x32_bf16 v[176:179], v[196:199], v[60:63], v[176:179]
    ds_read_b128 v[244:247], v27 offset:11776
    v_mfma_f32_16x16x32_bf16 v[160:163], v[200:203], v[56:59], v[160:163]
    ds_read_b128 v[248:251], v27 offset:12288
    v_mfma_f32_16x16x32_bf16 v[180:183], v[200:203], v[60:63], v[180:183]
    v_mfma_f32_16x16x32_bf16 v[164:167], v[204:207], v[56:59], v[164:167]
    v_mfma_f32_16x16x32_bf16 v[184:187], v[204:207], v[60:63], v[184:187]
    v_mfma_f32_16x16x32_bf16 v[168:171], v[208:211], v[56:59], v[168:171]
    v_mfma_f32_16x16x32_bf16 v[188:191], v[208:211], v[60:63], v[188:191]
    s_waitcnt vmcnt(10) lgkmcnt(5)
    v_mfma_f32_16x16x32_bf16 v[152:155], v[212:215], v[64:67], v[152:155]
    ds_read_b128 v[192:195], v27 offset:20480
    v_mfma_f32_16x16x32_bf16 v[172:175], v[212:215], v[68:71], v[172:175]
    ds_read_b128 v[196:199], v27 offset:20992
    v_mfma_f32_16x16x32_bf16 v[156:159], v[216:219], v[64:67], v[156:159]
    ds_read_b128 v[200:203], v27 offset:21504
    v_mfma_f32_16x16x32_bf16 v[176:179], v[216:219], v[68:71], v[176:179]
    ds_read_b128 v[204:207], v27 offset:22016
    v_mfma_f32_16x16x32_bf16 v[160:163], v[220:223], v[64:67], v[160:163]
    ds_read_b128 v[208:211], v27 offset:22528
    v_mfma_f32_16x16x32_bf16 v[180:183], v[220:223], v[68:71], v[180:183]
    v_mfma_f32_16x16x32_bf16 v[164:167], v[224:227], v[64:67], v[164:167]
    v_mfma_f32_16x16x32_bf16 v[184:187], v[224:227], v[68:71], v[184:187]
    v_mfma_f32_16x16x32_bf16 v[168:171], v[228:231], v[64:67], v[168:171]
    v_mfma_f32_16x16x32_bf16 v[188:191], v[228:231], v[68:71], v[188:191]
    s_barrier
    s_branch B_second
B_slow:
    s_setprio 0
    s_waitcnt vmcnt(8) lgkmcnt(5)
    v_mfma_f32_16x16x32_bf16 v[152:155], v[192:195], v[32:35], 0
    ds_read_b128 v[232:235], v26 offset:20480
    v_mfma_f32_16x16x32_bf16 v[172:175], v[192:195], v[36:39], 0
    ds_read_b128 v[236:239], v26 offset:20992
    v_mfma_f32_16x16x32_bf16 v[156:159], v[196:199], v[32:35], 0
    ds_read_b128 v[240:243], v26 offset:21504
    v_mfma_f32_16x16x32_bf16 v[176:179], v[196:199], v[36:39], 0
    ds_read_b128 v[244:247], v26 offset:22016
    v_mfma_f32_16x16x32_bf16 v[160:163], v[200:203], v[32:35], 0
    ds_read_b128 v[248:251], v26 offset:22528
    v_mfma_f32_16x16x32_bf16 v[180:183], v[200:203], v[36:39], 0
    v_mfma_f32_16x16x32_bf16 v[164:167], v[204:207], v[32:35], 0
    v_mfma_f32_16x16x32_bf16 v[184:187], v[204:207], v[36:39], 0
    v_mfma_f32_16x16x32_bf16 v[168:171], v[208:211], v[32:35], 0
    v_mfma_f32_16x16x32_bf16 v[188:191], v[208:211], v[36:39], 0
    s_waitcnt vmcnt(6) lgkmcnt(5)
    v_mfma_f32_16x16x32_bf16 v[152:155], v[212:215], v[40:43], v[152:155]
    ds_read_b128 v[192:195], v26 offset:30720
    v_mfma_f32_16x16x32_bf16 v[172:175], v[212:215], v[44:47], v[172:175]
    ds_read_b128 v[196:199], v26 offset:31232
    v_mfma_f32_16x16x32_bf16 v[156:159], v[216:219], v[40:43], v[156:159]
    ds_read_b128 v[200:203], v26 offset:31744
    v_mfma_f32_16x16x32_bf16 v[176:179], v[216:219], v[44:47], v[176:179]
    ds_read_b128 v[204:207], v26 offset:32256
    v_mfma_f32_16x16x32_bf16 v[160:163], v[220:223], v[40:43], v[160:163]
    ds_read_b128 v[208:211], v26 offset:32768
    v_mfma_f32_16x16x32_bf16 v[180:183], v[220:223], v[44:47], v[180:183]
    v_mfma_f32_16x16x32_bf16 v[164:167], v[224:227], v[40:43], v[164:167]
    v_mfma_f32_16x16x32_bf16 v[184:187], v[224:227], v[44:47], v[184:187]
    v_mfma_f32_16x16x32_bf16 v[168:171], v[228:231], v[40:43], v[168:171]
    v_mfma_f32_16x16x32_bf16 v[188:191], v[228:231], v[44:47], v[188:191]
    s_waitcnt vmcnt(4) lgkmcnt(5)
    s_barrier
    v_mfma_f32_16x16x32_bf16 v[152:155], v[232:235], v[48:51], v[152:155]
    ds_read_b128 v[212:215], v27 offset:0
    v_mfma_f32_16x16x32_bf16 v[172:175], v[232:235], v[52:55], v[172:175]
    ds_read_b128 v[216:219], v27 offset:512
    v_mfma_f32_16x16x32_bf16 v[156:159], v[236:239], v[48:51], v[156:159]
    ds_read_b128 v[220:223], v27 offset:1024
    v_mfma_f32_16x16x32_bf16 v[176:179], v[236:239], v[52:55], v[176:179]
    ds_read_b128 v[224:227], v27 offset:1536
    v_mfma_f32_16x16x32_bf16 v[160:163], v[240:243], v[48:51], v[160:163]
    ds_read_b128 v[228:231], v27 offset:2048
    v_mfma_f32_16x16x32_bf16 v[180:183], v[240:243], v[52:55], v[180:183]
    v_mfma_f32_16x16x32_bf16 v[164:167], v[244:247], v[48:51], v[164:167]
    v_mfma_f32_16x16x32_bf16 v[184:187], v[244:247], v[52:55], v[184:187]
    v_mfma_f32_16x16x32_bf16 v[168:171], v[248:251], v[48:51], v[168:171]
    v_mfma_f32_16x16x32_bf16 v[188:191], v[248:251], v[52:55], v[188:191]
    s_waitcnt vmcnt(2) lgkmcnt(5)
    v_mfma_f32_16x16x32_bf16 v[152:155], v[192:195], v[56:59], v[152:155]
    ds_read_b128 v[232:235], v27 offset:10240
    v_mfma_f32_16x16x32_bf16 v[172:175], v[192:195], v[60:63], v[172:175]
    ds_read_b128 v[236:239], v27 offset:10752
    v_mfma_f32_16x16x32_bf16 v[156:159], v[196:199], v[56:59], v[156:159]
    ds_read_b128 v[240:243], v27 offset:11264
    v_mfma_f32_16x16x32_bf16 v[176:179], v[196:199], v[60:63], v[176:179]
    ds_read_b128 v[244:247], v27 offset:11776
    v_mfma_f32_16x16x32_bf16 v[160:163], v[200:203], v[56:59], v[160:163]
    ds_read_b128 v[248:251], v27 offset:12288
    v_mfma_f32_16x16x32_bf16 v[180:183], v[200:203], v[60:63], v[180:183]
    v_mfma_f32_16x16x32_bf16 v[164:167], v[204:207], v[56:59], v[164:167]
    v_mfma_f32_16x16x32_bf16 v[184:187], v[204:207], v[60:63], v[184:187]
    v_mfma_f32_16x16x32_bf16 v[168:171], v[208:211], v[56:59], v[168:171]
    v_mfma_f32_16x16x32_bf16 v[188:191], v[208:211], v[60:63], v[188:191]
    s_waitcnt vmcnt(0) lgkmcnt(5)
    v_mfma_f32_16x16x32_bf16 v[152:155], v[212:215], v[64:67], v[152:155]
    ds_read_b128 v[192:195], v27 offset:20480
    v_mfma_f32_16x16x32_bf16 v[172:175], v[212:215], v[68:71], v[172:175]
    ds_read_b128 v[196:199], v27 offset:20992
    v_mfma_f32_16x16x32_bf16 v[156:159], v[216:219], v[64:67], v[156:159]
    ds_read_b128 v[200:203], v27 offset:21504
    v_mfma_f32_16x16x32_bf16 v[176:179], v[216:219], v[68:71], v[176:179]
    ds_read_b128 v[204:207], v27 offset:22016
    v_mfma_f32_16x16x32_bf16 v[160:163], v[220:223], v[64:67], v[160:163]
    ds_read_b128 v[208:211], v27 offset:22528
    v_mfma_f32_16x16x32_bf16 v[180:183], v[220:223], v[68:71], v[180:183]
    v_mfma_f32_16x16x32_bf16 v[164:167], v[224:227], v[64:67], v[164:167]
    v_mfma_f32_16x16x32_bf16 v[184:187], v[224:227], v[68:71], v[184:187]
    v_mfma_f32_16x16x32_bf16 v[168:171], v[228:231], v[64:67], v[168:171]
    v_mfma_f32_16x16x32_bf16 v[188:191], v[228:231], v[68:71], v[188:191]
    s_cmp_lg_u32 s28, 0
    s_cbranch_scc1 B_pollo_done
    s_add_u32 s98, s60, s57
    s_addc_u32 s99, s61, 0
    s_mov_b32 s59, 0
B_pollo:
    s_load_dword s58, s[98:99], 0 glc
    s_add_u32 s59, s59, 1
    s_waitcnt lgkmcnt(0)
    s_cmp_ge_u32 s58, 2097152
    s_cbranch_scc1 B_pollo_done
    s_cmp_gt_u32 s59, 1048576
    s_cbranch_scc1 B_pollo_done
    s_sleep 2
    s_branch B_pollo
B_pollo_done:
    s_barrier
    s_lshl_b32 s33, s53, 11
    s_add_u32 s33, s33, 20480
    s_add_u32 s53, s53, 2
    s_cmp_ge_u32 s53, 10
    s_cselect_b32 s32, 10, 0
    buffer_load_dwordx4 v[72:75], v25, s[12:15], s33 offen sc1
    s_sub_u32 s53, s53, s32
    buffer_load_dwordx4 v[76:79], v25, s[12:15], s33 offen offset:256 sc1
    s_lshl_b32 s33, s53, 11
    s_add_u32 s33, s33, 20480
    s_add_u32 s53, s53, 2
    s_cmp_ge_u32 s53, 10
    s_cselect_b32 s32, 10, 0
    buffer_load_dwordx4 v[80:83], v25, s[12:15], s33 offen sc1
    s_sub_u32 s53, s53, s32
    buffer_load_dwordx4 v[84:87], v25, s[12:15], s33 offen offset:256 sc1
    s_lshl_b32 s33, s53, 11
    s_add_u32 s33, s33, 20480
    s_add_u32 s53, s53, 2
    s_cmp_ge_u32 s53, 10
    s_cselect_b32 s32, 10, 0
    buffer_load_dwordx4 v[88:91], v25, s[12:15], s33 offen sc1
    s_sub_u32 s53, s53, s32
    buffer_load_dwordx4 v[92:95], v25, s[12:15], s33 offen offset:256 sc1
    s_lshl_b32 s33, s53, 11
    s_add_u32 s33, s33, 20480
    s_add_u32 s53, s53, 2
    s_cmp_ge_u32 s53, 10
    s_cselect_b32 s32, 10, 0
    buffer_load_dwordx4 v[96:99], v25, s[12:15], s33 offen sc1
    s_sub_u32 s53, s53, s32
    buffer_load_dwordx4 v[100:103], v25, s[12:15], s33 offen offset:256 sc1
    s_lshl_b32 s33, s53, 11
    s_add_u32 s33, s33, 20480
    s_add_u32 s53, s53, 2
    s_cmp_ge_u32 s53, 10
    s_cselect_b32 s32, 10, 0
    buffer_load_dwordx4 v[104:107], v25, s[12:15], s33 offen sc1
    s_sub_u32 s53, s53, s32
    buffer_load_dwordx4 v[108:111], v25, s[12:15], s33 offen offset:256 sc1
B_second:
    s_waitcnt vmcnt(8) lgkmcnt(5)
    v_mfma_f32_16x16x32_bf16 v[152:155], v[232:235], v[72:75], v[152:155]
    ds_read_b128 v[212:215], v27 offset:30720
    v_mfma_f32_16x16x32_bf16 v[172:175], v[232:235], v[76:79], v[172:175]
    ds_read_b128 v[216:219], v27 offset:31232
    v_mfma_f32_16x16x32_bf16 v[156:159], v[236:239], v[72:75], v[156:159]
    ds_read_b128 v[220:223], v27 offset:31744
    v_mfma_f32_16x16x32_bf16 v[176:179], v[236:239], v[76:79], v[176:179]
    ds_read_b128 v[224:227], v27 offset:32256
    v_mfma_f32_16x16x32_bf16 v[160:163], v[240:243], v[72:75], v[160:163]
    ds_read_b128 v[228:231], v27 offset:32768
    v_mfma_f32_16x16x32_bf16 v[180:183], v[240:243], v[76:79], v[180:183]
    v_mfma_f32_16x16x32_bf16 v[164:167], v[244:247], v[72:75], v[164:167]
    v_mfma_f32_16x16x32_bf16 v[184:187], v[244:247], v[76:79], v[184:187]
    v_mfma_f32_16x16x32_bf16 v[168:171], v[248:251], v[72:75], v[168:171]
    v_mfma_f32_16x16x32_bf16 v[188:191], v[248:251], v[76:79], v[188:191]
    s_waitcnt vmcnt(6) lgkmcnt(5)
    v_mfma_f32_16x16x32_bf16 v[152:155], v[192:195], v[80:83], v[152:155]
    ds_read_b128 v[232:235], v26 offset:0
    v_mfma_f32_16x16x32_bf16 v[172:175], v[192:195], v[84:87], v[172:175]
    ds_read_b128 v[236:239], v26 offset:512
    v_mfma_f32_16x16x32_bf16 v[156:159], v[196:199], v[80:83], v[156:159]
    ds_read_b128 v[240:243], v26 offset:1024
    v_mfma_f32_16x16x32_bf16 v[176:179], v[196:199], v[84:87], v[176:179]
    ds_read_b128 v[244:247], v26 offset:1536
    v_mfma_f32_16x16x32_bf16 v[160:163], v[200:203], v[80:83], v[160:163]
    ds_read_b128 v[248:251], v26 offset:2048
    v_mfma_f32_16x16x32_bf16 v[180:183], v[200:203], v[84:87], v[180:183]
    v_mfma_f32_16x16x32_bf16 v[164:167], v[204:207], v[80:83], v[164:167]
    v_mfma_f32_16x16x32_bf16 v[184:187], v[204:207], v[84:87], v[184:187]
    v_mfma_f32_16x16x32_bf16 v[168:171], v[208:211], v[80:83], v[168:171]
    v_mfma_f32_16x16x32_bf16 v[188:191], v[208:211], v[84:87], v[188:191]
    s_waitcnt vmcnt(4) lgkmcnt(5)
    v_mfma_f32_16x16x32_bf16 v[152:155], v[212:215], v[88:91], v[152:155]
    ds_read_b128 v[192:195], v26 offset:10240
    v_mfma_f32_16x16x32_bf16 v[172:175], v[212:215], v[92:95], v[172:175]
    ds_read_b128 v[196:199], v26 offset:10752
    v_mfma_f32_16x16x32_bf16 v[156:159], v[216:219], v[88:91], v[156:159]
    ds_read_b128 v[200:203], v26 offset:11264
    v_mfma_f32_16x16x32_bf16 v[176:179], v[216:219], v[92:95], v[176:179]
    ds_read_b128 v[204:207], v26 offset:11776
    v_mfma_f32_16x16x32_bf16 v[160:163], v[220:223], v[88:91], v[160:163]
    ds_read_b128 v[208:211], v26 offset:12288
    v_mfma_f32_16x16x32_bf16 v[180:183], v[220:223], v[92:95], v[180:183]
    v_mfma_f32_16x16x32_bf16 v[164:167], v[224:227], v[88:91], v[164:167]
    v_mfma_f32_16x16x32_bf16 v[184:187], v[224:227], v[92:95], v[184:187]
    v_mfma_f32_16x16x32_bf16 v[168:171], v[228:231], v[88:91], v[168:171]
    v_mfma_f32_16x16x32_bf16 v[188:191], v[228:231], v[92:95], v[188:191]
    s_waitcnt vmcnt(2) lgkmcnt(5)
    v_mfma_f32_16x16x32_bf16 v[152:155], v[232:235], v[96:99], v[152:155]
    v_mfma_f32_16x16x32_bf16 v[172:175], v[232:235], v[100:103], v[172:175]
    v_mfma_f32_16x16x32_bf16 v[156:159], v[236:239], v[96:99], v[156:159]
    v_mfma_f32_16x16x32_bf16 v[176:179], v[236:239], v[100:103], v[176:179]
    v_mfma_f32_16x16x32_bf16 v[160:163], v[240:243], v[96:99], v[160:163]
    v_mfma_f32_16x16x32_bf16 v[180:183], v[240:243], v[100:103], v[180:183]
    v_mfma_f32_16x16x32_bf16 v[164:167], v[244:247], v[96:99], v[164:167]
    v_mfma_f32_16x16x32_bf16 v[184:187], v[244:247], v[100:103], v[184:187]
    v_mfma_f32_16x16x32_bf16 v[168:171], v[248:251], v[96:99], v[168:171]
    v_mfma_f32_16x16x32_bf16 v[188:191], v[248:251], v[100:103], v[188:191]
    s_waitcnt vmcnt(0) lgkmcnt(0)
    v_mfma_f32_16x16x32_bf16 v[152:155], v[192:195], v[104:107], v[152:155]
    v_mfma_f32_16x16x32_bf16 v[172:175], v[192:195], v[108:111], v[172:175]
    v_mfma_f32_16x16x32_bf16 v[156:159], v[196:199], v[104:107], v[156:159]
    v_mfma_f32_16x16x32_bf16 v[176:179], v[196:199], v[108:111], v[176:179]
    v_mfma_f32_16x16x32_bf16 v[160:163], v[200:203], v[104:107], v[160:163]
    v_mfma_f32_16x16x32_bf16 v[180:183], v[200:203], v[108:111], v[180:183]
    v_mfma_f32_16x16x32_bf16 v[164:167], v[204:207], v[104:107], v[164:167]
    v_mfma_f32_16x16x32_bf16 v[184:187], v[204:207], v[108:111], v[184:187]
    v_mfma_f32_16x16x32_bf16 v[168:171], v[208:211], v[104:107], v[168:171]
    v_mfma_f32_16x16x32_bf16 v[188:191], v[208:211], v[108:111], v[188:191]
    s_cmp_eq_u32 s36, 0
    s_cbranch_scc1 B_keep0
    s_nop 5
    v_fmac_f32 v112, v152, v10
    v_fmac_f32 v113, v153, v10
    v_fmac_f32 v114, v154, v10
    v_fmac_f32 v115, v155, v10
    ds_write_b128 v30, v[112:115] offset:0
    v_fmac_f32 v116, v156, v10
    v_fmac_f32 v117, v157, v10
    v_fmac_f32 v118, v158, v10
    v_fmac_f32 v119, v159, v10
    ds_write_b128 v30, v[116:119] offset:1024
    v_fmac_f32 v120, v160, v10
    v_fmac_f32 v121, v161, v10
    v_fmac_f32 v122, v162, v10
    v_fmac_f32 v123, v163, v10
    ds_write_b128 v30, v[120:123] offset:2048
    v_fmac_f32 v124, v164, v10
    v_fmac_f32 v125, v165, v10
    v_fmac_f32 v126, v166, v10
    v_fmac_f32 v127, v167, v10
    ds_write_b128 v30, v[124:127] offset:3072
    v_fmac_f32 v128, v168, v10
    v_fmac_f32 v129, v169, v10
    v_fmac_f32 v130, v170, v10
    v_fmac_f32 v131, v171, v10
    ds_write_b128 v30, v[128:131] offset:4096
    v_fma_f32 v32, v172, v11, v132
    v_fma_f32 v33, v173, v11, v133
    v_fma_f32 v34, v174, v11, v134
    v_fma_f32 v35, v175, v11, v135
    v_fma_f32 v36, v176, v11, v136
    v_fma_f32 v37, v177, v11, v137
    v_fma_f32 v38, v178, v11, v138
    v_fma_f32 v39, v179, v11, v139
    v_fma_f32 v40, v180, v11, v140
    v_fma_f32 v41, v181, v11, v141
    v_fma_f32 v42, v182, v11, v142
    v_fma_f32 v43, v183, v11, v143
    v_fma_f32 v44, v184, v11, v144
    v_fma_f32 v45, v185, v11, v145
    v_fma_f32 v46, v186, v11, v146
    v_fma_f32 v47, v187, v11, v147
    v_fma_f32 v48, v188, v11, v148
    v_fma_f32 v49, v189, v11, v149
    v_fma_f32 v50, v190, v11, v150
    v_fma_f32 v51, v191, v11, v151
    s_branch B_kept
B_keep0:
    s_nop 5
    v_fmac_f32 v132, v172, v11
    v_fmac_f32 v133, v173, v11
    v_fmac_f32 v134, v174, v11
    v_fmac_f32 v135, v175, v11
    ds_write_b128 v30, v[132:135] offset:0
    v_fmac_f32 v136, v176, v11
    v_fmac_f32 v137, v177, v11
    v_fmac_f32 v138, v178, v11
    v_fmac_f32 v139, v179, v11
    ds_write_b128 v30, v[136:139] offset:1024
    v_fmac_f32 v140, v180, v11
    v_fmac_f32 v141, v181, v11
    v_fmac_f32 v142, v182, v11
    v_fmac_f32 v143, v183, v11
    ds_write_b128 v30, v[140:143] offset:2048
    v_fmac_f32 v144, v184, v11
    v_fmac_f32 v145, v185, v11
    v_fmac_f32 v146, v186, v11
    v_fmac_f32 v147, v187, v11
    ds_write_b128 v30, v[144:147] offset:3072
    v_fmac_f32 v148, v188, v11
    v_fmac_f32 v149, v189, v11
    v_fmac_f32 v150, v190, v11
    v_fmac_f32 v151, v191, v11
    ds_write_b128 v30, v[148:151] offset:4096
    v_fma_f32 v32, v152, v10, v112
    v_fma_f32 v33, v153, v10, v113
    v_fma_f32 v34, v154, v10, v114
    v_fma_f32 v35, v155, v10, v115
    v_fma_f32 v36, v156, v10, v116
    v_fma_f32 v37, v157, v10, v117
    v_fma_f32 v38, v158, v10, v118
    v_fma_f32 v39, v159, v10, v119
    v_fma_f32 v40, v160, v10, v120
    v_fma_f32 v41, v161, v10, v121
    v_fma_f32 v42, v162, v10, v122
    v_fma_f32 v43, v163, v10, v123
    v_fma_f32 v44, v164, v10, v124
    v_fma_f32 v45, v165, v10, v125
    v_fma_f32 v46, v166, v10, v126
    v_fma_f32 v47, v167, v10, v127
    v_fma_f32 v48, v168, v10, v128
    v_fma_f32 v49, v169, v10, v129
    v_fma_f32 v50, v170, v10, v130
    v_fma_f32 v51, v171, v10, v131
B_kept:
    s_waitcnt lgkmcnt(0)
    s_barrier
    ds_read_b128 v[52:55], v31 offset:0
    ds_read_b128 v[56:59], v31 offset:1024
    ds_read_b128 v[60:63], v31 offset:2048
    ds_read_b128 v[64:67], v31 offset:3072
    ds_read_b128 v[68:71], v31 offset:4096
    s_waitcnt lgkmcnt(4)
    v_pk_add_f32 v[32:33], v[32:33], v[52:53]
    v_pk_add_f32 v[34:35], v[34:35], v[54:55]
    v_cvt_pk_bf16_f32 v32, v32, v33
    v_cvt_pk_bf16_f32 v33, v34, v35
    buffer_store_dwordx2 v[32:33], v28, s[40:43], 0 offen offset:0
    s_waitcnt lgkmcnt(3)
    v_pk_add_f32 v[36:37], v[36:37], v[56:57]
    v_pk_add_f32 v[38:39], v[38:39], v[58:59]
    v_cvt_pk_bf16_f32 v36, v36, v37
    v_cvt_pk_bf16_f32 v37, v38, v39
    buffer_store_dwordx2 v[36:37], v28, s[40:43], 0 offen offset:32
    s_waitcnt lgkmcnt(2)
    v_pk_add_f32 v[40:41], v[40:41], v[60:61]
    v_pk_add_f32 v[42:43], v[42:43], v[62:63]
    v_cvt_pk_bf16_f32 v40, v40, v41
    v_cvt_pk_bf16_f32 v41, v42, v43
    buffer_store_dwordx2 v[40:41], v28, s[40:43], 0 offen offset:64
    s_waitcnt lgkmcnt(1)
    v_pk_add_f32 v[44:45], v[44:45], v[64:65]
    v_pk_add_f32 v[46:47], v[46:47], v[66:67]
    v_cvt_pk_bf16_f32 v44, v44, v45
    v_cvt_pk_bf16_f32 v45, v46, v47
    buffer_store_dwordx2 v[44:45], v28, s[40:43], 0 offen offset:96
    s_waitcnt lgkmcnt(0)
    v_pk_add_f32 v[48:49], v[48:49], v[68:69]
    v_pk_add_f32 v[50:51], v[50:51], v[70:71]
    v_cvt_pk_bf16_f32 v48, v48, v49
    v_cvt_pk_bf16_f32 v49, v50, v51
    buffer_store_dwordx2 v[48:49], v28, s[40:43], 0 offen offset:128
    s_endpgm
CODE_END:
    s_endpgm
.section .rodata,"a"
.p2align 6
.amdhsa_kernel gated_mix__mha_block__swiglu_ffn__prompt_kernel
  .amdhsa_next_free_vgpr 256
  .amdhsa_next_free_sgpr 102
  .amdhsa_accum_offset 256
  .amdhsa_group_segment_fixed_size 0
  .amdhsa_kernarg_size 88
  .amdhsa_user_sgpr_count 2
  .amdhsa_user_sgpr_kernarg_segment_ptr 1
  .amdhsa_system_sgpr_workgroup_id_x 1
.end_amdhsa_kernel
```
